```python
import torch

def _softmax(x, axis=-1):
    return torch.softmax(x, dim=axis)
def _gelu(x):
    return torch.nn.functional.gelu(x, approximate="tanh")
def _silu(x):
    return torch.nn.functional.silu(x)
def _sigmoid(x):
    return torch.sigmoid(x)
def _layernorm(x, axis=-1, eps=1e-5):
    m = x.mean(dim=axis, keepdim=True)
    v = x.var(dim=axis, keepdim=True, unbiased=False)
    return (x - m) / torch.sqrt(v + eps)
def _scatter_add(tgt, idx, src, axis=0):
    return tgt.clone().index_add_(axis, idx, src)
def _segment_sum(src, seg, n):
    out = torch.zeros((n,) + src.shape[1:], dtype=src.dtype)
    return out.index_add_(0, seg, src)
def _pad(x, pw):
    flat = tuple(v for pair in reversed(pw) for v in pair)
    return torch.nn.functional.pad(x, flat)

kernel_name = 'gated_mix__mha_block_cached__moe_arch_mod__decode'

def setup_inputs():

    _w = (lambda a: (lambda t: t.to(torch.bfloat16) if t.is_floating_point() else t)(torch.as_tensor(a)))
    def _A_setup():
        B, Sq, D = 8, 1, 512
        H, Sk, Dh = 32, 4096, 128
        return {
            "x": _w((lambda *s: torch.randn(*s, dtype=torch.bfloat16) * 0.05)(B, Sq, D)),
            "k_cache": _w((lambda *s: torch.randn(*s, dtype=torch.bfloat16) * 3.2)(B, H, Sk, Dh)),
            "v_cache": _w((lambda *s: torch.randn(*s, dtype=torch.bfloat16) * 1.6)(B, H, Sk, Dh)),
            "wq": _w((lambda *s: torch.randn(*s, dtype=torch.bfloat16) * 3.2)(D, H * Dh) * (D ** -0.5)),
            "wo": _w((lambda *s: torch.randn(*s, dtype=torch.bfloat16) * 1.6)(H * Dh, D) * ((H * Dh) ** -0.5)),
        }
    _A_in = _A_setup()

    def _B_setup():
        B, S, D, F, C = 8, 1, 512, 1792, 1
        return {
            "x": _w((lambda *s: torch.randn(*s, dtype=torch.bfloat16) * 0.05)(B, S, D)),
            "w_r": _w((lambda *s: torch.randn(*s, dtype=torch.bfloat16) * 1.6)(D)),
            "w_gate": _w((lambda *s: torch.randn(*s, dtype=torch.bfloat16) * 0.1)(D, F)),
            "w_up": _w((lambda *s: torch.randn(*s, dtype=torch.bfloat16) * 0.1)(D, F)),
            "w_down": _w((lambda *s: torch.randn(*s, dtype=torch.bfloat16) * 0.1)(F, D)),
        }
    _B_in = _B_setup()

    return {
        "A_x": _A_in["x"],
        "A_k_cache": _A_in["k_cache"],
        "A_v_cache": _A_in["v_cache"],
        "A_wq": _A_in["wq"],
        "A_wo": _A_in["wo"],
        "B_x": _B_in["x"],
        "B_w_r": _B_in["w_r"],
        "B_w_gate": _B_in["w_gate"],
        "B_w_up": _B_in["w_up"],
        "B_w_down": _B_in["w_down"],
        "gate_w": _w((lambda *s: torch.randn(*s, dtype=torch.bfloat16) * 0.05)(512) * 16.0),
    }

def reference(A_x, A_k_cache, A_v_cache, A_wq, A_wo, B_x, B_w_r, B_w_gate, B_w_up, B_w_down, gate_w):
    def _A_ref(x, k_cache, v_cache, wq, wo):
        B, Sq, D = x.shape
        H, Dh = 32, 128
        q = (lambda x, *d: x.permute(*d))((x @ wq).reshape(B, Sq, H, Dh), 0, 2, 1, 3)
        scores = torch.einsum("bhqd,bhkd->bhqk", q, k_cache) * (Dh ** -0.5)
        p = _softmax(scores, axis=-1)
        o = torch.einsum("bhqk,bhkd->bhqd", p, v_cache)
        return (lambda x, *d: x.permute(*d))(o, 0, 2, 1, 3).reshape(B, Sq, H * Dh) @ wo

    def _B_ref(x, w_r, w_gate, w_up, w_down):
        B, S, D = x.shape
        C = 1
        r = x @ w_r
        idx = torch.argsort(-r, axis=-1)[:, :C]
        idx_e = (lambda x, n, axis: torch.repeat_interleave(x, n, dim=axis))(idx.reshape(B, C, 1), D, axis=2)
        x_sel = (lambda x, i, axis: torch.take_along_dim(x, i, dim=axis))(x, idx_e, axis=1)
        g = _silu(x_sel @ w_gate)
        u = x_sel @ w_up
        y = (g * u) @ w_down
        r_sel = _sigmoid((lambda x, i, axis: torch.take_along_dim(x, i, dim=axis))(r, idx, axis=1))
        y = y * r_sel.reshape(B, C, 1)
        b_off = (torch.arange(B) * S).reshape(B, 1)
        flat_idx = (idx + b_off).reshape(B * C)
        zero = (x * 0.0).reshape(B * S, D)
        upd = _scatter_add(zero, flat_idx, y.reshape(B * C, D), axis=0)
        return x + upd.reshape(B, S, D)

    x = A_x
    g = _sigmoid((x * gate_w).sum(-1, keepdims=True))
    a = _A_ref(x, A_k_cache, A_v_cache, A_wq, A_wo)
    b = _B_ref(x, B_w_r, B_w_gate, B_w_up, B_w_down)
    return g * a + (1 - g) * b
```

```asm
; @launch grid=(256,1,1) block=(512,1,1) lds=153856
.amdgcn_target "amdgcn-amd-amdhsa--gfx950"
.text
.globl gated_mix__mha_block_cached__moe_arch_mod__decode_kernel
.p2align 8
.type gated_mix__mha_block_cached__moe_arch_mod__decode_kernel,@function
gated_mix__mha_block_cached__moe_arch_mod__decode_kernel:
    s_cmp_ge_u32 s2, 256
    s_cbranch_scc1 L_done
    s_load_dwordx16 s[4:19], s[0:1], 0
    s_load_dwordx8 s[20:27], s[0:1], 64
    s_load_dwordx4 s[28:31], s[0:1], 96
    v_lshrrev_b32 v1, 6, v0
    v_and_b32 v0, 63, v0
    v_readfirstlane_b32 s3, v1
    s_and_b32 s33, s2, 7
    s_lshl_b32 s33, s33, 2
    s_lshr_b32 s32, s2, 3
    s_and_b32 s34, s32, 3
    s_add_u32 s33, s33, s34
    s_lshr_b32 s32, s32, 2
    s_mov_b32 s46, 0x05040100
    s_mov_b32 s47, 0x07060302
    s_mov_b32 s48, 0x3e0293ee
    s_xor_b32 s3, s3, 4
    s_cmp_lt_u32 s3, 4
    s_cbranch_scc0 L_stream
    v_and_b32 v2, 15, v0
    v_lshrrev_b32 v3, 4, v0
    v_lshlrev_b32 v5, 14, v3
    v_lshl_add_u32 v5, v2, 4, v5
    v_add_u32 v6, 0x2000, v5
    s_lshl_b32 s44, s3, 16
    s_lshl_b32 s35, s33, 8
    s_add_u32 s44, s44, s35
    v_lshlrev_b32 v4, 6, v2
    v_lshl_add_u32 v4, v3, 2, v4
    s_lshl_b32 s45, s3, 4
    s_lshl_b32 s35, s32, 10
    s_mov_b32 s38, 1024
    s_mov_b32 s39, 0x20000
    s_mov_b32 s42, 0x400000
    s_mov_b32 s43, 0x20000
    s_waitcnt lgkmcnt(0)
    s_add_u32 s36, s4, s35
    s_addc_u32 s37, s5, 0
    s_mov_b32 s40, s10
    s_mov_b32 s41, s11
    buffer_load_dword v16, v4, s[36:39], s45 offen
    buffer_load_dwordx4 v[56:59], v5, s[40:43], s44 offen offset:0 nt
    buffer_load_dwordx4 v[60:63], v6, s[40:43], s44 offen offset:0 nt
    s_add_u32 s44, s44, 262144
    buffer_load_dwordx4 v[64:67], v5, s[40:43], s44 offen offset:0 nt
    s_branch L_helper
L_stream:
    s_sub_u32 s3, s3, 4
    s_and_b32 s35, s3, 1
    s_lshl_b32 s35, s35, 13
    s_lshr_b32 s34, s3, 1
    s_lshl_b32 s34, s34, 10
    s_add_u32 s35, s35, s34
    v_lshlrev_b32 v1, 4, v0
    v_add_u32 v1, s35, v1
    s_lshl_b32 s34, s32, 5
    s_add_u32 s34, s34, s33
    s_lshl_b32 s35, s34, 20
    s_mov_b32 s38, 0x100000
    s_mov_b32 s39, 0x20000
    s_mov_b32 s42, 0x100000
    s_mov_b32 s43, 0x20000
    s_mov_b32 s44, 0
    s_bitcmp1_b32 s34, 0
    s_cselect_b32 s45, 131072, 0
    s_xor_b32 s44, s44, s45
    s_bitcmp1_b32 s34, 7
    s_cselect_b32 s45, 262144, 0
    s_xor_b32 s44, s44, s45
    s_and_b32 s62, s2, 7
    s_lshr_b32 s63, s2, 3
    s_lshl_b32 s63, s63, 2
    s_add_u32 s63, s63, s3
    v_lshlrev_b32 v2, 4, v0
    s_mov_b32 s66, 0x400000
    s_mov_b32 s67, 0x20000
    s_mov_b32 s70, 0x400000
    s_mov_b32 s71, 0x20000
    s_lshl_b32 s45, s63, 15
    s_lshl_b32 s57, s62, 10
    s_add_u32 s45, s45, s57
    s_lshl_b32 s84, s62, 19
    s_lshl_b32 s57, s63, 12
    s_add_u32 s84, s84, s57
    s_waitcnt lgkmcnt(0)
    s_mov_b32 s64, s10
    s_mov_b32 s65, s11
    buffer_load_dwordx4 v[176:179], v2, s[64:67], s45 offen offset:0
    s_add_u32 s45, s45, 8192
    buffer_load_dwordx4 v[180:183], v2, s[64:67], s45 offen offset:0
    s_add_u32 s45, s45, 8192
    buffer_load_dwordx4 v[184:187], v2, s[64:67], s45 offen offset:0
    s_add_u32 s45, s45, 8192
    buffer_load_dwordx4 v[188:191], v2, s[64:67], s45 offen offset:0
    s_mov_b32 s68, s12
    s_mov_b32 s69, s13
    buffer_load_dwordx4 v[192:195], v2, s[68:71], s84 offen offset:0
    s_add_u32 s36, s6, s35
    s_addc_u32 s37, s7, 0
    s_add_u32 s40, s8, s35
    s_addc_u32 s41, s9, 0
    s_mov_b64 exec, 1
    s_cmp_lg_u32 s3, 0
    s_cbranch_scc1 L_t1
    buffer_load_dword v240, v1, s[36:39], s44 offen nt
L_t1:
    s_cmp_lg_u32 s3, 1
    s_cbranch_scc1 L_t2
    buffer_load_dword v240, v1, s[40:43], s44 offen nt
L_t2:
    s_mov_b64 exec, -1
    s_cmp_lt_u32 s62, 7
    s_cselect_b32 s74, 0x1c0000, 0
    s_mov_b32 s75, 0x20000
    s_mov_b32 s72, s18
    s_mov_b32 s73, s19
    s_mov_b32 s78, s74
    s_mov_b32 s79, 0x20000
    s_mov_b32 s76, s20
    s_mov_b32 s77, s21
    s_mov_b32 s82, 0x1c0000
    s_mov_b32 s83, 0x20000
    s_mov_b32 s80, s22
    s_mov_b32 s81, s23
    v_lshrrev_b32 v3, 5, v0
    v_mul_u32_u24 v3, 3584, v3
    v_and_b32 v4, 31, v0
    v_lshl_add_u32 v3, v4, 4, v3
    s_mul_i32 s45, s63, 14336
    s_lshl_b32 s57, s62, 9
    s_add_u32 s45, s45, s57
    s_add_u32 s57, s45, 7168
    buffer_load_dwordx4 v[196:199], v2, s[68:71], s84 offen offset:1024
    s_waitcnt vmcnt(5)
    buffer_load_dwordx4 v[200:203], v2, s[68:71], s84 offen offset:2048
    s_waitcnt vmcnt(5)
    buffer_load_dwordx4 v[204:207], v2, s[68:71], s84 offen offset:3072
    s_waitcnt vmcnt(5)
    buffer_load_dwordx4 v[208:211], v3, s[72:75], s45 offen offset:0
    s_waitcnt vmcnt(5)
    buffer_load_dwordx4 v[212:215], v3, s[72:75], s57 offen offset:0
    s_waitcnt vmcnt(5)
    buffer_load_dwordx4 v[216:219], v3, s[76:79], s45 offen offset:0
    s_waitcnt vmcnt(5)
    buffer_load_dwordx4 v[220:223], v3, s[76:79], s57 offen offset:0
    s_lshl_b32 s45, s62, 18
    s_lshl_b32 s57, s63, 11
    s_add_u32 s45, s45, s57
    s_waitcnt vmcnt(5)
    buffer_load_dwordx4 v[224:227], v2, s[80:83], s45 offen offset:0
    s_waitcnt vmcnt(5)
    buffer_load_dwordx4 v[228:231], v2, s[80:83], s45 offen offset:1024
    s_waitcnt vmcnt(4)
    buffer_load_dwordx4 v[48:51], v1, s[36:39], s44 offen offset:0 nt
    s_waitcnt vmcnt(4)
    buffer_load_dwordx4 v[52:55], v1, s[36:39], s44 offen offset:2048 nt
    s_add_u32 s44, s44, 4096
    s_waitcnt vmcnt(4)
    buffer_load_dwordx4 v[56:59], v1, s[36:39], s44 offen offset:0 nt
    s_waitcnt vmcnt(4)
    buffer_load_dwordx4 v[60:63], v1, s[36:39], s44 offen offset:2048 nt
    s_add_u32 s44, s44, 12288
    s_waitcnt vmcnt(4)
    buffer_load_dwordx4 v[64:67], v1, s[36:39], s44 offen offset:0 nt
    v_mov_b32 v30, 0xff800000
    v_mov_b32 v8, 0
    v_mov_b32 v9, 0
    v_mov_b32 v10, 0
    v_mov_b32 v11, 0
    v_mov_b32 v12, 0
    v_mov_b32 v13, 0
    v_mov_b32 v14, 0
    v_mov_b32 v15, 0
    s_add_u32 s40, s8, s35
    s_addc_u32 s41, s9, 0
    s_mul_i32 s54, s3, 32768
    s_add_u32 s54, s54, 22784
    v_and_b32 v2, 15, v0
    v_lshlrev_b32 v2, 5, v2
    s_getreg_b32 s49, hwreg(HW_REG_XCC_ID)
    s_and_b32 s49, s49, 1
    s_lshl_b32 s35, s32, 5
    s_add_u32 s52, s28, s35
    s_addc_u32 s53, s29, 0
    s_mov_b32 s58, 0xaaaaaaaa
    s_mov_b32 s59, 0xaaaaaaaa
    s_mov_b32 s60, 0xcccccccc
    s_mov_b32 s61, 0xcccccccc
    v_lshlrev_b32 v3, 4, v0
    v_add_u32 v3, s54, v3
    s_mov_b32 s55, 0
    s_cmp_eq_u32 s49, 0
    s_cselect_b32 s57, 4, 0
    s_add_u32 s55, s55, s57
    s_lshr_b32 s57, s10, 8
    s_add_u32 s57, s57, s33
    s_and_b32 s57, s57, 3
    s_cmp_eq_u32 s57, 1
    s_cselect_b32 s57, 1, 0
    s_add_u32 s55, s55, s57
    s_lshr_b32 s57, s18, 7
    s_add_u32 s57, s57, s33
    s_and_b32 s57, s57, 3
    s_cmp_eq_u32 s57, 3
    s_cselect_b32 s57, 2, 0
    s_cmp_lt_u32 s33, 28
    s_cselect_b32 s57, s57, 0
    s_add_i32 s55, s55, s57
    s_getreg_b32 s57, hwreg(HW_REG_HW_ID, 8, 4)
    s_mul_i32 s57, s57, 1
    s_lshr_b32 s57, s57, 3
    s_add_i32 s55, s55, s57
    s_max_i32 s55, s55, 0
    s_lshr_b32 s56, s2, 3
    s_and_b32 s56, s56, 7
    s_waitcnt vmcnt(4)
    buffer_load_dwordx4 v[68:71], v1, s[36:39], s44 offen offset:2048 nt
    s_add_u32 s44, s44, 4096
    s_waitcnt vmcnt(4)
    buffer_load_dwordx4 v[72:75], v1, s[36:39], s44 offen offset:0 nt
    s_waitcnt vmcnt(4)
    buffer_load_dwordx4 v[76:79], v1, s[36:39], s44 offen offset:2048 nt
    s_add_u32 s44, s44, 12288
    s_and_b32 s44, s44, 0xfffff
    s_waitcnt vmcnt(4)
    buffer_load_dwordx4 v[80:83], v1, s[36:39], s44 offen offset:0 nt
    s_waitcnt vmcnt(4)
    buffer_load_dwordx4 v[84:87], v1, s[36:39], s44 offen offset:2048 nt
    s_add_u32 s44, s44, 4096
    s_waitcnt vmcnt(4)
    buffer_load_dwordx4 v[88:91], v1, s[36:39], s44 offen offset:0 nt
    s_waitcnt vmcnt(4)
    buffer_load_dwordx4 v[92:95], v1, s[36:39], s44 offen offset:2048 nt
    s_add_u32 s44, s44, 12288
    s_waitcnt vmcnt(4)
    buffer_load_dwordx4 v[96:99], v1, s[36:39], s44 offen offset:0 nt
    s_waitcnt vmcnt(4)
    buffer_load_dwordx4 v[100:103], v1, s[36:39], s44 offen offset:2048 nt
    s_add_u32 s44, s44, 4096
    s_waitcnt vmcnt(4)
    buffer_load_dwordx4 v[104:107], v1, s[36:39], s44 offen offset:0 nt
    s_waitcnt vmcnt(4)
    buffer_load_dwordx4 v[108:111], v1, s[36:39], s44 offen offset:2048 nt
    s_add_u32 s44, s44, 12288
    s_and_b32 s44, s44, 0xfffff
    s_waitcnt vmcnt(4)
    buffer_load_dwordx4 v[112:115], v1, s[36:39], s44 offen offset:0 nt
    s_waitcnt vmcnt(4)
    buffer_load_dwordx4 v[116:119], v1, s[36:39], s44 offen offset:2048 nt
    s_add_u32 s44, s44, 4096
    s_waitcnt vmcnt(4)
    buffer_load_dwordx4 v[120:123], v1, s[36:39], s44 offen offset:0 nt
    s_waitcnt vmcnt(4)
    buffer_load_dwordx4 v[124:127], v1, s[36:39], s44 offen offset:2048 nt
    s_add_u32 s44, s44, 12288
    s_waitcnt vmcnt(4)
    buffer_load_dwordx4 v[128:131], v1, s[36:39], s44 offen offset:0 nt
    s_waitcnt vmcnt(4)
    buffer_load_dwordx4 v[132:135], v1, s[36:39], s44 offen offset:2048 nt
    s_add_u32 s44, s44, 4096
    s_waitcnt vmcnt(4)
    buffer_load_dwordx4 v[136:139], v1, s[36:39], s44 offen offset:0 nt
    s_waitcnt vmcnt(4)
    buffer_load_dwordx4 v[140:143], v1, s[36:39], s44 offen offset:2048 nt
    s_add_u32 s44, s44, 12288
    s_and_b32 s44, s44, 0xfffff
    s_waitcnt vmcnt(4)
    buffer_load_dwordx4 v[144:147], v1, s[36:39], s44 offen offset:0 nt
    s_waitcnt vmcnt(4)
    buffer_load_dwordx4 v[148:151], v1, s[36:39], s44 offen offset:2048 nt
    s_add_u32 s44, s44, 4096
    s_waitcnt vmcnt(4)
    buffer_load_dwordx4 v[152:155], v1, s[36:39], s44 offen offset:0 nt
    s_waitcnt vmcnt(4)
    buffer_load_dwordx4 v[156:159], v1, s[36:39], s44 offen offset:2048 nt
    s_add_u32 s44, s44, 12288
    s_waitcnt vmcnt(4)
    buffer_load_dwordx4 v[160:163], v1, s[36:39], s44 offen offset:0 nt
    s_waitcnt vmcnt(4)
    buffer_load_dwordx4 v[164:167], v1, s[36:39], s44 offen offset:2048 nt
    s_add_u32 s44, s44, 4096
    s_waitcnt vmcnt(4)
    buffer_load_dwordx4 v[168:171], v1, s[36:39], s44 offen offset:0 nt
    s_waitcnt vmcnt(4)
    buffer_load_dwordx4 v[172:175], v1, s[36:39], s44 offen offset:2048 nt
    s_add_u32 s44, s44, 12288
    s_and_b32 s44, s44, 0xfffff
    s_waitcnt vmcnt(4)
    buffer_load_dwordx4 v[176:179], v1, s[36:39], s44 offen offset:0 nt
    s_waitcnt vmcnt(4)
    buffer_load_dwordx4 v[180:183], v1, s[36:39], s44 offen offset:2048 nt
    s_add_u32 s44, s44, 4096
    s_waitcnt vmcnt(4)
    buffer_load_dwordx4 v[184:187], v1, s[36:39], s44 offen offset:0 nt
    s_waitcnt vmcnt(4)
    buffer_load_dwordx4 v[188:191], v1, s[36:39], s44 offen offset:2048 nt
    s_add_u32 s44, s44, 12288
    s_waitcnt vmcnt(4)
    buffer_load_dwordx4 v[192:195], v1, s[36:39], s44 offen offset:0 nt
    s_waitcnt vmcnt(4)
    buffer_load_dwordx4 v[196:199], v1, s[36:39], s44 offen offset:2048 nt
    s_add_u32 s44, s44, 4096
    s_waitcnt vmcnt(4)
    buffer_load_dwordx4 v[200:203], v1, s[36:39], s44 offen offset:0 nt
    s_waitcnt vmcnt(4)
    buffer_load_dwordx4 v[204:207], v1, s[36:39], s44 offen offset:2048 nt
    s_add_u32 s44, s44, 12288
    s_and_b32 s44, s44, 0xfffff
    s_add_u32 m0, s54, 0
    s_waitcnt vmcnt(4)
    buffer_load_dwordx4 v1, s[36:39], s44 offen offset:0 nt lds
    s_add_u32 m0, s54, -1024
    s_waitcnt vmcnt(4)
    buffer_load_dwordx4 v1, s[36:39], s44 offen offset:2048 nt lds
    s_add_u32 s44, s44, 4096
    s_add_u32 m0, s54, 2048
    s_waitcnt vmcnt(4)
    buffer_load_dwordx4 v1, s[36:39], s44 offen offset:0 nt lds
    s_add_u32 m0, s54, 1024
    s_waitcnt vmcnt(4)
    buffer_load_dwordx4 v1, s[36:39], s44 offen offset:2048 nt lds
    s_add_u32 s44, s44, 12288
    s_add_u32 m0, s54, 4096
    s_waitcnt vmcnt(4)
    buffer_load_dwordx4 v1, s[36:39], s44 offen offset:0 nt lds
    s_add_u32 m0, s54, 3072
    s_waitcnt vmcnt(4)
    buffer_load_dwordx4 v1, s[36:39], s44 offen offset:2048 nt lds
    s_add_u32 s44, s44, 4096
    s_add_u32 m0, s54, 6144
    s_waitcnt vmcnt(4)
    buffer_load_dwordx4 v1, s[36:39], s44 offen offset:0 nt lds
    s_add_u32 m0, s54, 5120
    s_waitcnt vmcnt(4)
    buffer_load_dwordx4 v1, s[36:39], s44 offen offset:2048 nt lds
    s_add_u32 s44, s44, 12288
    s_and_b32 s44, s44, 0xfffff
    s_add_u32 m0, s54, 8192
    s_waitcnt vmcnt(4)
    buffer_load_dwordx4 v1, s[36:39], s44 offen offset:0 nt lds
    s_add_u32 m0, s54, 7168
    s_waitcnt vmcnt(4)
    buffer_load_dwordx4 v1, s[36:39], s44 offen offset:2048 nt lds
    s_add_u32 s44, s44, 4096
    s_add_u32 m0, s54, 10240
    s_waitcnt vmcnt(4)
    buffer_load_dwordx4 v1, s[36:39], s44 offen offset:0 nt lds
    s_add_u32 m0, s54, 9216
    s_waitcnt vmcnt(4)
    buffer_load_dwordx4 v1, s[36:39], s44 offen offset:2048 nt lds
    s_add_u32 s44, s44, 12288
    s_add_u32 m0, s54, 12288
    s_waitcnt vmcnt(4)
    buffer_load_dwordx4 v1, s[36:39], s44 offen offset:0 nt lds
    s_add_u32 m0, s54, 11264
    s_waitcnt vmcnt(4)
    buffer_load_dwordx4 v1, s[36:39], s44 offen offset:2048 nt lds
    s_add_u32 s44, s44, 4096
    s_add_u32 m0, s54, 14336
    s_waitcnt vmcnt(4)
    buffer_load_dwordx4 v1, s[36:39], s44 offen offset:0 nt lds
    s_add_u32 m0, s54, 13312
    s_waitcnt vmcnt(4)
    buffer_load_dwordx4 v1, s[36:39], s44 offen offset:2048 nt lds
    s_add_u32 s44, s44, 12288
    s_and_b32 s44, s44, 0xfffff
    s_add_u32 m0, s54, 16384
    s_waitcnt vmcnt(4)
    buffer_load_dwordx4 v1, s[36:39], s44 offen offset:0 nt lds
    s_add_u32 m0, s54, 15360
    s_waitcnt vmcnt(4)
    buffer_load_dwordx4 v1, s[36:39], s44 offen offset:2048 nt lds
    s_add_u32 s44, s44, 4096
    s_add_u32 m0, s54, 18432
    s_waitcnt vmcnt(4)
    buffer_load_dwordx4 v1, s[36:39], s44 offen offset:0 nt lds
    s_add_u32 m0, s54, 17408
    s_waitcnt vmcnt(4)
    buffer_load_dwordx4 v1, s[36:39], s44 offen offset:2048 nt lds
    s_add_u32 s44, s44, 12288
    s_add_u32 m0, s54, 20480
    s_waitcnt vmcnt(4)
    buffer_load_dwordx4 v1, s[36:39], s44 offen offset:0 nt lds
    s_add_u32 m0, s54, 19456
    s_waitcnt vmcnt(4)
    buffer_load_dwordx4 v1, s[36:39], s44 offen offset:2048 nt lds
    s_add_u32 s44, s44, 4096
    s_add_u32 m0, s54, 22528
    s_waitcnt vmcnt(4)
    buffer_load_dwordx4 v1, s[36:39], s44 offen offset:0 nt lds
    s_add_u32 m0, s54, 21504
    s_waitcnt vmcnt(4)
    buffer_load_dwordx4 v1, s[36:39], s44 offen offset:2048 nt lds
    s_add_u32 s44, s44, 12288
    s_and_b32 s44, s44, 0xfffff
    s_add_u32 m0, s54, 24576
    s_waitcnt vmcnt(4)
    buffer_load_dwordx4 v1, s[36:39], s44 offen offset:0 nt lds
    s_add_u32 m0, s54, 23552
    s_waitcnt vmcnt(4)
    buffer_load_dwordx4 v1, s[36:39], s44 offen offset:2048 nt lds
    s_add_u32 s44, s44, 4096
    s_add_u32 m0, s54, 26624
    s_waitcnt vmcnt(4)
    buffer_load_dwordx4 v1, s[36:39], s44 offen offset:0 nt lds
    s_add_u32 m0, s54, 25600
    s_waitcnt vmcnt(4)
    buffer_load_dwordx4 v1, s[36:39], s44 offen offset:2048 nt lds
    s_add_u32 s44, s44, 12288
    s_add_u32 m0, s54, 28672
    s_waitcnt vmcnt(4)
    buffer_load_dwordx4 v1, s[36:39], s44 offen offset:0 nt lds
    s_add_u32 m0, s54, 27648
    s_waitcnt vmcnt(4)
    buffer_load_dwordx4 v1, s[36:39], s44 offen offset:2048 nt lds
    s_add_u32 s44, s44, 4096
    s_add_u32 m0, s54, 30720
    s_waitcnt vmcnt(4)
    buffer_load_dwordx4 v1, s[36:39], s44 offen offset:0 nt lds
    s_add_u32 m0, s54, 29696
    s_waitcnt vmcnt(4)
    buffer_load_dwordx4 v1, s[36:39], s44 offen offset:2048 nt lds
    s_add_u32 s44, s44, 12288
    s_and_b32 s44, s44, 0xfffff
    s_barrier
    ds_read_b128 v[32:35], v2 offset:0
    ds_read_b128 v[36:39], v2 offset:16
    ds_read_b128 v[40:43], v2 offset:512
    ds_read_b128 v[44:47], v2 offset:528
    ds_read_b128 v[240:243], v2 offset:1024
    ds_read_b128 v[244:247], v2 offset:1040
    ds_read_b128 v[248:251], v2 offset:1536
    ds_read_b128 v[252:255], v2 offset:1552
    s_waitcnt vmcnt(4)
    buffer_load_dwordx4 v[208:211], v1, s[36:39], s44 offen offset:0 nt
    s_waitcnt lgkmcnt(0)
    v_pk_add_f32 v[32:33], v[32:33], v[40:41]
    v_pk_add_f32 v[34:35], v[34:35], v[42:43]
    v_pk_add_f32 v[36:37], v[36:37], v[44:45]
    v_pk_add_f32 v[38:39], v[38:39], v[46:47]
    v_pk_add_f32 v[240:241], v[240:241], v[248:249]
    v_pk_add_f32 v[242:243], v[242:243], v[250:251]
    v_pk_add_f32 v[244:245], v[244:245], v[252:253]
    v_pk_add_f32 v[246:247], v[246:247], v[254:255]
    v_pk_add_f32 v[32:33], v[32:33], v[240:241]
    v_pk_add_f32 v[34:35], v[34:35], v[242:243]
    v_pk_add_f32 v[36:37], v[36:37], v[244:245]
    v_pk_add_f32 v[38:39], v[38:39], v[246:247]
    v_cvt_pk_bf16_f32 v4, v32, v33
    v_cvt_pk_bf16_f32 v5, v34, v35
    v_cvt_pk_bf16_f32 v6, v36, v37
    s_waitcnt vmcnt(4)
    buffer_load_dwordx4 v[212:215], v1, s[36:39], s44 offen offset:2048 nt
    s_add_u32 s44, s44, 4096
    v_cvt_pk_bf16_f32 v7, v38, v39
    s_lshl_b32 s35, s3, 12
    s_add_u32 s35, s35, 6400
    v_lshl_add_u32 v2, v0, 3, s35
    v_dot2_f32_bf16 v16, v48, v4, 0
    v_dot2_f32_bf16 v17, v52, v4, 0
    v_dot2_f32_bf16 v18, v56, v4, 0
    v_dot2_f32_bf16 v19, v60, v4, 0
    v_dot2c_f32_bf16 v16, v49, v5
    v_dot2c_f32_bf16 v17, v53, v5
    v_dot2c_f32_bf16 v18, v57, v5
    v_dot2c_f32_bf16 v19, v61, v5
    v_dot2c_f32_bf16 v16, v50, v6
    v_dot2c_f32_bf16 v17, v54, v6
    v_dot2c_f32_bf16 v18, v58, v6
    s_waitcnt vmcnt(4)
    buffer_load_dwordx4 v[216:219], v1, s[36:39], s44 offen offset:0 nt
    v_dot2c_f32_bf16 v19, v62, v6
    v_dot2c_f32_bf16 v16, v51, v7
    v_dot2c_f32_bf16 v17, v55, v7
    v_dot2c_f32_bf16 v18, v59, v7
    v_dot2c_f32_bf16 v19, v63, v7
    v_add_f32_dpp v16, v16, v16 row_ror:8 row_mask:0xf bank_mask:0x3
    v_add_f32_dpp v17, v17, v17 row_ror:8 row_mask:0xf bank_mask:0x3
    v_add_f32_dpp v16, v18, v18 row_ror:8 row_mask:0xf bank_mask:0xc
    v_add_f32_dpp v17, v19, v19 row_ror:8 row_mask:0xf bank_mask:0xc
    v_dot2_f32_bf16 v20, v64, v4, 0
    v_dot2_f32_bf16 v21, v68, v4, 0
    v_dot2_f32_bf16 v22, v72, v4, 0
    v_dot2_f32_bf16 v23, v76, v4, 0
    v_dot2c_f32_bf16 v20, v65, v5
    v_dot2c_f32_bf16 v21, v69, v5
    s_waitcnt vmcnt(4)
    buffer_load_dwordx4 v[220:223], v1, s[36:39], s44 offen offset:2048 nt
    s_add_u32 s44, s44, 12288
    v_dot2c_f32_bf16 v22, v73, v5
    v_dot2c_f32_bf16 v23, v77, v5
    v_dot2c_f32_bf16 v20, v66, v6
    v_dot2c_f32_bf16 v21, v70, v6
    v_dot2c_f32_bf16 v22, v74, v6
    v_dot2c_f32_bf16 v23, v78, v6
    v_dot2c_f32_bf16 v20, v67, v7
    v_dot2c_f32_bf16 v21, v71, v7
    v_dot2c_f32_bf16 v22, v75, v7
    v_dot2c_f32_bf16 v23, v79, v7
    v_add_f32_dpp v20, v20, v20 row_ror:8 row_mask:0xf bank_mask:0x3
    v_add_f32_dpp v21, v21, v21 row_ror:8 row_mask:0xf bank_mask:0x3
    v_add_f32_dpp v20, v22, v22 row_ror:8 row_mask:0xf bank_mask:0xc
    v_add_f32_dpp v21, v23, v23 row_ror:8 row_mask:0xf bank_mask:0xc
    v_add_f32_dpp v24, v16, v16 row_half_mirror row_mask:0xf bank_mask:0x5
    v_add_f32_dpp v25, v17, v17 row_half_mirror row_mask:0xf bank_mask:0x5
    s_waitcnt vmcnt(4)
    buffer_load_dwordx4 v[224:227], v1, s[36:39], s44 offen offset:0 nt
    v_add_f32_dpp v24, v20, v20 row_half_mirror row_mask:0xf bank_mask:0xa
    v_add_f32_dpp v25, v21, v21 row_half_mirror row_mask:0xf bank_mask:0xa
    v_dot2_f32_bf16 v16, v80, v4, 0
    v_dot2_f32_bf16 v17, v84, v4, 0
    v_dot2_f32_bf16 v18, v88, v4, 0
    v_dot2_f32_bf16 v19, v92, v4, 0
    v_dot2c_f32_bf16 v16, v81, v5
    v_dot2c_f32_bf16 v17, v85, v5
    v_dot2c_f32_bf16 v18, v89, v5
    v_dot2c_f32_bf16 v19, v93, v5
    v_dot2c_f32_bf16 v16, v82, v6
    v_dot2c_f32_bf16 v17, v86, v6
    v_dot2c_f32_bf16 v18, v90, v6
    v_dot2c_f32_bf16 v19, v94, v6
    v_dot2c_f32_bf16 v16, v83, v7
    s_waitcnt vmcnt(4)
    buffer_load_dwordx4 v[228:231], v1, s[36:39], s44 offen offset:2048 nt
    s_add_u32 s44, s44, 4096
    v_dot2c_f32_bf16 v17, v87, v7
    v_dot2c_f32_bf16 v18, v91, v7
    v_dot2c_f32_bf16 v19, v95, v7
    v_add_f32_dpp v16, v16, v16 row_ror:8 row_mask:0xf bank_mask:0x3
    v_add_f32_dpp v17, v17, v17 row_ror:8 row_mask:0xf bank_mask:0x3
    v_add_f32_dpp v16, v18, v18 row_ror:8 row_mask:0xf bank_mask:0xc
    v_add_f32_dpp v17, v19, v19 row_ror:8 row_mask:0xf bank_mask:0xc
    v_dot2_f32_bf16 v20, v96, v4, 0
    v_dot2_f32_bf16 v21, v100, v4, 0
    v_dot2_f32_bf16 v22, v104, v4, 0
    v_dot2_f32_bf16 v23, v108, v4, 0
    v_dot2c_f32_bf16 v20, v97, v5
    v_dot2c_f32_bf16 v21, v101, v5
    v_dot2c_f32_bf16 v22, v105, v5
    v_dot2c_f32_bf16 v23, v109, v5
    s_waitcnt vmcnt(4)
    buffer_load_dwordx4 v[232:235], v1, s[36:39], s44 offen offset:0 nt
    v_dot2c_f32_bf16 v20, v98, v6
    v_dot2c_f32_bf16 v21, v102, v6
    v_dot2c_f32_bf16 v22, v106, v6
    v_dot2c_f32_bf16 v23, v110, v6
    v_dot2c_f32_bf16 v20, v99, v7
    v_dot2c_f32_bf16 v21, v103, v7
    v_dot2c_f32_bf16 v22, v107, v7
    v_dot2c_f32_bf16 v23, v111, v7
    v_add_f32_dpp v20, v20, v20 row_ror:8 row_mask:0xf bank_mask:0x3
    v_add_f32_dpp v21, v21, v21 row_ror:8 row_mask:0xf bank_mask:0x3
    v_add_f32_dpp v20, v22, v22 row_ror:8 row_mask:0xf bank_mask:0xc
    v_add_f32_dpp v21, v23, v23 row_ror:8 row_mask:0xf bank_mask:0xc
    v_add_f32_dpp v18, v16, v16 row_half_mirror row_mask:0xf bank_mask:0x5
    v_add_f32_dpp v19, v17, v17 row_half_mirror row_mask:0xf bank_mask:0x5
    v_add_f32_dpp v18, v20, v20 row_half_mirror row_mask:0xf bank_mask:0xa
    v_add_f32_dpp v19, v21, v21 row_half_mirror row_mask:0xf bank_mask:0xa
    s_waitcnt vmcnt(4)
    buffer_load_dwordx4 v[236:239], v1, s[36:39], s44 offen offset:2048 nt
    s_add_u32 s44, s44, 12288
    s_and_b32 s44, s44, 0xfffff
    v_cndmask_b32 v32, v24, v18, s[58:59]
    v_cndmask_b32 v33, v18, v24, s[58:59]
    v_cndmask_b32 v34, v25, v19, s[58:59]
    v_cndmask_b32 v35, v19, v25, s[58:59]
    v_add_f32_dpp v26, v33, v32 quad_perm:[1,0,3,2] row_mask:0xf bank_mask:0xf
    s_nop 0
    v_add_f32_dpp v27, v35, v34 quad_perm:[1,0,3,2] row_mask:0xf bank_mask:0xf
    ds_read_b128 v[80:83], v3 offset:0
    ds_read_b128 v[84:87], v3 offset:1024
    ds_read_b128 v[88:91], v3 offset:2048
    ds_read_b128 v[92:95], v3 offset:3072
    ds_read_b128 v[96:99], v3 offset:4096
    ds_read_b128 v[100:103], v3 offset:5120
    ds_read_b128 v[104:107], v3 offset:6144
    ds_read_b128 v[108:111], v3 offset:7168
    s_waitcnt vmcnt(4)
    buffer_load_dwordx4 v[48:51], v1, s[36:39], s44 offen offset:0 nt
    v_dot2_f32_bf16 v16, v112, v4, 0
    v_dot2_f32_bf16 v17, v116, v4, 0
    v_dot2_f32_bf16 v18, v120, v4, 0
    v_dot2_f32_bf16 v19, v124, v4, 0
    v_dot2c_f32_bf16 v16, v113, v5
    v_dot2c_f32_bf16 v17, v117, v5
    v_dot2c_f32_bf16 v18, v121, v5
    v_dot2c_f32_bf16 v19, v125, v5
    v_dot2c_f32_bf16 v16, v114, v6
    v_dot2c_f32_bf16 v17, v118, v6
    v_dot2c_f32_bf16 v18, v122, v6
    v_dot2c_f32_bf16 v19, v126, v6
    v_dot2c_f32_bf16 v16, v115, v7
    v_dot2c_f32_bf16 v17, v119, v7
    s_waitcnt vmcnt(4)
    buffer_load_dwordx4 v[52:55], v1, s[36:39], s44 offen offset:2048 nt
    s_add_u32 s44, s44, 4096
    v_dot2c_f32_bf16 v18, v123, v7
    v_dot2c_f32_bf16 v19, v127, v7
    v_add_f32_dpp v16, v16, v16 row_ror:8 row_mask:0xf bank_mask:0x3
    v_add_f32_dpp v17, v17, v17 row_ror:8 row_mask:0xf bank_mask:0x3
    v_add_f32_dpp v16, v18, v18 row_ror:8 row_mask:0xf bank_mask:0xc
    v_add_f32_dpp v17, v19, v19 row_ror:8 row_mask:0xf bank_mask:0xc
    v_dot2_f32_bf16 v20, v128, v4, 0
    v_dot2_f32_bf16 v21, v132, v4, 0
    v_dot2_f32_bf16 v22, v136, v4, 0
    v_dot2_f32_bf16 v23, v140, v4, 0
    v_dot2c_f32_bf16 v20, v129, v5
    v_dot2c_f32_bf16 v21, v133, v5
    v_dot2c_f32_bf16 v22, v137, v5
    v_dot2c_f32_bf16 v23, v141, v5
    s_waitcnt vmcnt(4)
    buffer_load_dwordx4 v[56:59], v1, s[36:39], s44 offen offset:0 nt
    v_dot2c_f32_bf16 v20, v130, v6
    v_dot2c_f32_bf16 v21, v134, v6
    v_dot2c_f32_bf16 v22, v138, v6
    v_dot2c_f32_bf16 v23, v142, v6
    v_dot2c_f32_bf16 v20, v131, v7
    v_dot2c_f32_bf16 v21, v135, v7
    v_dot2c_f32_bf16 v22, v139, v7
    v_dot2c_f32_bf16 v23, v143, v7
    v_add_f32_dpp v20, v20, v20 row_ror:8 row_mask:0xf bank_mask:0x3
    v_add_f32_dpp v21, v21, v21 row_ror:8 row_mask:0xf bank_mask:0x3
    v_add_f32_dpp v20, v22, v22 row_ror:8 row_mask:0xf bank_mask:0xc
    v_add_f32_dpp v21, v23, v23 row_ror:8 row_mask:0xf bank_mask:0xc
    v_add_f32_dpp v24, v16, v16 row_half_mirror row_mask:0xf bank_mask:0x5
    v_add_f32_dpp v25, v17, v17 row_half_mirror row_mask:0xf bank_mask:0x5
    v_add_f32_dpp v24, v20, v20 row_half_mirror row_mask:0xf bank_mask:0xa
    s_waitcnt vmcnt(4)
    buffer_load_dwordx4 v[60:63], v1, s[36:39], s44 offen offset:2048 nt
    s_add_u32 s44, s44, 12288
    v_add_f32_dpp v25, v21, v21 row_half_mirror row_mask:0xf bank_mask:0xa
    v_dot2_f32_bf16 v16, v144, v4, 0
    v_dot2_f32_bf16 v17, v148, v4, 0
    v_dot2_f32_bf16 v18, v152, v4, 0
    v_dot2_f32_bf16 v19, v156, v4, 0
    v_dot2c_f32_bf16 v16, v145, v5
    v_dot2c_f32_bf16 v17, v149, v5
    v_dot2c_f32_bf16 v18, v153, v5
    v_dot2c_f32_bf16 v19, v157, v5
    v_dot2c_f32_bf16 v16, v146, v6
    v_dot2c_f32_bf16 v17, v150, v6
    v_dot2c_f32_bf16 v18, v154, v6
    v_dot2c_f32_bf16 v19, v158, v6
    v_dot2c_f32_bf16 v16, v147, v7
    s_waitcnt vmcnt(4)
    buffer_load_dwordx4 v[64:67], v1, s[36:39], s44 offen offset:0 nt
    v_dot2c_f32_bf16 v17, v151, v7
    v_dot2c_f32_bf16 v18, v155, v7
    v_dot2c_f32_bf16 v19, v159, v7
    v_add_f32_dpp v16, v16, v16 row_ror:8 row_mask:0xf bank_mask:0x3
    v_add_f32_dpp v17, v17, v17 row_ror:8 row_mask:0xf bank_mask:0x3
    v_add_f32_dpp v16, v18, v18 row_ror:8 row_mask:0xf bank_mask:0xc
    v_add_f32_dpp v17, v19, v19 row_ror:8 row_mask:0xf bank_mask:0xc
    v_dot2_f32_bf16 v20, v160, v4, 0
    v_dot2_f32_bf16 v21, v164, v4, 0
    v_dot2_f32_bf16 v22, v168, v4, 0
    v_dot2_f32_bf16 v23, v172, v4, 0
    v_dot2c_f32_bf16 v20, v161, v5
    v_dot2c_f32_bf16 v21, v165, v5
    s_waitcnt vmcnt(4)
    buffer_load_dwordx4 v[68:71], v1, s[36:39], s44 offen offset:2048 nt
    s_add_u32 s44, s44, 4096
    v_dot2c_f32_bf16 v22, v169, v5
    v_dot2c_f32_bf16 v23, v173, v5
    v_dot2c_f32_bf16 v20, v162, v6
    v_dot2c_f32_bf16 v21, v166, v6
    v_dot2c_f32_bf16 v22, v170, v6
    v_dot2c_f32_bf16 v23, v174, v6
    v_dot2c_f32_bf16 v20, v163, v7
    v_dot2c_f32_bf16 v21, v167, v7
    v_dot2c_f32_bf16 v22, v171, v7
    v_dot2c_f32_bf16 v23, v175, v7
    v_add_f32_dpp v20, v20, v20 row_ror:8 row_mask:0xf bank_mask:0x3
    v_add_f32_dpp v21, v21, v21 row_ror:8 row_mask:0xf bank_mask:0x3
    v_add_f32_dpp v20, v22, v22 row_ror:8 row_mask:0xf bank_mask:0xc
    v_add_f32_dpp v21, v23, v23 row_ror:8 row_mask:0xf bank_mask:0xc
    s_waitcnt vmcnt(4)
    buffer_load_dwordx4 v[72:75], v1, s[36:39], s44 offen offset:0 nt
    v_add_f32_dpp v18, v16, v16 row_half_mirror row_mask:0xf bank_mask:0x5
    v_add_f32_dpp v19, v17, v17 row_half_mirror row_mask:0xf bank_mask:0x5
    v_add_f32_dpp v18, v20, v20 row_half_mirror row_mask:0xf bank_mask:0xa
    v_add_f32_dpp v19, v21, v21 row_half_mirror row_mask:0xf bank_mask:0xa
    v_cndmask_b32 v32, v24, v18, s[58:59]
    v_cndmask_b32 v33, v18, v24, s[58:59]
    v_cndmask_b32 v34, v25, v19, s[58:59]
    v_cndmask_b32 v35, v19, v25, s[58:59]
    v_add_f32_dpp v22, v33, v32 quad_perm:[1,0,3,2] row_mask:0xf bank_mask:0xf
    s_nop 0
    v_add_f32_dpp v23, v35, v34 quad_perm:[1,0,3,2] row_mask:0xf bank_mask:0xf
    v_cndmask_b32 v32, v26, v22, s[60:61]
    v_cndmask_b32 v33, v22, v26, s[60:61]
    v_cndmask_b32 v34, v27, v23, s[60:61]
    v_cndmask_b32 v35, v23, v27, s[60:61]
    s_waitcnt vmcnt(4)
    buffer_load_dwordx4 v[76:79], v1, s[36:39], s44 offen offset:2048 nt
    s_add_u32 s44, s44, 12288
    s_and_b32 s44, s44, 0xfffff
    v_add_f32_dpp v28, v33, v32 quad_perm:[2,3,0,1] row_mask:0xf bank_mask:0xf
    v_add_f32_dpp v29, v35, v34 quad_perm:[2,3,0,1] row_mask:0xf bank_mask:0xf
    ds_write_b64 v2, v[28:29]
    v_max3_f32 v30, v28, v29, v30
    v_add_u32 v2, 0x200, v2
    ds_read_b128 v[144:147], v3 offset:8192
    ds_read_b128 v[148:151], v3 offset:9216
    ds_read_b128 v[152:155], v3 offset:10240
    ds_read_b128 v[156:159], v3 offset:11264
    ds_read_b128 v[160:163], v3 offset:12288
    ds_read_b128 v[164:167], v3 offset:13312
    ds_read_b128 v[168:171], v3 offset:14336
    ds_read_b128 v[172:175], v3 offset:15360
    s_waitcnt vmcnt(4)
    buffer_load_dwordx4 v[112:115], v1, s[36:39], s44 offen offset:0 nt
    v_dot2_f32_bf16 v16, v176, v4, 0
    v_dot2_f32_bf16 v17, v180, v4, 0
    v_dot2_f32_bf16 v18, v184, v4, 0
    v_dot2_f32_bf16 v19, v188, v4, 0
    v_dot2c_f32_bf16 v16, v177, v5
    v_dot2c_f32_bf16 v17, v181, v5
    v_dot2c_f32_bf16 v18, v185, v5
    v_dot2c_f32_bf16 v19, v189, v5
    v_dot2c_f32_bf16 v16, v178, v6
    v_dot2c_f32_bf16 v17, v182, v6
    v_dot2c_f32_bf16 v18, v186, v6
    v_dot2c_f32_bf16 v19, v190, v6
    v_dot2c_f32_bf16 v16, v179, v7
    s_waitcnt vmcnt(4)
    buffer_load_dwordx4 v[116:119], v1, s[36:39], s44 offen offset:2048 nt
    s_add_u32 s44, s44, 4096
    v_dot2c_f32_bf16 v17, v183, v7
    v_dot2c_f32_bf16 v18, v187, v7
    v_dot2c_f32_bf16 v19, v191, v7
    v_add_f32_dpp v16, v16, v16 row_ror:8 row_mask:0xf bank_mask:0x3
    v_add_f32_dpp v17, v17, v17 row_ror:8 row_mask:0xf bank_mask:0x3
    v_add_f32_dpp v16, v18, v18 row_ror:8 row_mask:0xf bank_mask:0xc
    v_add_f32_dpp v17, v19, v19 row_ror:8 row_mask:0xf bank_mask:0xc
    v_dot2_f32_bf16 v20, v192, v4, 0
    v_dot2_f32_bf16 v21, v196, v4, 0
    v_dot2_f32_bf16 v22, v200, v4, 0
    v_dot2_f32_bf16 v23, v204, v4, 0
    v_dot2c_f32_bf16 v20, v193, v5
    v_dot2c_f32_bf16 v21, v197, v5
    s_waitcnt vmcnt(4)
    buffer_load_dwordx4 v[120:123], v1, s[36:39], s44 offen offset:0 nt
    v_dot2c_f32_bf16 v22, v201, v5
    v_dot2c_f32_bf16 v23, v205, v5
    v_dot2c_f32_bf16 v20, v194, v6
    v_dot2c_f32_bf16 v21, v198, v6
    v_dot2c_f32_bf16 v22, v202, v6
    v_dot2c_f32_bf16 v23, v206, v6
    v_dot2c_f32_bf16 v20, v195, v7
    v_dot2c_f32_bf16 v21, v199, v7
    v_dot2c_f32_bf16 v22, v203, v7
    v_dot2c_f32_bf16 v23, v207, v7
    v_add_f32_dpp v20, v20, v20 row_ror:8 row_mask:0xf bank_mask:0x3
    v_add_f32_dpp v21, v21, v21 row_ror:8 row_mask:0xf bank_mask:0x3
    v_add_f32_dpp v20, v22, v22 row_ror:8 row_mask:0xf bank_mask:0xc
    s_waitcnt vmcnt(4)
    buffer_load_dwordx4 v[124:127], v1, s[36:39], s44 offen offset:2048 nt
    s_add_u32 s44, s44, 12288
    v_add_f32_dpp v21, v23, v23 row_ror:8 row_mask:0xf bank_mask:0xc
    v_add_f32_dpp v24, v16, v16 row_half_mirror row_mask:0xf bank_mask:0x5
    v_add_f32_dpp v25, v17, v17 row_half_mirror row_mask:0xf bank_mask:0x5
    v_add_f32_dpp v24, v20, v20 row_half_mirror row_mask:0xf bank_mask:0xa
    v_add_f32_dpp v25, v21, v21 row_half_mirror row_mask:0xf bank_mask:0xa
    s_waitcnt lgkmcnt(0)
    v_dot2_f32_bf16 v16, v80, v4, 0
    v_dot2_f32_bf16 v17, v84, v4, 0
    v_dot2_f32_bf16 v18, v88, v4, 0
    v_dot2_f32_bf16 v19, v92, v4, 0
    v_dot2c_f32_bf16 v16, v81, v5
    v_dot2c_f32_bf16 v17, v85, v5
    v_dot2c_f32_bf16 v18, v89, v5
    s_waitcnt vmcnt(4)
    buffer_load_dwordx4 v[128:131], v1, s[36:39], s44 offen offset:0 nt
    v_dot2c_f32_bf16 v19, v93, v5
    v_dot2c_f32_bf16 v16, v82, v6
    v_dot2c_f32_bf16 v17, v86, v6
    v_dot2c_f32_bf16 v18, v90, v6
    v_dot2c_f32_bf16 v19, v94, v6
    v_dot2c_f32_bf16 v16, v83, v7
    v_dot2c_f32_bf16 v17, v87, v7
    v_dot2c_f32_bf16 v18, v91, v7
    v_dot2c_f32_bf16 v19, v95, v7
    v_add_f32_dpp v16, v16, v16 row_ror:8 row_mask:0xf bank_mask:0x3
    v_add_f32_dpp v17, v17, v17 row_ror:8 row_mask:0xf bank_mask:0x3
    v_add_f32_dpp v16, v18, v18 row_ror:8 row_mask:0xf bank_mask:0xc
    v_add_f32_dpp v17, v19, v19 row_ror:8 row_mask:0xf bank_mask:0xc
    s_waitcnt vmcnt(4)
    buffer_load_dwordx4 v[132:135], v1, s[36:39], s44 offen offset:2048 nt
    s_add_u32 s44, s44, 4096
    v_dot2_f32_bf16 v20, v96, v4, 0
    v_dot2_f32_bf16 v21, v100, v4, 0
    v_dot2_f32_bf16 v22, v104, v4, 0
    v_dot2_f32_bf16 v23, v108, v4, 0
    v_dot2c_f32_bf16 v20, v97, v5
    v_dot2c_f32_bf16 v21, v101, v5
    v_dot2c_f32_bf16 v22, v105, v5
    v_dot2c_f32_bf16 v23, v109, v5
    v_dot2c_f32_bf16 v20, v98, v6
    v_dot2c_f32_bf16 v21, v102, v6
    v_dot2c_f32_bf16 v22, v106, v6
    v_dot2c_f32_bf16 v23, v110, v6
    v_dot2c_f32_bf16 v20, v99, v7
    s_waitcnt vmcnt(4)
    buffer_load_dwordx4 v[136:139], v1, s[36:39], s44 offen offset:0 nt
    v_dot2c_f32_bf16 v21, v103, v7
    v_dot2c_f32_bf16 v22, v107, v7
    v_dot2c_f32_bf16 v23, v111, v7
    v_add_f32_dpp v20, v20, v20 row_ror:8 row_mask:0xf bank_mask:0x3
    v_add_f32_dpp v21, v21, v21 row_ror:8 row_mask:0xf bank_mask:0x3
    v_add_f32_dpp v20, v22, v22 row_ror:8 row_mask:0xf bank_mask:0xc
    v_add_f32_dpp v21, v23, v23 row_ror:8 row_mask:0xf bank_mask:0xc
    v_add_f32_dpp v18, v16, v16 row_half_mirror row_mask:0xf bank_mask:0x5
    v_add_f32_dpp v19, v17, v17 row_half_mirror row_mask:0xf bank_mask:0x5
    v_add_f32_dpp v18, v20, v20 row_half_mirror row_mask:0xf bank_mask:0xa
    v_add_f32_dpp v19, v21, v21 row_half_mirror row_mask:0xf bank_mask:0xa
    v_cndmask_b32 v32, v24, v18, s[58:59]
    v_cndmask_b32 v33, v18, v24, s[58:59]
    s_waitcnt vmcnt(4)
    buffer_load_dwordx4 v[140:143], v1, s[36:39], s44 offen offset:2048 nt
    s_add_u32 s44, s44, 12288
    s_and_b32 s44, s44, 0xfffff
    v_cndmask_b32 v34, v25, v19, s[58:59]
    v_cndmask_b32 v35, v19, v25, s[58:59]
    v_add_f32_dpp v26, v33, v32 quad_perm:[1,0,3,2] row_mask:0xf bank_mask:0xf
    s_nop 0
    v_add_f32_dpp v27, v35, v34 quad_perm:[1,0,3,2] row_mask:0xf bank_mask:0xf
    ds_read_b128 v[80:83], v3 offset:16384
    ds_read_b128 v[84:87], v3 offset:17408
    ds_read_b128 v[88:91], v3 offset:18432
    ds_read_b128 v[92:95], v3 offset:19456
    ds_read_b128 v[96:99], v3 offset:20480
    ds_read_b128 v[100:103], v3 offset:21504
    ds_read_b128 v[104:107], v3 offset:22528
    ds_read_b128 v[108:111], v3 offset:23552
    s_waitcnt vmcnt(4)
    buffer_load_dwordx4 v[176:179], v1, s[36:39], s44 offen offset:0 nt
    s_waitcnt lgkmcnt(0)
    v_dot2_f32_bf16 v16, v144, v4, 0
    v_dot2_f32_bf16 v17, v148, v4, 0
    v_dot2_f32_bf16 v18, v152, v4, 0
    v_dot2_f32_bf16 v19, v156, v4, 0
    v_dot2c_f32_bf16 v16, v145, v5
    v_dot2c_f32_bf16 v17, v149, v5
    v_dot2c_f32_bf16 v18, v153, v5
    v_dot2c_f32_bf16 v19, v157, v5
    v_dot2c_f32_bf16 v16, v146, v6
    v_dot2c_f32_bf16 v17, v150, v6
    v_dot2c_f32_bf16 v18, v154, v6
    v_dot2c_f32_bf16 v19, v158, v6
    v_dot2c_f32_bf16 v16, v147, v7
    v_dot2c_f32_bf16 v17, v151, v7
    s_waitcnt vmcnt(4)
    buffer_load_dwordx4 v[180:183], v1, s[36:39], s44 offen offset:2048 nt
    s_add_u32 s44, s44, 4096
    v_dot2c_f32_bf16 v18, v155, v7
    v_dot2c_f32_bf16 v19, v159, v7
    v_add_f32_dpp v16, v16, v16 row_ror:8 row_mask:0xf bank_mask:0x3
    v_add_f32_dpp v17, v17, v17 row_ror:8 row_mask:0xf bank_mask:0x3
    v_add_f32_dpp v16, v18, v18 row_ror:8 row_mask:0xf bank_mask:0xc
    v_add_f32_dpp v17, v19, v19 row_ror:8 row_mask:0xf bank_mask:0xc
    v_dot2_f32_bf16 v20, v160, v4, 0
    v_dot2_f32_bf16 v21, v164, v4, 0
    v_dot2_f32_bf16 v22, v168, v4, 0
    v_dot2_f32_bf16 v23, v172, v4, 0
    v_dot2c_f32_bf16 v20, v161, v5
    v_dot2c_f32_bf16 v21, v165, v5
    v_dot2c_f32_bf16 v22, v169, v5
    v_dot2c_f32_bf16 v23, v173, v5
    v_dot2c_f32_bf16 v20, v162, v6
    s_waitcnt vmcnt(4)
    buffer_load_dwordx4 v[184:187], v1, s[36:39], s44 offen offset:0 nt
    v_dot2c_f32_bf16 v21, v166, v6
    v_dot2c_f32_bf16 v22, v170, v6
    v_dot2c_f32_bf16 v23, v174, v6
    v_dot2c_f32_bf16 v20, v163, v7
    v_dot2c_f32_bf16 v21, v167, v7
    v_dot2c_f32_bf16 v22, v171, v7
    v_dot2c_f32_bf16 v23, v175, v7
    v_add_f32_dpp v20, v20, v20 row_ror:8 row_mask:0xf bank_mask:0x3
    v_add_f32_dpp v21, v21, v21 row_ror:8 row_mask:0xf bank_mask:0x3
    v_add_f32_dpp v20, v22, v22 row_ror:8 row_mask:0xf bank_mask:0xc
    v_add_f32_dpp v21, v23, v23 row_ror:8 row_mask:0xf bank_mask:0xc
    v_add_f32_dpp v24, v16, v16 row_half_mirror row_mask:0xf bank_mask:0x5
    v_add_f32_dpp v25, v17, v17 row_half_mirror row_mask:0xf bank_mask:0x5
    v_add_f32_dpp v24, v20, v20 row_half_mirror row_mask:0xf bank_mask:0xa
    s_waitcnt vmcnt(4)
    buffer_load_dwordx4 v[188:191], v1, s[36:39], s44 offen offset:2048 nt
    s_add_u32 s44, s44, 12288
    v_add_f32_dpp v25, v21, v21 row_half_mirror row_mask:0xf bank_mask:0xa
    s_waitcnt lgkmcnt(0)
    v_dot2_f32_bf16 v16, v80, v4, 0
    v_dot2_f32_bf16 v17, v84, v4, 0
    v_dot2_f32_bf16 v18, v88, v4, 0
    v_dot2_f32_bf16 v19, v92, v4, 0
    v_dot2c_f32_bf16 v16, v81, v5
    v_dot2c_f32_bf16 v17, v85, v5
    v_dot2c_f32_bf16 v18, v89, v5
    v_dot2c_f32_bf16 v19, v93, v5
    v_dot2c_f32_bf16 v16, v82, v6
    v_dot2c_f32_bf16 v17, v86, v6
    v_dot2c_f32_bf16 v18, v90, v6
    v_dot2c_f32_bf16 v19, v94, v6
    s_waitcnt vmcnt(4)
    buffer_load_dwordx4 v[192:195], v1, s[36:39], s44 offen offset:0 nt
    v_dot2c_f32_bf16 v16, v83, v7
    v_dot2c_f32_bf16 v17, v87, v7
    v_dot2c_f32_bf16 v18, v91, v7
    v_dot2c_f32_bf16 v19, v95, v7
    v_add_f32_dpp v16, v16, v16 row_ror:8 row_mask:0xf bank_mask:0x3
    v_add_f32_dpp v17, v17, v17 row_ror:8 row_mask:0xf bank_mask:0x3
    v_add_f32_dpp v16, v18, v18 row_ror:8 row_mask:0xf bank_mask:0xc
    v_add_f32_dpp v17, v19, v19 row_ror:8 row_mask:0xf bank_mask:0xc
    v_dot2_f32_bf16 v20, v96, v4, 0
    v_dot2_f32_bf16 v21, v100, v4, 0
    v_dot2_f32_bf16 v22, v104, v4, 0
    v_dot2_f32_bf16 v23, v108, v4, 0
    v_dot2c_f32_bf16 v20, v97, v5
    v_dot2c_f32_bf16 v21, v101, v5
    s_waitcnt vmcnt(4)
    buffer_load_dwordx4 v[196:199], v1, s[36:39], s44 offen offset:2048 nt
    s_add_u32 s44, s44, 4096
    v_dot2c_f32_bf16 v22, v105, v5
    v_dot2c_f32_bf16 v23, v109, v5
    v_dot2c_f32_bf16 v20, v98, v6
    v_dot2c_f32_bf16 v21, v102, v6
    v_dot2c_f32_bf16 v22, v106, v6
    v_dot2c_f32_bf16 v23, v110, v6
    v_dot2c_f32_bf16 v20, v99, v7
    v_dot2c_f32_bf16 v21, v103, v7
    v_dot2c_f32_bf16 v22, v107, v7
    v_dot2c_f32_bf16 v23, v111, v7
    v_add_f32_dpp v20, v20, v20 row_ror:8 row_mask:0xf bank_mask:0x3
    v_add_f32_dpp v21, v21, v21 row_ror:8 row_mask:0xf bank_mask:0x3
    v_add_f32_dpp v20, v22, v22 row_ror:8 row_mask:0xf bank_mask:0xc
    v_add_f32_dpp v21, v23, v23 row_ror:8 row_mask:0xf bank_mask:0xc
    s_waitcnt vmcnt(4)
    buffer_load_dwordx4 v[200:203], v1, s[36:39], s44 offen offset:0 nt
    v_add_f32_dpp v18, v16, v16 row_half_mirror row_mask:0xf bank_mask:0x5
    v_add_f32_dpp v19, v17, v17 row_half_mirror row_mask:0xf bank_mask:0x5
    v_add_f32_dpp v18, v20, v20 row_half_mirror row_mask:0xf bank_mask:0xa
    v_add_f32_dpp v19, v21, v21 row_half_mirror row_mask:0xf bank_mask:0xa
    v_cndmask_b32 v32, v24, v18, s[58:59]
    v_cndmask_b32 v33, v18, v24, s[58:59]
    v_cndmask_b32 v34, v25, v19, s[58:59]
    v_cndmask_b32 v35, v19, v25, s[58:59]
    v_add_f32_dpp v22, v33, v32 quad_perm:[1,0,3,2] row_mask:0xf bank_mask:0xf
    s_nop 0
    v_add_f32_dpp v23, v35, v34 quad_perm:[1,0,3,2] row_mask:0xf bank_mask:0xf
    v_cndmask_b32 v32, v26, v22, s[60:61]
    v_cndmask_b32 v33, v22, v26, s[60:61]
    v_cndmask_b32 v34, v27, v23, s[60:61]
    v_cndmask_b32 v35, v23, v27, s[60:61]
    s_waitcnt vmcnt(4)
    buffer_load_dwordx4 v[204:207], v1, s[36:39], s44 offen offset:2048 nt
    s_add_u32 s44, s44, 12288
    s_and_b32 s44, s44, 0xfffff
    v_add_f32_dpp v28, v33, v32 quad_perm:[2,3,0,1] row_mask:0xf bank_mask:0xf
    v_add_f32_dpp v29, v35, v34 quad_perm:[2,3,0,1] row_mask:0xf bank_mask:0xf
    ds_write_b64 v2, v[28:29]
    v_max3_f32 v30, v28, v29, v30
    v_add_u32 v2, 0x200, v2
    ds_read_b128 v[80:83], v3 offset:24576
    ds_read_b128 v[84:87], v3 offset:25600
    ds_read_b128 v[88:91], v3 offset:26624
    ds_read_b128 v[92:95], v3 offset:27648
    ds_read_b128 v[96:99], v3 offset:28672
    ds_read_b128 v[100:103], v3 offset:29696
    ds_read_b128 v[104:107], v3 offset:30720
    ds_read_b128 v[108:111], v3 offset:31744
    s_waitcnt vmcnt(4)
    buffer_load_dwordx4 v[144:147], v1, s[36:39], s44 offen offset:0 nt
    s_waitcnt lgkmcnt(0)
    v_dot2_f32_bf16 v16, v80, v4, 0
    v_dot2_f32_bf16 v17, v84, v4, 0
    v_dot2_f32_bf16 v18, v88, v4, 0
    v_dot2_f32_bf16 v19, v92, v4, 0
    v_dot2c_f32_bf16 v16, v81, v5
    v_dot2c_f32_bf16 v17, v85, v5
    v_dot2c_f32_bf16 v18, v89, v5
    v_dot2c_f32_bf16 v19, v93, v5
    v_dot2c_f32_bf16 v16, v82, v6
    v_dot2c_f32_bf16 v17, v86, v6
    v_dot2c_f32_bf16 v18, v90, v6
    v_dot2c_f32_bf16 v19, v94, v6
    s_waitcnt vmcnt(4)
    buffer_load_dwordx4 v[148:151], v1, s[36:39], s44 offen offset:2048 nt
    s_add_u32 s44, s44, 4096
    v_dot2c_f32_bf16 v16, v83, v7
    v_dot2c_f32_bf16 v17, v87, v7
    v_dot2c_f32_bf16 v18, v91, v7
    v_dot2c_f32_bf16 v19, v95, v7
    v_add_f32_dpp v16, v16, v16 row_ror:8 row_mask:0xf bank_mask:0x3
    v_add_f32_dpp v17, v17, v17 row_ror:8 row_mask:0xf bank_mask:0x3
    v_add_f32_dpp v16, v18, v18 row_ror:8 row_mask:0xf bank_mask:0xc
    v_add_f32_dpp v17, v19, v19 row_ror:8 row_mask:0xf bank_mask:0xc
    v_dot2_f32_bf16 v20, v96, v4, 0
    v_dot2_f32_bf16 v21, v100, v4, 0
    v_dot2_f32_bf16 v22, v104, v4, 0
    v_dot2_f32_bf16 v23, v108, v4, 0
    s_waitcnt vmcnt(4)
    buffer_load_dwordx4 v[152:155], v1, s[36:39], s44 offen offset:0 nt
    v_dot2c_f32_bf16 v20, v97, v5
    v_dot2c_f32_bf16 v21, v101, v5
    v_dot2c_f32_bf16 v22, v105, v5
    v_dot2c_f32_bf16 v23, v109, v5
    v_dot2c_f32_bf16 v20, v98, v6
    v_dot2c_f32_bf16 v21, v102, v6
    v_dot2c_f32_bf16 v22, v106, v6
    v_dot2c_f32_bf16 v23, v110, v6
    v_dot2c_f32_bf16 v20, v99, v7
    v_dot2c_f32_bf16 v21, v103, v7
    v_dot2c_f32_bf16 v22, v107, v7
    v_dot2c_f32_bf16 v23, v111, v7
    s_waitcnt vmcnt(4)
    buffer_load_dwordx4 v[156:159], v1, s[36:39], s44 offen offset:2048 nt
    s_add_u32 s44, s44, 12288
    v_add_f32_dpp v20, v20, v20 row_ror:8 row_mask:0xf bank_mask:0x3
    v_add_f32_dpp v21, v21, v21 row_ror:8 row_mask:0xf bank_mask:0x3
    v_add_f32_dpp v20, v22, v22 row_ror:8 row_mask:0xf bank_mask:0xc
    v_add_f32_dpp v21, v23, v23 row_ror:8 row_mask:0xf bank_mask:0xc
    v_add_f32_dpp v24, v16, v16 row_half_mirror row_mask:0xf bank_mask:0x5
    v_add_f32_dpp v25, v17, v17 row_half_mirror row_mask:0xf bank_mask:0x5
    v_add_f32_dpp v24, v20, v20 row_half_mirror row_mask:0xf bank_mask:0xa
    v_add_f32_dpp v25, v21, v21 row_half_mirror row_mask:0xf bank_mask:0xa
    v_dot2_f32_bf16 v16, v208, v4, 0
    v_dot2_f32_bf16 v17, v212, v4, 0
    v_dot2_f32_bf16 v18, v216, v4, 0
    s_waitcnt vmcnt(4)
    buffer_load_dwordx4 v[160:163], v1, s[36:39], s44 offen offset:0 nt
    v_dot2_f32_bf16 v19, v220, v4, 0
    v_dot2c_f32_bf16 v16, v209, v5
    v_dot2c_f32_bf16 v17, v213, v5
    v_dot2c_f32_bf16 v18, v217, v5
    v_dot2c_f32_bf16 v19, v221, v5
    v_dot2c_f32_bf16 v16, v210, v6
    v_dot2c_f32_bf16 v17, v214, v6
    v_dot2c_f32_bf16 v18, v218, v6
    v_dot2c_f32_bf16 v19, v222, v6
    v_dot2c_f32_bf16 v16, v211, v7
    v_dot2c_f32_bf16 v17, v215, v7
    v_dot2c_f32_bf16 v18, v219, v7
    s_waitcnt vmcnt(4)
    buffer_load_dwordx4 v[164:167], v1, s[36:39], s44 offen offset:2048 nt
    s_add_u32 s44, s44, 4096
    v_dot2c_f32_bf16 v19, v223, v7
    v_add_f32_dpp v16, v16, v16 row_ror:8 row_mask:0xf bank_mask:0x3
    v_add_f32_dpp v17, v17, v17 row_ror:8 row_mask:0xf bank_mask:0x3
    v_add_f32_dpp v16, v18, v18 row_ror:8 row_mask:0xf bank_mask:0xc
    v_add_f32_dpp v17, v19, v19 row_ror:8 row_mask:0xf bank_mask:0xc
    v_dot2_f32_bf16 v20, v224, v4, 0
    v_dot2_f32_bf16 v21, v228, v4, 0
    v_dot2_f32_bf16 v22, v232, v4, 0
    v_dot2_f32_bf16 v23, v236, v4, 0
    v_dot2c_f32_bf16 v20, v225, v5
    v_dot2c_f32_bf16 v21, v229, v5
    s_waitcnt vmcnt(4)
    buffer_load_dwordx4 v[168:171], v1, s[36:39], s44 offen offset:0 nt
    v_dot2c_f32_bf16 v22, v233, v5
    v_dot2c_f32_bf16 v23, v237, v5
    v_dot2c_f32_bf16 v20, v226, v6
    v_dot2c_f32_bf16 v21, v230, v6
    v_dot2c_f32_bf16 v22, v234, v6
    v_dot2c_f32_bf16 v23, v238, v6
    v_dot2c_f32_bf16 v20, v227, v7
    v_dot2c_f32_bf16 v21, v231, v7
    v_dot2c_f32_bf16 v22, v235, v7
    v_dot2c_f32_bf16 v23, v239, v7
    v_add_f32_dpp v20, v20, v20 row_ror:8 row_mask:0xf bank_mask:0x3
    v_add_f32_dpp v21, v21, v21 row_ror:8 row_mask:0xf bank_mask:0x3
    s_waitcnt vmcnt(4)
    buffer_load_dwordx4 v[172:175], v1, s[36:39], s44 offen offset:2048 nt
    s_add_u32 s44, s44, 12288
    s_and_b32 s44, s44, 0xfffff
    v_add_f32_dpp v20, v22, v22 row_ror:8 row_mask:0xf bank_mask:0xc
    v_add_f32_dpp v21, v23, v23 row_ror:8 row_mask:0xf bank_mask:0xc
    v_add_f32_dpp v18, v16, v16 row_half_mirror row_mask:0xf bank_mask:0x5
    v_add_f32_dpp v19, v17, v17 row_half_mirror row_mask:0xf bank_mask:0x5
    v_add_f32_dpp v18, v20, v20 row_half_mirror row_mask:0xf bank_mask:0xa
    v_add_f32_dpp v19, v21, v21 row_half_mirror row_mask:0xf bank_mask:0xa
    v_cndmask_b32 v32, v24, v18, s[58:59]
    v_cndmask_b32 v33, v18, v24, s[58:59]
    v_cndmask_b32 v34, v25, v19, s[58:59]
    v_cndmask_b32 v35, v19, v25, s[58:59]
    v_add_f32_dpp v26, v33, v32 quad_perm:[1,0,3,2] row_mask:0xf bank_mask:0xf
    s_nop 0
    v_add_f32_dpp v27, v35, v34 quad_perm:[1,0,3,2] row_mask:0xf bank_mask:0xf
    s_waitcnt vmcnt(4)
    buffer_load_dwordx4 v[80:83], v1, s[36:39], s44 offen offset:0 nt
    v_dot2_f32_bf16 v16, v48, v4, 0
    v_dot2_f32_bf16 v17, v52, v4, 0
    v_dot2_f32_bf16 v18, v56, v4, 0
    v_dot2_f32_bf16 v19, v60, v4, 0
    v_dot2c_f32_bf16 v16, v49, v5
    v_dot2c_f32_bf16 v17, v53, v5
    v_dot2c_f32_bf16 v18, v57, v5
    v_dot2c_f32_bf16 v19, v61, v5
    v_dot2c_f32_bf16 v16, v50, v6
    v_dot2c_f32_bf16 v17, v54, v6
    v_dot2c_f32_bf16 v18, v58, v6
    v_dot2c_f32_bf16 v19, v62, v6
    v_dot2c_f32_bf16 v16, v51, v7
    s_waitcnt vmcnt(4)
    buffer_load_dwordx4 v[84:87], v1, s[36:39], s44 offen offset:2048 nt
    s_add_u32 s44, s44, 4096
    v_dot2c_f32_bf16 v17, v55, v7
    v_dot2c_f32_bf16 v18, v59, v7
    v_dot2c_f32_bf16 v19, v63, v7
    v_add_f32_dpp v16, v16, v16 row_ror:8 row_mask:0xf bank_mask:0x3
    v_add_f32_dpp v17, v17, v17 row_ror:8 row_mask:0xf bank_mask:0x3
    v_add_f32_dpp v16, v18, v18 row_ror:8 row_mask:0xf bank_mask:0xc
    v_add_f32_dpp v17, v19, v19 row_ror:8 row_mask:0xf bank_mask:0xc
    v_dot2_f32_bf16 v20, v64, v4, 0
    v_dot2_f32_bf16 v21, v68, v4, 0
    v_dot2_f32_bf16 v22, v72, v4, 0
    v_dot2_f32_bf16 v23, v76, v4, 0
    v_dot2c_f32_bf16 v20, v65, v5
    v_dot2c_f32_bf16 v21, v69, v5
    s_waitcnt vmcnt(4)
    buffer_load_dwordx4 v[88:91], v1, s[36:39], s44 offen offset:0 nt
    v_dot2c_f32_bf16 v22, v73, v5
    v_dot2c_f32_bf16 v23, v77, v5
    v_dot2c_f32_bf16 v20, v66, v6
    v_dot2c_f32_bf16 v21, v70, v6
    v_dot2c_f32_bf16 v22, v74, v6
    v_dot2c_f32_bf16 v23, v78, v6
    v_dot2c_f32_bf16 v20, v67, v7
    v_dot2c_f32_bf16 v21, v71, v7
    v_dot2c_f32_bf16 v22, v75, v7
    v_dot2c_f32_bf16 v23, v79, v7
    v_add_f32_dpp v20, v20, v20 row_ror:8 row_mask:0xf bank_mask:0x3
    v_add_f32_dpp v21, v21, v21 row_ror:8 row_mask:0xf bank_mask:0x3
    v_add_f32_dpp v20, v22, v22 row_ror:8 row_mask:0xf bank_mask:0xc
    v_add_f32_dpp v21, v23, v23 row_ror:8 row_mask:0xf bank_mask:0xc
    s_waitcnt vmcnt(4)
    buffer_load_dwordx4 v[92:95], v1, s[36:39], s44 offen offset:2048 nt
    s_add_u32 s44, s44, 12288
    v_add_f32_dpp v24, v16, v16 row_half_mirror row_mask:0xf bank_mask:0x5
    v_add_f32_dpp v25, v17, v17 row_half_mirror row_mask:0xf bank_mask:0x5
    v_add_f32_dpp v24, v20, v20 row_half_mirror row_mask:0xf bank_mask:0xa
    v_add_f32_dpp v25, v21, v21 row_half_mirror row_mask:0xf bank_mask:0xa
    v_dot2_f32_bf16 v16, v112, v4, 0
    v_dot2_f32_bf16 v17, v116, v4, 0
    v_dot2_f32_bf16 v18, v120, v4, 0
    v_dot2_f32_bf16 v19, v124, v4, 0
    v_dot2c_f32_bf16 v16, v113, v5
    v_dot2c_f32_bf16 v17, v117, v5
    v_dot2c_f32_bf16 v18, v121, v5
    v_dot2c_f32_bf16 v19, v125, v5
    s_waitcnt vmcnt(4)
    buffer_load_dwordx4 v[96:99], v1, s[36:39], s44 offen offset:0 nt
    v_dot2c_f32_bf16 v16, v114, v6
    v_dot2c_f32_bf16 v17, v118, v6
    v_dot2c_f32_bf16 v18, v122, v6
    v_dot2c_f32_bf16 v19, v126, v6
    v_dot2c_f32_bf16 v16, v115, v7
    v_dot2c_f32_bf16 v17, v119, v7
    v_dot2c_f32_bf16 v18, v123, v7
    v_dot2c_f32_bf16 v19, v127, v7
    v_add_f32_dpp v16, v16, v16 row_ror:8 row_mask:0xf bank_mask:0x3
    v_add_f32_dpp v17, v17, v17 row_ror:8 row_mask:0xf bank_mask:0x3
    v_add_f32_dpp v16, v18, v18 row_ror:8 row_mask:0xf bank_mask:0xc
    v_add_f32_dpp v17, v19, v19 row_ror:8 row_mask:0xf bank_mask:0xc
    s_waitcnt vmcnt(4)
    buffer_load_dwordx4 v[100:103], v1, s[36:39], s44 offen offset:2048 nt
    s_add_u32 s44, s44, 4096
    v_dot2_f32_bf16 v20, v128, v4, 0
    v_dot2_f32_bf16 v21, v132, v4, 0
    v_dot2_f32_bf16 v22, v136, v4, 0
    v_dot2_f32_bf16 v23, v140, v4, 0
    v_dot2c_f32_bf16 v20, v129, v5
    v_dot2c_f32_bf16 v21, v133, v5
    v_dot2c_f32_bf16 v22, v137, v5
    v_dot2c_f32_bf16 v23, v141, v5
    v_dot2c_f32_bf16 v20, v130, v6
    v_dot2c_f32_bf16 v21, v134, v6
    v_dot2c_f32_bf16 v22, v138, v6
    v_dot2c_f32_bf16 v23, v142, v6
    v_dot2c_f32_bf16 v20, v131, v7
    s_waitcnt vmcnt(4)
    buffer_load_dwordx4 v[104:107], v1, s[36:39], s44 offen offset:0 nt
    v_dot2c_f32_bf16 v21, v135, v7
    v_dot2c_f32_bf16 v22, v139, v7
    v_dot2c_f32_bf16 v23, v143, v7
    v_add_f32_dpp v20, v20, v20 row_ror:8 row_mask:0xf bank_mask:0x3
    v_add_f32_dpp v21, v21, v21 row_ror:8 row_mask:0xf bank_mask:0x3
    v_add_f32_dpp v20, v22, v22 row_ror:8 row_mask:0xf bank_mask:0xc
    v_add_f32_dpp v21, v23, v23 row_ror:8 row_mask:0xf bank_mask:0xc
    v_add_f32_dpp v18, v16, v16 row_half_mirror row_mask:0xf bank_mask:0x5
    v_add_f32_dpp v19, v17, v17 row_half_mirror row_mask:0xf bank_mask:0x5
    v_add_f32_dpp v18, v20, v20 row_half_mirror row_mask:0xf bank_mask:0xa
    v_add_f32_dpp v19, v21, v21 row_half_mirror row_mask:0xf bank_mask:0xa
    v_cndmask_b32 v32, v24, v18, s[58:59]
    v_cndmask_b32 v33, v18, v24, s[58:59]
    s_waitcnt vmcnt(4)
    buffer_load_dwordx4 v[108:111], v1, s[36:39], s44 offen offset:2048 nt
    s_add_u32 s44, s44, 12288
    s_and_b32 s44, s44, 0xfffff
    v_cndmask_b32 v34, v25, v19, s[58:59]
    v_cndmask_b32 v35, v19, v25, s[58:59]
    v_add_f32_dpp v22, v33, v32 quad_perm:[1,0,3,2] row_mask:0xf bank_mask:0xf
    s_nop 0
    v_add_f32_dpp v23, v35, v34 quad_perm:[1,0,3,2] row_mask:0xf bank_mask:0xf
    v_cndmask_b32 v32, v26, v22, s[60:61]
    v_cndmask_b32 v33, v22, v26, s[60:61]
    v_cndmask_b32 v34, v27, v23, s[60:61]
    v_cndmask_b32 v35, v23, v27, s[60:61]
    v_add_f32_dpp v28, v33, v32 quad_perm:[2,3,0,1] row_mask:0xf bank_mask:0xf
    s_nop 0
    v_add_f32_dpp v29, v35, v34 quad_perm:[2,3,0,1] row_mask:0xf bank_mask:0xf
    ds_write_b64 v2, v[28:29]
    v_max3_f32 v30, v28, v29, v30
    v_add_u32 v2, 0x200, v2
    s_waitcnt vmcnt(4)
    buffer_load_dwordx4 v[208:211], v1, s[36:39], s44 offen offset:0 nt
    v_dot2_f32_bf16 v16, v176, v4, 0
    v_dot2_f32_bf16 v17, v180, v4, 0
    v_dot2_f32_bf16 v18, v184, v4, 0
    v_dot2_f32_bf16 v19, v188, v4, 0
    v_dot2c_f32_bf16 v16, v177, v5
    v_dot2c_f32_bf16 v17, v181, v5
    v_dot2c_f32_bf16 v18, v185, v5
    v_dot2c_f32_bf16 v19, v189, v5
    v_dot2c_f32_bf16 v16, v178, v6
    v_dot2c_f32_bf16 v17, v182, v6
    v_dot2c_f32_bf16 v18, v186, v6
    v_dot2c_f32_bf16 v19, v190, v6
    s_waitcnt vmcnt(4)
    buffer_load_dwordx4 v[212:215], v1, s[36:39], s44 offen offset:2048 nt
    s_add_u32 s44, s44, 4096
    v_dot2c_f32_bf16 v16, v179, v7
    v_dot2c_f32_bf16 v17, v183, v7
    v_dot2c_f32_bf16 v18, v187, v7
    v_dot2c_f32_bf16 v19, v191, v7
    v_add_f32_dpp v16, v16, v16 row_ror:8 row_mask:0xf bank_mask:0x3
    v_add_f32_dpp v17, v17, v17 row_ror:8 row_mask:0xf bank_mask:0x3
    v_add_f32_dpp v16, v18, v18 row_ror:8 row_mask:0xf bank_mask:0xc
    v_add_f32_dpp v17, v19, v19 row_ror:8 row_mask:0xf bank_mask:0xc
    v_dot2_f32_bf16 v20, v192, v4, 0
    v_dot2_f32_bf16 v21, v196, v4, 0
    v_dot2_f32_bf16 v22, v200, v4, 0
    v_dot2_f32_bf16 v23, v204, v4, 0
    s_waitcnt vmcnt(4)
    buffer_load_dwordx4 v[216:219], v1, s[36:39], s44 offen offset:0 nt
    v_dot2c_f32_bf16 v20, v193, v5
    v_dot2c_f32_bf16 v21, v197, v5
    v_dot2c_f32_bf16 v22, v201, v5
    v_dot2c_f32_bf16 v23, v205, v5
    v_dot2c_f32_bf16 v20, v194, v6
    v_dot2c_f32_bf16 v21, v198, v6
    v_dot2c_f32_bf16 v22, v202, v6
    v_dot2c_f32_bf16 v23, v206, v6
    v_dot2c_f32_bf16 v20, v195, v7
    v_dot2c_f32_bf16 v21, v199, v7
    v_dot2c_f32_bf16 v22, v203, v7
    v_dot2c_f32_bf16 v23, v207, v7
    s_waitcnt vmcnt(4)
    buffer_load_dwordx4 v[220:223], v1, s[36:39], s44 offen offset:2048 nt
    s_add_u32 s44, s44, 12288
    v_add_f32_dpp v20, v20, v20 row_ror:8 row_mask:0xf bank_mask:0x3
    v_add_f32_dpp v21, v21, v21 row_ror:8 row_mask:0xf bank_mask:0x3
    v_add_f32_dpp v20, v22, v22 row_ror:8 row_mask:0xf bank_mask:0xc
    v_add_f32_dpp v21, v23, v23 row_ror:8 row_mask:0xf bank_mask:0xc
    v_add_f32_dpp v24, v16, v16 row_half_mirror row_mask:0xf bank_mask:0x5
    v_add_f32_dpp v25, v17, v17 row_half_mirror row_mask:0xf bank_mask:0x5
    v_add_f32_dpp v24, v20, v20 row_half_mirror row_mask:0xf bank_mask:0xa
    v_add_f32_dpp v25, v21, v21 row_half_mirror row_mask:0xf bank_mask:0xa
    v_dot2_f32_bf16 v16, v144, v4, 0
    v_dot2_f32_bf16 v17, v148, v4, 0
    v_dot2_f32_bf16 v18, v152, v4, 0
    s_waitcnt vmcnt(4)
    buffer_load_dwordx4 v[224:227], v1, s[36:39], s44 offen offset:0 nt
    v_dot2_f32_bf16 v19, v156, v4, 0
    v_dot2c_f32_bf16 v16, v145, v5
    v_dot2c_f32_bf16 v17, v149, v5
    v_dot2c_f32_bf16 v18, v153, v5
    v_dot2c_f32_bf16 v19, v157, v5
    v_dot2c_f32_bf16 v16, v146, v6
    v_dot2c_f32_bf16 v17, v150, v6
    v_dot2c_f32_bf16 v18, v154, v6
    v_dot2c_f32_bf16 v19, v158, v6
    v_dot2c_f32_bf16 v16, v147, v7
    v_dot2c_f32_bf16 v17, v151, v7
    v_dot2c_f32_bf16 v18, v155, v7
    s_waitcnt vmcnt(4)
    buffer_load_dwordx4 v[228:231], v1, s[36:39], s44 offen offset:2048 nt
    s_add_u32 s44, s44, 4096
    v_dot2c_f32_bf16 v19, v159, v7
    v_add_f32_dpp v16, v16, v16 row_ror:8 row_mask:0xf bank_mask:0x3
    v_add_f32_dpp v17, v17, v17 row_ror:8 row_mask:0xf bank_mask:0x3
    v_add_f32_dpp v16, v18, v18 row_ror:8 row_mask:0xf bank_mask:0xc
    v_add_f32_dpp v17, v19, v19 row_ror:8 row_mask:0xf bank_mask:0xc
    v_dot2_f32_bf16 v20, v160, v4, 0
    v_dot2_f32_bf16 v21, v164, v4, 0
    v_dot2_f32_bf16 v22, v168, v4, 0
    v_dot2_f32_bf16 v23, v172, v4, 0
    v_dot2c_f32_bf16 v20, v161, v5
    v_dot2c_f32_bf16 v21, v165, v5
    s_waitcnt vmcnt(4)
    buffer_load_dwordx4 v[232:235], v1, s[36:39], s44 offen offset:0 nt
    v_dot2c_f32_bf16 v22, v169, v5
    v_dot2c_f32_bf16 v23, v173, v5
    v_dot2c_f32_bf16 v20, v162, v6
    v_dot2c_f32_bf16 v21, v166, v6
    v_dot2c_f32_bf16 v22, v170, v6
    v_dot2c_f32_bf16 v23, v174, v6
    v_dot2c_f32_bf16 v20, v163, v7
    v_dot2c_f32_bf16 v21, v167, v7
    v_dot2c_f32_bf16 v22, v171, v7
    v_dot2c_f32_bf16 v23, v175, v7
    v_add_f32_dpp v20, v20, v20 row_ror:8 row_mask:0xf bank_mask:0x3
    v_add_f32_dpp v21, v21, v21 row_ror:8 row_mask:0xf bank_mask:0x3
    s_waitcnt vmcnt(4)
    buffer_load_dwordx4 v[236:239], v1, s[36:39], s44 offen offset:2048 nt
    s_add_u32 s44, s44, 12288
    s_and_b32 s44, s44, 0xfffff
    v_add_f32_dpp v20, v22, v22 row_ror:8 row_mask:0xf bank_mask:0xc
    v_add_f32_dpp v21, v23, v23 row_ror:8 row_mask:0xf bank_mask:0xc
    v_add_f32_dpp v18, v16, v16 row_half_mirror row_mask:0xf bank_mask:0x5
    v_add_f32_dpp v19, v17, v17 row_half_mirror row_mask:0xf bank_mask:0x5
    v_add_f32_dpp v18, v20, v20 row_half_mirror row_mask:0xf bank_mask:0xa
    v_add_f32_dpp v19, v21, v21 row_half_mirror row_mask:0xf bank_mask:0xa
    v_cndmask_b32 v32, v24, v18, s[58:59]
    v_cndmask_b32 v33, v18, v24, s[58:59]
    v_cndmask_b32 v34, v25, v19, s[58:59]
    v_cndmask_b32 v35, v19, v25, s[58:59]
    v_add_f32_dpp v26, v33, v32 quad_perm:[1,0,3,2] row_mask:0xf bank_mask:0xf
    s_nop 0
    v_add_f32_dpp v27, v35, v34 quad_perm:[1,0,3,2] row_mask:0xf bank_mask:0xf
    s_waitcnt vmcnt(4)
    buffer_load_dwordx4 v[48:51], v1, s[36:39], s44 offen offset:0 nt
    v_dot2_f32_bf16 v16, v80, v4, 0
    v_dot2_f32_bf16 v17, v84, v4, 0
    v_dot2_f32_bf16 v18, v88, v4, 0
    v_dot2_f32_bf16 v19, v92, v4, 0
    v_dot2c_f32_bf16 v16, v81, v5
    v_dot2c_f32_bf16 v17, v85, v5
    v_dot2c_f32_bf16 v18, v89, v5
    v_dot2c_f32_bf16 v19, v93, v5
    v_dot2c_f32_bf16 v16, v82, v6
    v_dot2c_f32_bf16 v17, v86, v6
    v_dot2c_f32_bf16 v18, v90, v6
    v_dot2c_f32_bf16 v19, v94, v6
    v_dot2c_f32_bf16 v16, v83, v7
    s_waitcnt vmcnt(4)
    buffer_load_dwordx4 v[52:55], v1, s[36:39], s44 offen offset:2048 nt
    s_add_u32 s44, s44, 4096
    v_dot2c_f32_bf16 v17, v87, v7
    v_dot2c_f32_bf16 v18, v91, v7
    v_dot2c_f32_bf16 v19, v95, v7
    v_add_f32_dpp v16, v16, v16 row_ror:8 row_mask:0xf bank_mask:0x3
    v_add_f32_dpp v17, v17, v17 row_ror:8 row_mask:0xf bank_mask:0x3
    v_add_f32_dpp v16, v18, v18 row_ror:8 row_mask:0xf bank_mask:0xc
    v_add_f32_dpp v17, v19, v19 row_ror:8 row_mask:0xf bank_mask:0xc
    v_dot2_f32_bf16 v20, v96, v4, 0
    v_dot2_f32_bf16 v21, v100, v4, 0
    v_dot2_f32_bf16 v22, v104, v4, 0
    v_dot2_f32_bf16 v23, v108, v4, 0
    v_dot2c_f32_bf16 v20, v97, v5
    v_dot2c_f32_bf16 v21, v101, v5
    s_waitcnt vmcnt(4)
    buffer_load_dwordx4 v[56:59], v1, s[36:39], s44 offen offset:0 nt
    v_dot2c_f32_bf16 v22, v105, v5
    v_dot2c_f32_bf16 v23, v109, v5
    v_dot2c_f32_bf16 v20, v98, v6
    v_dot2c_f32_bf16 v21, v102, v6
    v_dot2c_f32_bf16 v22, v106, v6
    v_dot2c_f32_bf16 v23, v110, v6
    v_dot2c_f32_bf16 v20, v99, v7
    v_dot2c_f32_bf16 v21, v103, v7
    v_dot2c_f32_bf16 v22, v107, v7
    v_dot2c_f32_bf16 v23, v111, v7
    v_add_f32_dpp v20, v20, v20 row_ror:8 row_mask:0xf bank_mask:0x3
    v_add_f32_dpp v21, v21, v21 row_ror:8 row_mask:0xf bank_mask:0x3
    v_add_f32_dpp v20, v22, v22 row_ror:8 row_mask:0xf bank_mask:0xc
    v_add_f32_dpp v21, v23, v23 row_ror:8 row_mask:0xf bank_mask:0xc
    s_waitcnt vmcnt(4)
    buffer_load_dwordx4 v[60:63], v1, s[36:39], s44 offen offset:2048 nt
    s_add_u32 s44, s44, 12288
    v_add_f32_dpp v24, v16, v16 row_half_mirror row_mask:0xf bank_mask:0x5
    v_add_f32_dpp v25, v17, v17 row_half_mirror row_mask:0xf bank_mask:0x5
    v_add_f32_dpp v24, v20, v20 row_half_mirror row_mask:0xf bank_mask:0xa
    v_add_f32_dpp v25, v21, v21 row_half_mirror row_mask:0xf bank_mask:0xa
    v_dot2_f32_bf16 v16, v208, v4, 0
    v_dot2_f32_bf16 v17, v212, v4, 0
    v_dot2_f32_bf16 v18, v216, v4, 0
    v_dot2_f32_bf16 v19, v220, v4, 0
    v_dot2c_f32_bf16 v16, v209, v5
    v_dot2c_f32_bf16 v17, v213, v5
    v_dot2c_f32_bf16 v18, v217, v5
    v_dot2c_f32_bf16 v19, v221, v5
    s_waitcnt vmcnt(4)
    buffer_load_dwordx4 v[64:67], v1, s[36:39], s44 offen offset:0 nt
    v_dot2c_f32_bf16 v16, v210, v6
    v_dot2c_f32_bf16 v17, v214, v6
    v_dot2c_f32_bf16 v18, v218, v6
    v_dot2c_f32_bf16 v19, v222, v6
    v_dot2c_f32_bf16 v16, v211, v7
    v_dot2c_f32_bf16 v17, v215, v7
    v_dot2c_f32_bf16 v18, v219, v7
    v_dot2c_f32_bf16 v19, v223, v7
    v_add_f32_dpp v16, v16, v16 row_ror:8 row_mask:0xf bank_mask:0x3
    v_add_f32_dpp v17, v17, v17 row_ror:8 row_mask:0xf bank_mask:0x3
    v_add_f32_dpp v16, v18, v18 row_ror:8 row_mask:0xf bank_mask:0xc
    v_add_f32_dpp v17, v19, v19 row_ror:8 row_mask:0xf bank_mask:0xc
    s_waitcnt vmcnt(4)
    buffer_load_dwordx4 v[68:71], v1, s[36:39], s44 offen offset:2048 nt
    s_add_u32 s44, s44, 4096
    v_dot2_f32_bf16 v20, v224, v4, 0
    v_dot2_f32_bf16 v21, v228, v4, 0
    v_dot2_f32_bf16 v22, v232, v4, 0
    v_dot2_f32_bf16 v23, v236, v4, 0
    v_dot2c_f32_bf16 v20, v225, v5
    v_dot2c_f32_bf16 v21, v229, v5
    v_dot2c_f32_bf16 v22, v233, v5
    v_dot2c_f32_bf16 v23, v237, v5
    v_dot2c_f32_bf16 v20, v226, v6
    v_dot2c_f32_bf16 v21, v230, v6
    v_dot2c_f32_bf16 v22, v234, v6
    v_dot2c_f32_bf16 v23, v238, v6
    v_dot2c_f32_bf16 v20, v227, v7
    s_waitcnt vmcnt(4)
    buffer_load_dwordx4 v[72:75], v1, s[36:39], s44 offen offset:0 nt
    v_dot2c_f32_bf16 v21, v231, v7
    v_dot2c_f32_bf16 v22, v235, v7
    v_dot2c_f32_bf16 v23, v239, v7
    v_add_f32_dpp v20, v20, v20 row_ror:8 row_mask:0xf bank_mask:0x3
    v_add_f32_dpp v21, v21, v21 row_ror:8 row_mask:0xf bank_mask:0x3
    v_add_f32_dpp v20, v22, v22 row_ror:8 row_mask:0xf bank_mask:0xc
    v_add_f32_dpp v21, v23, v23 row_ror:8 row_mask:0xf bank_mask:0xc
    v_add_f32_dpp v18, v16, v16 row_half_mirror row_mask:0xf bank_mask:0x5
    v_add_f32_dpp v19, v17, v17 row_half_mirror row_mask:0xf bank_mask:0x5
    v_add_f32_dpp v18, v20, v20 row_half_mirror row_mask:0xf bank_mask:0xa
    v_add_f32_dpp v19, v21, v21 row_half_mirror row_mask:0xf bank_mask:0xa
    v_cndmask_b32 v32, v24, v18, s[58:59]
    v_cndmask_b32 v33, v18, v24, s[58:59]
    s_waitcnt vmcnt(4)
    buffer_load_dwordx4 v[76:79], v1, s[36:39], s44 offen offset:2048 nt
    s_add_u32 s44, s44, 12288
    s_and_b32 s44, s44, 0xfffff
    v_cndmask_b32 v34, v25, v19, s[58:59]
    v_cndmask_b32 v35, v19, v25, s[58:59]
    v_add_f32_dpp v22, v33, v32 quad_perm:[1,0,3,2] row_mask:0xf bank_mask:0xf
    s_nop 0
    v_add_f32_dpp v23, v35, v34 quad_perm:[1,0,3,2] row_mask:0xf bank_mask:0xf
    v_cndmask_b32 v32, v26, v22, s[60:61]
    v_cndmask_b32 v33, v22, v26, s[60:61]
    v_cndmask_b32 v34, v27, v23, s[60:61]
    v_cndmask_b32 v35, v23, v27, s[60:61]
    v_add_f32_dpp v28, v33, v32 quad_perm:[2,3,0,1] row_mask:0xf bank_mask:0xf
    s_nop 0
    v_add_f32_dpp v29, v35, v34 quad_perm:[2,3,0,1] row_mask:0xf bank_mask:0xf
    ds_write_b64 v2, v[28:29]
    v_max3_f32 v30, v28, v29, v30
    v_add_u32 v2, 0x200, v2
    s_mov_b32 s45, 3
L_topK:
    s_add_u32 s56, s56, s55
    s_cmp_ge_u32 s56, 9
    s_cbranch_scc1 L_BK
L_AK:
    s_waitcnt vmcnt(4)
    buffer_load_dwordx4 v[112:115], v1, s[36:39], s44 offen offset:0 nt
    v_dot2_f32_bf16 v16, v48, v4, 0
    v_dot2_f32_bf16 v17, v52, v4, 0
    v_dot2_f32_bf16 v18, v56, v4, 0
    v_dot2_f32_bf16 v19, v60, v4, 0
    v_dot2c_f32_bf16 v16, v49, v5
    s_waitcnt vmcnt(4)
    buffer_load_dwordx4 v[116:119], v1, s[36:39], s44 offen offset:2048 nt
    s_add_u32 s44, s44, 4096
    v_dot2c_f32_bf16 v17, v53, v5
    v_dot2c_f32_bf16 v18, v57, v5
    v_dot2c_f32_bf16 v19, v61, v5
    v_dot2c_f32_bf16 v16, v50, v6
    v_dot2c_f32_bf16 v17, v54, v6
    v_dot2c_f32_bf16 v18, v58, v6
    s_waitcnt vmcnt(4)
    buffer_load_dwordx4 v[120:123], v1, s[36:39], s44 offen offset:0 nt
    v_dot2c_f32_bf16 v19, v62, v6
    v_dot2c_f32_bf16 v16, v51, v7
    v_dot2c_f32_bf16 v17, v55, v7
    v_dot2c_f32_bf16 v18, v59, v7
    v_dot2c_f32_bf16 v19, v63, v7
    v_add_f32_dpp v16, v16, v16 row_ror:8 row_mask:0xf bank_mask:0x3
    s_waitcnt vmcnt(4)
    buffer_load_dwordx4 v[124:127], v1, s[36:39], s44 offen offset:2048 nt
    s_add_u32 s44, s44, 12288
    v_add_f32_dpp v17, v17, v17 row_ror:8 row_mask:0xf bank_mask:0x3
    v_add_f32_dpp v16, v18, v18 row_ror:8 row_mask:0xf bank_mask:0xc
    v_add_f32_dpp v17, v19, v19 row_ror:8 row_mask:0xf bank_mask:0xc
    s_waitcnt vmcnt(4)
    buffer_load_dwordx4 v[128:131], v1, s[36:39], s44 offen offset:0 nt
    v_dot2_f32_bf16 v20, v64, v4, 0
    v_dot2_f32_bf16 v21, v68, v4, 0
    v_dot2_f32_bf16 v22, v72, v4, 0
    v_dot2_f32_bf16 v23, v76, v4, 0
    v_dot2c_f32_bf16 v20, v65, v5
    v_dot2c_f32_bf16 v21, v69, v5
    s_waitcnt vmcnt(4)
    buffer_load_dwordx4 v[132:135], v1, s[36:39], s44 offen offset:2048 nt
    s_add_u32 s44, s44, 4096
    v_dot2c_f32_bf16 v22, v73, v5
    v_dot2c_f32_bf16 v23, v77, v5
    v_dot2c_f32_bf16 v20, v66, v6
    v_dot2c_f32_bf16 v21, v70, v6
    v_dot2c_f32_bf16 v22, v74, v6
    v_dot2c_f32_bf16 v23, v78, v6
    s_waitcnt vmcnt(4)
    buffer_load_dwordx4 v[136:139], v1, s[36:39], s44 offen offset:0 nt
    v_dot2c_f32_bf16 v20, v67, v7
    v_dot2c_f32_bf16 v21, v71, v7
    v_dot2c_f32_bf16 v22, v75, v7
    v_dot2c_f32_bf16 v23, v79, v7
    v_add_f32_dpp v20, v20, v20 row_ror:8 row_mask:0xf bank_mask:0x3
    v_add_f32_dpp v21, v21, v21 row_ror:8 row_mask:0xf bank_mask:0x3
    s_waitcnt vmcnt(4)
    buffer_load_dwordx4 v[140:143], v1, s[36:39], s44 offen offset:2048 nt
    s_add_u32 s44, s44, 12288
    s_and_b32 s44, s44, 0xfffff
    v_add_f32_dpp v20, v22, v22 row_ror:8 row_mask:0xf bank_mask:0xc
    v_add_f32_dpp v21, v23, v23 row_ror:8 row_mask:0xf bank_mask:0xc
    v_add_f32_dpp v24, v16, v16 row_half_mirror row_mask:0xf bank_mask:0x5
    v_add_f32_dpp v25, v17, v17 row_half_mirror row_mask:0xf bank_mask:0x5
    v_add_f32_dpp v24, v20, v20 row_half_mirror row_mask:0xf bank_mask:0xa
    v_add_f32_dpp v25, v21, v21 row_half_mirror row_mask:0xf bank_mask:0xa
    s_waitcnt vmcnt(4)
    buffer_load_dwordx4 v[48:51], v1, s[36:39], s44 offen offset:0 nt
    v_dot2_f32_bf16 v16, v112, v4, 0
    v_dot2_f32_bf16 v17, v116, v4, 0
    v_dot2_f32_bf16 v18, v120, v4, 0
    v_dot2_f32_bf16 v19, v124, v4, 0
    v_dot2c_f32_bf16 v16, v113, v5
    v_dot2c_f32_bf16 v17, v117, v5
    s_waitcnt vmcnt(4)
    buffer_load_dwordx4 v[52:55], v1, s[36:39], s44 offen offset:2048 nt
    s_add_u32 s44, s44, 4096
    v_dot2c_f32_bf16 v18, v121, v5
    v_dot2c_f32_bf16 v19, v125, v5
    v_dot2c_f32_bf16 v16, v114, v6
    v_dot2c_f32_bf16 v17, v118, v6
    v_dot2c_f32_bf16 v18, v122, v6
    v_dot2c_f32_bf16 v19, v126, v6
    v_dot2c_f32_bf16 v16, v115, v7
    s_waitcnt vmcnt(4)
    buffer_load_dwordx4 v[56:59], v1, s[36:39], s44 offen offset:0 nt
    v_dot2c_f32_bf16 v17, v119, v7
    v_dot2c_f32_bf16 v18, v123, v7
    v_dot2c_f32_bf16 v19, v127, v7
    v_add_f32_dpp v16, v16, v16 row_ror:8 row_mask:0xf bank_mask:0x3
    v_add_f32_dpp v17, v17, v17 row_ror:8 row_mask:0xf bank_mask:0x3
    v_add_f32_dpp v16, v18, v18 row_ror:8 row_mask:0xf bank_mask:0xc
    v_add_f32_dpp v17, v19, v19 row_ror:8 row_mask:0xf bank_mask:0xc
    s_waitcnt vmcnt(4)
    buffer_load_dwordx4 v[60:63], v1, s[36:39], s44 offen offset:2048 nt
    s_add_u32 s44, s44, 12288
    s_waitcnt vmcnt(4)
    buffer_load_dwordx4 v[64:67], v1, s[36:39], s44 offen offset:0 nt
    v_dot2_f32_bf16 v20, v128, v4, 0
    v_dot2_f32_bf16 v21, v132, v4, 0
    v_dot2_f32_bf16 v22, v136, v4, 0
    v_dot2_f32_bf16 v23, v140, v4, 0
    v_dot2c_f32_bf16 v20, v129, v5
    v_dot2c_f32_bf16 v21, v133, v5
    v_dot2c_f32_bf16 v22, v137, v5
    s_waitcnt vmcnt(4)
    buffer_load_dwordx4 v[68:71], v1, s[36:39], s44 offen offset:2048 nt
    s_add_u32 s44, s44, 4096
    v_dot2c_f32_bf16 v23, v141, v5
    v_dot2c_f32_bf16 v20, v130, v6
    v_dot2c_f32_bf16 v21, v134, v6
    v_dot2c_f32_bf16 v22, v138, v6
    v_dot2c_f32_bf16 v23, v142, v6
    v_dot2c_f32_bf16 v20, v131, v7
    v_dot2c_f32_bf16 v21, v135, v7
    v_dot2c_f32_bf16 v22, v139, v7
    s_waitcnt vmcnt(4)
    buffer_load_dwordx4 v[72:75], v1, s[36:39], s44 offen offset:0 nt
    v_dot2c_f32_bf16 v23, v143, v7
    v_add_f32_dpp v20, v20, v20 row_ror:8 row_mask:0xf bank_mask:0x3
    v_add_f32_dpp v21, v21, v21 row_ror:8 row_mask:0xf bank_mask:0x3
    v_add_f32_dpp v20, v22, v22 row_ror:8 row_mask:0xf bank_mask:0xc
    v_add_f32_dpp v21, v23, v23 row_ror:8 row_mask:0xf bank_mask:0xc
    v_add_f32_dpp v18, v16, v16 row_half_mirror row_mask:0xf bank_mask:0x5
    v_add_f32_dpp v19, v17, v17 row_half_mirror row_mask:0xf bank_mask:0x5
    v_add_f32_dpp v18, v20, v20 row_half_mirror row_mask:0xf bank_mask:0xa
    s_waitcnt vmcnt(4)
    buffer_load_dwordx4 v[76:79], v1, s[36:39], s44 offen offset:2048 nt
    s_add_u32 s44, s44, 12288
    s_and_b32 s44, s44, 0xfffff
    v_add_f32_dpp v19, v21, v21 row_half_mirror row_mask:0xf bank_mask:0xa
    v_cndmask_b32 v32, v24, v18, s[58:59]
    v_cndmask_b32 v33, v18, v24, s[58:59]
    v_cndmask_b32 v34, v25, v19, s[58:59]
    v_cndmask_b32 v35, v19, v25, s[58:59]
    v_add_f32_dpp v26, v33, v32 quad_perm:[1,0,3,2] row_mask:0xf bank_mask:0xf
    s_nop 0
    v_add_f32_dpp v27, v35, v34 quad_perm:[1,0,3,2] row_mask:0xf bank_mask:0xf
    s_waitcnt vmcnt(4)
    buffer_load_dwordx4 v[112:115], v1, s[36:39], s44 offen offset:0 nt
    v_dot2_f32_bf16 v16, v48, v4, 0
    v_dot2_f32_bf16 v17, v52, v4, 0
    v_dot2_f32_bf16 v18, v56, v4, 0
    v_dot2_f32_bf16 v19, v60, v4, 0
    v_dot2c_f32_bf16 v16, v49, v5
    s_waitcnt vmcnt(4)
    buffer_load_dwordx4 v[116:119], v1, s[36:39], s44 offen offset:2048 nt
    s_add_u32 s44, s44, 4096
    v_dot2c_f32_bf16 v17, v53, v5
    v_dot2c_f32_bf16 v18, v57, v5
    v_dot2c_f32_bf16 v19, v61, v5
    v_dot2c_f32_bf16 v16, v50, v6
    v_dot2c_f32_bf16 v17, v54, v6
    v_dot2c_f32_bf16 v18, v58, v6
    s_waitcnt vmcnt(4)
    buffer_load_dwordx4 v[120:123], v1, s[36:39], s44 offen offset:0 nt
    v_dot2c_f32_bf16 v19, v62, v6
    v_dot2c_f32_bf16 v16, v51, v7
    v_dot2c_f32_bf16 v17, v55, v7
    v_dot2c_f32_bf16 v18, v59, v7
    v_dot2c_f32_bf16 v19, v63, v7
    v_add_f32_dpp v16, v16, v16 row_ror:8 row_mask:0xf bank_mask:0x3
    s_waitcnt vmcnt(4)
    buffer_load_dwordx4 v[124:127], v1, s[36:39], s44 offen offset:2048 nt
    s_add_u32 s44, s44, 12288
    v_add_f32_dpp v17, v17, v17 row_ror:8 row_mask:0xf bank_mask:0x3
    v_add_f32_dpp v16, v18, v18 row_ror:8 row_mask:0xf bank_mask:0xc
    v_add_f32_dpp v17, v19, v19 row_ror:8 row_mask:0xf bank_mask:0xc
    s_waitcnt vmcnt(4)
    buffer_load_dwordx4 v[128:131], v1, s[36:39], s44 offen offset:0 nt
    v_dot2_f32_bf16 v20, v64, v4, 0
    v_dot2_f32_bf16 v21, v68, v4, 0
    v_dot2_f32_bf16 v22, v72, v4, 0
    v_dot2_f32_bf16 v23, v76, v4, 0
    v_dot2c_f32_bf16 v20, v65, v5
    v_dot2c_f32_bf16 v21, v69, v5
    s_waitcnt vmcnt(4)
    buffer_load_dwordx4 v[132:135], v1, s[36:39], s44 offen offset:2048 nt
    s_add_u32 s44, s44, 4096
    v_dot2c_f32_bf16 v22, v73, v5
    v_dot2c_f32_bf16 v23, v77, v5
    v_dot2c_f32_bf16 v20, v66, v6
    v_dot2c_f32_bf16 v21, v70, v6
    v_dot2c_f32_bf16 v22, v74, v6
    v_dot2c_f32_bf16 v23, v78, v6
    s_waitcnt vmcnt(4)
    buffer_load_dwordx4 v[136:139], v1, s[36:39], s44 offen offset:0 nt
    v_dot2c_f32_bf16 v20, v67, v7
    v_dot2c_f32_bf16 v21, v71, v7
    v_dot2c_f32_bf16 v22, v75, v7
    v_dot2c_f32_bf16 v23, v79, v7
    v_add_f32_dpp v20, v20, v20 row_ror:8 row_mask:0xf bank_mask:0x3
    v_add_f32_dpp v21, v21, v21 row_ror:8 row_mask:0xf bank_mask:0x3
    s_waitcnt vmcnt(4)
    buffer_load_dwordx4 v[140:143], v1, s[36:39], s44 offen offset:2048 nt
    s_add_u32 s44, s44, 12288
    s_and_b32 s44, s44, 0xfffff
    v_add_f32_dpp v20, v22, v22 row_ror:8 row_mask:0xf bank_mask:0xc
    v_add_f32_dpp v21, v23, v23 row_ror:8 row_mask:0xf bank_mask:0xc
    v_add_f32_dpp v24, v16, v16 row_half_mirror row_mask:0xf bank_mask:0x5
    v_add_f32_dpp v25, v17, v17 row_half_mirror row_mask:0xf bank_mask:0x5
    v_add_f32_dpp v24, v20, v20 row_half_mirror row_mask:0xf bank_mask:0xa
    v_add_f32_dpp v25, v21, v21 row_half_mirror row_mask:0xf bank_mask:0xa
    s_waitcnt vmcnt(4)
    buffer_load_dwordx4 v[48:51], v1, s[36:39], s44 offen offset:0 nt
    v_dot2_f32_bf16 v16, v112, v4, 0
    v_dot2_f32_bf16 v17, v116, v4, 0
    v_dot2_f32_bf16 v18, v120, v4, 0
    v_dot2_f32_bf16 v19, v124, v4, 0
    v_dot2c_f32_bf16 v16, v113, v5
    v_dot2c_f32_bf16 v17, v117, v5
    v_dot2c_f32_bf16 v18, v121, v5
    s_waitcnt vmcnt(4)
    buffer_load_dwordx4 v[52:55], v1, s[36:39], s44 offen offset:2048 nt
    s_add_u32 s44, s44, 4096
    v_dot2c_f32_bf16 v19, v125, v5
    v_dot2c_f32_bf16 v16, v114, v6
    v_dot2c_f32_bf16 v17, v118, v6
    v_dot2c_f32_bf16 v18, v122, v6
    v_dot2c_f32_bf16 v19, v126, v6
    v_dot2c_f32_bf16 v16, v115, v7
    v_dot2c_f32_bf16 v17, v119, v7
    v_dot2c_f32_bf16 v18, v123, v7
    s_waitcnt vmcnt(4)
    buffer_load_dwordx4 v[56:59], v1, s[36:39], s44 offen offset:0 nt
    v_dot2c_f32_bf16 v19, v127, v7
    v_add_f32_dpp v16, v16, v16 row_ror:8 row_mask:0xf bank_mask:0x3
    v_add_f32_dpp v17, v17, v17 row_ror:8 row_mask:0xf bank_mask:0x3
    v_add_f32_dpp v16, v18, v18 row_ror:8 row_mask:0xf bank_mask:0xc
    v_add_f32_dpp v17, v19, v19 row_ror:8 row_mask:0xf bank_mask:0xc
    s_waitcnt vmcnt(4)
    buffer_load_dwordx4 v[60:63], v1, s[36:39], s44 offen offset:2048 nt
    s_add_u32 s44, s44, 12288
    s_waitcnt vmcnt(4)
    buffer_load_dwordx4 v[64:67], v1, s[36:39], s44 offen offset:0 nt
    v_dot2_f32_bf16 v20, v128, v4, 0
    v_dot2_f32_bf16 v21, v132, v4, 0
    v_dot2_f32_bf16 v22, v136, v4, 0
    v_dot2_f32_bf16 v23, v140, v4, 0
    v_dot2c_f32_bf16 v20, v129, v5
    v_dot2c_f32_bf16 v21, v133, v5
    v_dot2c_f32_bf16 v22, v137, v5
    v_dot2c_f32_bf16 v23, v141, v5
    v_dot2c_f32_bf16 v20, v130, v6
    s_waitcnt vmcnt(4)
    buffer_load_dwordx4 v[68:71], v1, s[36:39], s44 offen offset:2048 nt
    s_add_u32 s44, s44, 4096
    v_dot2c_f32_bf16 v21, v134, v6
    v_dot2c_f32_bf16 v22, v138, v6
    v_dot2c_f32_bf16 v23, v142, v6
    v_dot2c_f32_bf16 v20, v131, v7
    v_dot2c_f32_bf16 v21, v135, v7
    v_dot2c_f32_bf16 v22, v139, v7
    v_dot2c_f32_bf16 v23, v143, v7
    v_add_f32_dpp v20, v20, v20 row_ror:8 row_mask:0xf bank_mask:0x3
    v_add_f32_dpp v21, v21, v21 row_ror:8 row_mask:0xf bank_mask:0x3
    v_add_f32_dpp v20, v22, v22 row_ror:8 row_mask:0xf bank_mask:0xc
    s_waitcnt vmcnt(4)
    buffer_load_dwordx4 v[72:75], v1, s[36:39], s44 offen offset:0 nt
    v_add_f32_dpp v21, v23, v23 row_ror:8 row_mask:0xf bank_mask:0xc
    v_add_f32_dpp v18, v16, v16 row_half_mirror row_mask:0xf bank_mask:0x5
    v_add_f32_dpp v19, v17, v17 row_half_mirror row_mask:0xf bank_mask:0x5
    v_add_f32_dpp v18, v20, v20 row_half_mirror row_mask:0xf bank_mask:0xa
    v_add_f32_dpp v19, v21, v21 row_half_mirror row_mask:0xf bank_mask:0xa
    v_cndmask_b32 v32, v24, v18, s[58:59]
    v_cndmask_b32 v33, v18, v24, s[58:59]
    v_cndmask_b32 v34, v25, v19, s[58:59]
    v_cndmask_b32 v35, v19, v25, s[58:59]
    v_add_f32_dpp v22, v33, v32 quad_perm:[1,0,3,2] row_mask:0xf bank_mask:0xf
    s_waitcnt vmcnt(4)
    buffer_load_dwordx4 v[76:79], v1, s[36:39], s44 offen offset:2048 nt
    s_add_u32 s44, s44, 12288
    s_and_b32 s44, s44, 0xfffff
    v_add_f32_dpp v23, v35, v34 quad_perm:[1,0,3,2] row_mask:0xf bank_mask:0xf
    v_cndmask_b32 v32, v26, v22, s[60:61]
    v_cndmask_b32 v33, v22, v26, s[60:61]
    v_cndmask_b32 v34, v27, v23, s[60:61]
    v_cndmask_b32 v35, v23, v27, s[60:61]
    v_add_f32_dpp v28, v33, v32 quad_perm:[2,3,0,1] row_mask:0xf bank_mask:0xf
    s_nop 0
    v_add_f32_dpp v29, v35, v34 quad_perm:[2,3,0,1] row_mask:0xf bank_mask:0xf
    ds_write_b64 v2, v[28:29]
    v_max3_f32 v30, v28, v29, v30
    v_add_u32 v2, 0x200, v2
    s_sub_u32 s45, s45, 1
    s_cmp_lg_u32 s45, 0
    s_cbranch_scc1 L_topK
    s_branch L_xK
L_BK:
    s_sub_u32 s56, s56, 9
    s_waitcnt vmcnt(4)
    buffer_load_dwordx4 v[112:115], v1, s[36:39], s44 offen offset:0 nt
    v_dot2_f32_bf16 v16, v48, v4, 0
    v_dot2_f32_bf16 v17, v52, v4, 0
    v_dot2_f32_bf16 v18, v56, v4, 0
    v_dot2_f32_bf16 v19, v60, v4, 0
    v_dot2c_f32_bf16 v16, v49, v5
    buffer_load_dwordx4 v[116:119], v1, s[36:39], s44 offen offset:2048 nt
    s_add_u32 s44, s44, 4096
    v_dot2c_f32_bf16 v17, v53, v5
    v_dot2c_f32_bf16 v18, v57, v5
    v_dot2c_f32_bf16 v19, v61, v5
    v_dot2c_f32_bf16 v16, v50, v6
    v_dot2c_f32_bf16 v17, v54, v6
    v_dot2c_f32_bf16 v18, v58, v6
    s_waitcnt vmcnt(4)
    buffer_load_dwordx4 v[120:123], v1, s[36:39], s44 offen offset:0 nt
    v_dot2c_f32_bf16 v19, v62, v6
    v_dot2c_f32_bf16 v16, v51, v7
    v_dot2c_f32_bf16 v17, v55, v7
    v_dot2c_f32_bf16 v18, v59, v7
    v_dot2c_f32_bf16 v19, v63, v7
    v_add_f32_dpp v16, v16, v16 row_ror:8 row_mask:0xf bank_mask:0x3
    buffer_load_dwordx4 v[124:127], v1, s[36:39], s44 offen offset:2048 nt
    s_add_u32 s44, s44, 12288
    v_add_f32_dpp v17, v17, v17 row_ror:8 row_mask:0xf bank_mask:0x3
    v_add_f32_dpp v16, v18, v18 row_ror:8 row_mask:0xf bank_mask:0xc
    v_add_f32_dpp v17, v19, v19 row_ror:8 row_mask:0xf bank_mask:0xc
    s_waitcnt vmcnt(4)
    buffer_load_dwordx4 v[128:131], v1, s[36:39], s44 offen offset:0 nt
    v_dot2_f32_bf16 v20, v64, v4, 0
    v_dot2_f32_bf16 v21, v68, v4, 0
    v_dot2_f32_bf16 v22, v72, v4, 0
    v_dot2_f32_bf16 v23, v76, v4, 0
    v_dot2c_f32_bf16 v20, v65, v5
    v_dot2c_f32_bf16 v21, v69, v5
    buffer_load_dwordx4 v[132:135], v1, s[36:39], s44 offen offset:2048 nt
    s_add_u32 s44, s44, 4096
    v_dot2c_f32_bf16 v22, v73, v5
    v_dot2c_f32_bf16 v23, v77, v5
    v_dot2c_f32_bf16 v20, v66, v6
    v_dot2c_f32_bf16 v21, v70, v6
    v_dot2c_f32_bf16 v22, v74, v6
    v_dot2c_f32_bf16 v23, v78, v6
    s_waitcnt vmcnt(4)
    buffer_load_dwordx4 v[136:139], v1, s[36:39], s44 offen offset:0 nt
    v_dot2c_f32_bf16 v20, v67, v7
    v_dot2c_f32_bf16 v21, v71, v7
    v_dot2c_f32_bf16 v22, v75, v7
    v_dot2c_f32_bf16 v23, v79, v7
    v_add_f32_dpp v20, v20, v20 row_ror:8 row_mask:0xf bank_mask:0x3
    v_add_f32_dpp v21, v21, v21 row_ror:8 row_mask:0xf bank_mask:0x3
    buffer_load_dwordx4 v[140:143], v1, s[36:39], s44 offen offset:2048 nt
    s_add_u32 s44, s44, 12288
    s_and_b32 s44, s44, 0xfffff
    v_add_f32_dpp v20, v22, v22 row_ror:8 row_mask:0xf bank_mask:0xc
    v_add_f32_dpp v21, v23, v23 row_ror:8 row_mask:0xf bank_mask:0xc
    v_add_f32_dpp v24, v16, v16 row_half_mirror row_mask:0xf bank_mask:0x5
    v_add_f32_dpp v25, v17, v17 row_half_mirror row_mask:0xf bank_mask:0x5
    v_add_f32_dpp v24, v20, v20 row_half_mirror row_mask:0xf bank_mask:0xa
    v_add_f32_dpp v25, v21, v21 row_half_mirror row_mask:0xf bank_mask:0xa
    s_waitcnt vmcnt(4)
    buffer_load_dwordx4 v[48:51], v1, s[36:39], s44 offen offset:0 nt
    v_dot2_f32_bf16 v16, v112, v4, 0
    v_dot2_f32_bf16 v17, v116, v4, 0
    v_dot2_f32_bf16 v18, v120, v4, 0
    v_dot2_f32_bf16 v19, v124, v4, 0
    v_dot2c_f32_bf16 v16, v113, v5
    v_dot2c_f32_bf16 v17, v117, v5
    buffer_load_dwordx4 v[52:55], v1, s[36:39], s44 offen offset:2048 nt
    s_add_u32 s44, s44, 4096
    v_dot2c_f32_bf16 v18, v121, v5
    v_dot2c_f32_bf16 v19, v125, v5
    v_dot2c_f32_bf16 v16, v114, v6
    v_dot2c_f32_bf16 v17, v118, v6
    v_dot2c_f32_bf16 v18, v122, v6
    v_dot2c_f32_bf16 v19, v126, v6
    v_dot2c_f32_bf16 v16, v115, v7
    s_waitcnt vmcnt(4)
    buffer_load_dwordx4 v[56:59], v1, s[36:39], s44 offen offset:0 nt
    v_dot2c_f32_bf16 v17, v119, v7
    v_dot2c_f32_bf16 v18, v123, v7
    v_dot2c_f32_bf16 v19, v127, v7
    v_add_f32_dpp v16, v16, v16 row_ror:8 row_mask:0xf bank_mask:0x3
    v_add_f32_dpp v17, v17, v17 row_ror:8 row_mask:0xf bank_mask:0x3
    v_add_f32_dpp v16, v18, v18 row_ror:8 row_mask:0xf bank_mask:0xc
    v_add_f32_dpp v17, v19, v19 row_ror:8 row_mask:0xf bank_mask:0xc
    buffer_load_dwordx4 v[60:63], v1, s[36:39], s44 offen offset:2048 nt
    s_add_u32 s44, s44, 12288
    s_waitcnt vmcnt(4)
    buffer_load_dwordx4 v[64:67], v1, s[36:39], s44 offen offset:0 nt
    v_dot2_f32_bf16 v20, v128, v4, 0
    v_dot2_f32_bf16 v21, v132, v4, 0
    v_dot2_f32_bf16 v22, v136, v4, 0
    v_dot2_f32_bf16 v23, v140, v4, 0
    v_dot2c_f32_bf16 v20, v129, v5
    v_dot2c_f32_bf16 v21, v133, v5
    v_dot2c_f32_bf16 v22, v137, v5
    buffer_load_dwordx4 v[68:71], v1, s[36:39], s44 offen offset:2048 nt
    s_add_u32 s44, s44, 4096
    v_dot2c_f32_bf16 v23, v141, v5
    v_dot2c_f32_bf16 v20, v130, v6
    v_dot2c_f32_bf16 v21, v134, v6
    v_dot2c_f32_bf16 v22, v138, v6
    v_dot2c_f32_bf16 v23, v142, v6
    v_dot2c_f32_bf16 v20, v131, v7
    v_dot2c_f32_bf16 v21, v135, v7
    v_dot2c_f32_bf16 v22, v139, v7
    s_waitcnt vmcnt(4)
    buffer_load_dwordx4 v[72:75], v1, s[36:39], s44 offen offset:0 nt
    v_dot2c_f32_bf16 v23, v143, v7
    v_add_f32_dpp v20, v20, v20 row_ror:8 row_mask:0xf bank_mask:0x3
    v_add_f32_dpp v21, v21, v21 row_ror:8 row_mask:0xf bank_mask:0x3
    v_add_f32_dpp v20, v22, v22 row_ror:8 row_mask:0xf bank_mask:0xc
    v_add_f32_dpp v21, v23, v23 row_ror:8 row_mask:0xf bank_mask:0xc
    v_add_f32_dpp v18, v16, v16 row_half_mirror row_mask:0xf bank_mask:0x5
    v_add_f32_dpp v19, v17, v17 row_half_mirror row_mask:0xf bank_mask:0x5
    v_add_f32_dpp v18, v20, v20 row_half_mirror row_mask:0xf bank_mask:0xa
    buffer_load_dwordx4 v[76:79], v1, s[36:39], s44 offen offset:2048 nt
    s_add_u32 s44, s44, 12288
    s_and_b32 s44, s44, 0xfffff
    v_add_f32_dpp v19, v21, v21 row_half_mirror row_mask:0xf bank_mask:0xa
    v_cndmask_b32 v32, v24, v18, s[58:59]
    v_cndmask_b32 v33, v18, v24, s[58:59]
    v_cndmask_b32 v34, v25, v19, s[58:59]
    v_cndmask_b32 v35, v19, v25, s[58:59]
    v_add_f32_dpp v26, v33, v32 quad_perm:[1,0,3,2] row_mask:0xf bank_mask:0xf
    s_nop 0
    v_add_f32_dpp v27, v35, v34 quad_perm:[1,0,3,2] row_mask:0xf bank_mask:0xf
    s_waitcnt vmcnt(4)
    buffer_load_dwordx4 v[112:115], v1, s[36:39], s44 offen offset:0 nt
    v_dot2_f32_bf16 v16, v48, v4, 0
    v_dot2_f32_bf16 v17, v52, v4, 0
    v_dot2_f32_bf16 v18, v56, v4, 0
    v_dot2_f32_bf16 v19, v60, v4, 0
    v_dot2c_f32_bf16 v16, v49, v5
    buffer_load_dwordx4 v[116:119], v1, s[36:39], s44 offen offset:2048 nt
    s_add_u32 s44, s44, 4096
    v_dot2c_f32_bf16 v17, v53, v5
    v_dot2c_f32_bf16 v18, v57, v5
    v_dot2c_f32_bf16 v19, v61, v5
    v_dot2c_f32_bf16 v16, v50, v6
    v_dot2c_f32_bf16 v17, v54, v6
    v_dot2c_f32_bf16 v18, v58, v6
    s_waitcnt vmcnt(4)
    buffer_load_dwordx4 v[120:123], v1, s[36:39], s44 offen offset:0 nt
    v_dot2c_f32_bf16 v19, v62, v6
    v_dot2c_f32_bf16 v16, v51, v7
    v_dot2c_f32_bf16 v17, v55, v7
    v_dot2c_f32_bf16 v18, v59, v7
    v_dot2c_f32_bf16 v19, v63, v7
    v_add_f32_dpp v16, v16, v16 row_ror:8 row_mask:0xf bank_mask:0x3
    buffer_load_dwordx4 v[124:127], v1, s[36:39], s44 offen offset:2048 nt
    s_add_u32 s44, s44, 12288
    v_add_f32_dpp v17, v17, v17 row_ror:8 row_mask:0xf bank_mask:0x3
    v_add_f32_dpp v16, v18, v18 row_ror:8 row_mask:0xf bank_mask:0xc
    v_add_f32_dpp v17, v19, v19 row_ror:8 row_mask:0xf bank_mask:0xc
    s_waitcnt vmcnt(4)
    buffer_load_dwordx4 v[128:131], v1, s[36:39], s44 offen offset:0 nt
    v_dot2_f32_bf16 v20, v64, v4, 0
    v_dot2_f32_bf16 v21, v68, v4, 0
    v_dot2_f32_bf16 v22, v72, v4, 0
    v_dot2_f32_bf16 v23, v76, v4, 0
    v_dot2c_f32_bf16 v20, v65, v5
    v_dot2c_f32_bf16 v21, v69, v5
    buffer_load_dwordx4 v[132:135], v1, s[36:39], s44 offen offset:2048 nt
    s_add_u32 s44, s44, 4096
    v_dot2c_f32_bf16 v22, v73, v5
    v_dot2c_f32_bf16 v23, v77, v5
    v_dot2c_f32_bf16 v20, v66, v6
    v_dot2c_f32_bf16 v21, v70, v6
    v_dot2c_f32_bf16 v22, v74, v6
    v_dot2c_f32_bf16 v23, v78, v6
    s_waitcnt vmcnt(4)
    buffer_load_dwordx4 v[136:139], v1, s[36:39], s44 offen offset:0 nt
    v_dot2c_f32_bf16 v20, v67, v7
    v_dot2c_f32_bf16 v21, v71, v7
    v_dot2c_f32_bf16 v22, v75, v7
    v_dot2c_f32_bf16 v23, v79, v7
    v_add_f32_dpp v20, v20, v20 row_ror:8 row_mask:0xf bank_mask:0x3
    v_add_f32_dpp v21, v21, v21 row_ror:8 row_mask:0xf bank_mask:0x3
    buffer_load_dwordx4 v[140:143], v1, s[36:39], s44 offen offset:2048 nt
    s_add_u32 s44, s44, 12288
    s_and_b32 s44, s44, 0xfffff
    v_add_f32_dpp v20, v22, v22 row_ror:8 row_mask:0xf bank_mask:0xc
    v_add_f32_dpp v21, v23, v23 row_ror:8 row_mask:0xf bank_mask:0xc
    v_add_f32_dpp v24, v16, v16 row_half_mirror row_mask:0xf bank_mask:0x5
    v_add_f32_dpp v25, v17, v17 row_half_mirror row_mask:0xf bank_mask:0x5
    v_add_f32_dpp v24, v20, v20 row_half_mirror row_mask:0xf bank_mask:0xa
    v_add_f32_dpp v25, v21, v21 row_half_mirror row_mask:0xf bank_mask:0xa
    s_waitcnt vmcnt(4)
    buffer_load_dwordx4 v[48:51], v1, s[36:39], s44 offen offset:0 nt
    v_dot2_f32_bf16 v16, v112, v4, 0
    v_dot2_f32_bf16 v17, v116, v4, 0
    v_dot2_f32_bf16 v18, v120, v4, 0
    v_dot2_f32_bf16 v19, v124, v4, 0
    v_dot2c_f32_bf16 v16, v113, v5
    v_dot2c_f32_bf16 v17, v117, v5
    v_dot2c_f32_bf16 v18, v121, v5
    buffer_load_dwordx4 v[52:55], v1, s[36:39], s44 offen offset:2048 nt
    s_add_u32 s44, s44, 4096
    v_dot2c_f32_bf16 v19, v125, v5
    v_dot2c_f32_bf16 v16, v114, v6
    v_dot2c_f32_bf16 v17, v118, v6
    v_dot2c_f32_bf16 v18, v122, v6
    v_dot2c_f32_bf16 v19, v126, v6
    v_dot2c_f32_bf16 v16, v115, v7
    v_dot2c_f32_bf16 v17, v119, v7
    v_dot2c_f32_bf16 v18, v123, v7
    s_waitcnt vmcnt(4)
    buffer_load_dwordx4 v[56:59], v1, s[36:39], s44 offen offset:0 nt
    v_dot2c_f32_bf16 v19, v127, v7
    v_add_f32_dpp v16, v16, v16 row_ror:8 row_mask:0xf bank_mask:0x3
    v_add_f32_dpp v17, v17, v17 row_ror:8 row_mask:0xf bank_mask:0x3
    v_add_f32_dpp v16, v18, v18 row_ror:8 row_mask:0xf bank_mask:0xc
    v_add_f32_dpp v17, v19, v19 row_ror:8 row_mask:0xf bank_mask:0xc
    buffer_load_dwordx4 v[60:63], v1, s[36:39], s44 offen offset:2048 nt
    s_add_u32 s44, s44, 12288
    s_waitcnt vmcnt(4)
    buffer_load_dwordx4 v[64:67], v1, s[36:39], s44 offen offset:0 nt
    v_dot2_f32_bf16 v20, v128, v4, 0
    v_dot2_f32_bf16 v21, v132, v4, 0
    v_dot2_f32_bf16 v22, v136, v4, 0
    v_dot2_f32_bf16 v23, v140, v4, 0
    v_dot2c_f32_bf16 v20, v129, v5
    v_dot2c_f32_bf16 v21, v133, v5
    v_dot2c_f32_bf16 v22, v137, v5
    v_dot2c_f32_bf16 v23, v141, v5
    v_dot2c_f32_bf16 v20, v130, v6
    buffer_load_dwordx4 v[68:71], v1, s[36:39], s44 offen offset:2048 nt
    s_add_u32 s44, s44, 4096
    v_dot2c_f32_bf16 v21, v134, v6
    v_dot2c_f32_bf16 v22, v138, v6
    v_dot2c_f32_bf16 v23, v142, v6
    v_dot2c_f32_bf16 v20, v131, v7
    v_dot2c_f32_bf16 v21, v135, v7
    v_dot2c_f32_bf16 v22, v139, v7
    v_dot2c_f32_bf16 v23, v143, v7
    v_add_f32_dpp v20, v20, v20 row_ror:8 row_mask:0xf bank_mask:0x3
    v_add_f32_dpp v21, v21, v21 row_ror:8 row_mask:0xf bank_mask:0x3
    v_add_f32_dpp v20, v22, v22 row_ror:8 row_mask:0xf bank_mask:0xc
    s_waitcnt vmcnt(4)
    buffer_load_dwordx4 v[72:75], v1, s[36:39], s44 offen offset:0 nt
    v_add_f32_dpp v21, v23, v23 row_ror:8 row_mask:0xf bank_mask:0xc
    v_add_f32_dpp v18, v16, v16 row_half_mirror row_mask:0xf bank_mask:0x5
    v_add_f32_dpp v19, v17, v17 row_half_mirror row_mask:0xf bank_mask:0x5
    v_add_f32_dpp v18, v20, v20 row_half_mirror row_mask:0xf bank_mask:0xa
    v_add_f32_dpp v19, v21, v21 row_half_mirror row_mask:0xf bank_mask:0xa
    v_cndmask_b32 v32, v24, v18, s[58:59]
    v_cndmask_b32 v33, v18, v24, s[58:59]
    v_cndmask_b32 v34, v25, v19, s[58:59]
    v_cndmask_b32 v35, v19, v25, s[58:59]
    v_add_f32_dpp v22, v33, v32 quad_perm:[1,0,3,2] row_mask:0xf bank_mask:0xf
    buffer_load_dwordx4 v[76:79], v1, s[36:39], s44 offen offset:2048 nt
    s_add_u32 s44, s44, 12288
    s_and_b32 s44, s44, 0xfffff
    v_add_f32_dpp v23, v35, v34 quad_perm:[1,0,3,2] row_mask:0xf bank_mask:0xf
    v_cndmask_b32 v32, v26, v22, s[60:61]
    v_cndmask_b32 v33, v22, v26, s[60:61]
    v_cndmask_b32 v34, v27, v23, s[60:61]
    v_cndmask_b32 v35, v23, v27, s[60:61]
    v_add_f32_dpp v28, v33, v32 quad_perm:[2,3,0,1] row_mask:0xf bank_mask:0xf
    s_nop 0
    v_add_f32_dpp v29, v35, v34 quad_perm:[2,3,0,1] row_mask:0xf bank_mask:0xf
    ds_write_b64 v2, v[28:29]
    v_max3_f32 v30, v28, v29, v30
    v_add_u32 v2, 0x200, v2
    s_sub_u32 s45, s45, 1
    s_cmp_lg_u32 s45, 0
    s_cbranch_scc1 L_topK
L_xK:
    s_waitcnt vmcnt(4)
    buffer_load_dwordx4 v[112:115], v1, s[36:39], s44 offen offset:0 nt
    v_dot2_f32_bf16 v16, v48, v4, 0
    v_dot2_f32_bf16 v17, v52, v4, 0
    v_dot2_f32_bf16 v18, v56, v4, 0
    v_dot2_f32_bf16 v19, v60, v4, 0
    v_dot2c_f32_bf16 v16, v49, v5
    s_waitcnt vmcnt(4)
    buffer_load_dwordx4 v[116:119], v1, s[36:39], s44 offen offset:2048 nt
    s_add_u32 s44, s44, 4096
    v_dot2c_f32_bf16 v17, v53, v5
    v_dot2c_f32_bf16 v18, v57, v5
    v_dot2c_f32_bf16 v19, v61, v5
    v_dot2c_f32_bf16 v16, v50, v6
    v_dot2c_f32_bf16 v17, v54, v6
    v_dot2c_f32_bf16 v18, v58, v6
    s_waitcnt vmcnt(4)
    buffer_load_dwordx4 v[120:123], v1, s[36:39], s44 offen offset:0 nt
    v_dot2c_f32_bf16 v19, v62, v6
    v_dot2c_f32_bf16 v16, v51, v7
    v_dot2c_f32_bf16 v17, v55, v7
    v_dot2c_f32_bf16 v18, v59, v7
    v_dot2c_f32_bf16 v19, v63, v7
    v_add_f32_dpp v16, v16, v16 row_ror:8 row_mask:0xf bank_mask:0x3
    s_waitcnt vmcnt(4)
    buffer_load_dwordx4 v[124:127], v1, s[36:39], s44 offen offset:2048 nt
    s_add_u32 s44, s44, 12288
    v_add_f32_dpp v17, v17, v17 row_ror:8 row_mask:0xf bank_mask:0x3
    v_add_f32_dpp v16, v18, v18 row_ror:8 row_mask:0xf bank_mask:0xc
    v_add_f32_dpp v17, v19, v19 row_ror:8 row_mask:0xf bank_mask:0xc
    s_waitcnt vmcnt(4)
    buffer_load_dwordx4 v[128:131], v1, s[36:39], s44 offen offset:0 nt
    v_dot2_f32_bf16 v20, v64, v4, 0
    v_dot2_f32_bf16 v21, v68, v4, 0
    v_dot2_f32_bf16 v22, v72, v4, 0
    v_dot2_f32_bf16 v23, v76, v4, 0
    v_dot2c_f32_bf16 v20, v65, v5
    v_dot2c_f32_bf16 v21, v69, v5
    s_waitcnt vmcnt(4)
    buffer_load_dwordx4 v[132:135], v1, s[36:39], s44 offen offset:2048 nt
    s_add_u32 s44, s44, 4096
    v_dot2c_f32_bf16 v22, v73, v5
    v_dot2c_f32_bf16 v23, v77, v5
    v_dot2c_f32_bf16 v20, v66, v6
    v_dot2c_f32_bf16 v21, v70, v6
    v_dot2c_f32_bf16 v22, v74, v6
    v_dot2c_f32_bf16 v23, v78, v6
    s_waitcnt vmcnt(4)
    buffer_load_dwordx4 v[136:139], v1, s[36:39], s44 offen offset:0 nt
    v_dot2c_f32_bf16 v20, v67, v7
    v_dot2c_f32_bf16 v21, v71, v7
    v_dot2c_f32_bf16 v22, v75, v7
    v_dot2c_f32_bf16 v23, v79, v7
    v_add_f32_dpp v20, v20, v20 row_ror:8 row_mask:0xf bank_mask:0x3
    v_add_f32_dpp v21, v21, v21 row_ror:8 row_mask:0xf bank_mask:0x3
    s_waitcnt vmcnt(4)
    buffer_load_dwordx4 v[140:143], v1, s[36:39], s44 offen offset:2048 nt
    s_add_u32 s44, s44, 12288
    s_and_b32 s44, s44, 0xfffff
    v_add_f32_dpp v20, v22, v22 row_ror:8 row_mask:0xf bank_mask:0xc
    v_add_f32_dpp v21, v23, v23 row_ror:8 row_mask:0xf bank_mask:0xc
    v_add_f32_dpp v24, v16, v16 row_half_mirror row_mask:0xf bank_mask:0x5
    v_add_f32_dpp v25, v17, v17 row_half_mirror row_mask:0xf bank_mask:0x5
    v_add_f32_dpp v24, v20, v20 row_half_mirror row_mask:0xf bank_mask:0xa
    v_add_f32_dpp v25, v21, v21 row_half_mirror row_mask:0xf bank_mask:0xa
    s_waitcnt vmcnt(4)
    buffer_load_dwordx4 v[176:179], v1, s[36:39], s44 offen offset:0 nt
    v_dot2_f32_bf16 v16, v112, v4, 0
    v_dot2_f32_bf16 v17, v116, v4, 0
    v_dot2_f32_bf16 v18, v120, v4, 0
    v_dot2_f32_bf16 v19, v124, v4, 0
    v_dot2c_f32_bf16 v16, v113, v5
    v_dot2c_f32_bf16 v17, v117, v5
    s_waitcnt vmcnt(4)
    buffer_load_dwordx4 v[180:183], v1, s[36:39], s44 offen offset:2048 nt
    s_add_u32 s44, s44, 4096
    v_dot2c_f32_bf16 v18, v121, v5
    v_dot2c_f32_bf16 v19, v125, v5
    v_dot2c_f32_bf16 v16, v114, v6
    v_dot2c_f32_bf16 v17, v118, v6
    v_dot2c_f32_bf16 v18, v122, v6
    v_dot2c_f32_bf16 v19, v126, v6
    v_dot2c_f32_bf16 v16, v115, v7
    s_waitcnt vmcnt(4)
    buffer_load_dwordx4 v[184:187], v1, s[36:39], s44 offen offset:0 nt
    v_dot2c_f32_bf16 v17, v119, v7
    v_dot2c_f32_bf16 v18, v123, v7
    v_dot2c_f32_bf16 v19, v127, v7
    v_add_f32_dpp v16, v16, v16 row_ror:8 row_mask:0xf bank_mask:0x3
    v_add_f32_dpp v17, v17, v17 row_ror:8 row_mask:0xf bank_mask:0x3
    v_add_f32_dpp v16, v18, v18 row_ror:8 row_mask:0xf bank_mask:0xc
    v_add_f32_dpp v17, v19, v19 row_ror:8 row_mask:0xf bank_mask:0xc
    s_waitcnt vmcnt(4)
    buffer_load_dwordx4 v[188:191], v1, s[36:39], s44 offen offset:2048 nt
    s_add_u32 s44, s44, 12288
    s_waitcnt vmcnt(4)
    buffer_load_dwordx4 v[192:195], v1, s[36:39], s44 offen offset:0 nt
    v_dot2_f32_bf16 v20, v128, v4, 0
    v_dot2_f32_bf16 v21, v132, v4, 0
    v_dot2_f32_bf16 v22, v136, v4, 0
    v_dot2_f32_bf16 v23, v140, v4, 0
    v_dot2c_f32_bf16 v20, v129, v5
    v_dot2c_f32_bf16 v21, v133, v5
    v_dot2c_f32_bf16 v22, v137, v5
    s_waitcnt vmcnt(4)
    buffer_load_dwordx4 v[196:199], v1, s[36:39], s44 offen offset:2048 nt
    s_add_u32 s44, s44, 4096
    v_dot2c_f32_bf16 v23, v141, v5
    v_dot2c_f32_bf16 v20, v130, v6
    v_dot2c_f32_bf16 v21, v134, v6
    v_dot2c_f32_bf16 v22, v138, v6
    v_dot2c_f32_bf16 v23, v142, v6
    v_dot2c_f32_bf16 v20, v131, v7
    v_dot2c_f32_bf16 v21, v135, v7
    v_dot2c_f32_bf16 v22, v139, v7
    s_waitcnt vmcnt(4)
    buffer_load_dwordx4 v[200:203], v1, s[36:39], s44 offen offset:0 nt
    v_dot2c_f32_bf16 v23, v143, v7
    v_add_f32_dpp v20, v20, v20 row_ror:8 row_mask:0xf bank_mask:0x3
    v_add_f32_dpp v21, v21, v21 row_ror:8 row_mask:0xf bank_mask:0x3
    v_add_f32_dpp v20, v22, v22 row_ror:8 row_mask:0xf bank_mask:0xc
    v_add_f32_dpp v21, v23, v23 row_ror:8 row_mask:0xf bank_mask:0xc
    v_add_f32_dpp v18, v16, v16 row_half_mirror row_mask:0xf bank_mask:0x5
    v_add_f32_dpp v19, v17, v17 row_half_mirror row_mask:0xf bank_mask:0x5
    v_add_f32_dpp v18, v20, v20 row_half_mirror row_mask:0xf bank_mask:0xa
    s_waitcnt vmcnt(4)
    buffer_load_dwordx4 v[204:207], v1, s[36:39], s44 offen offset:2048 nt
    s_add_u32 s44, s44, 12288
    s_and_b32 s44, s44, 0xfffff
    v_add_f32_dpp v19, v21, v21 row_half_mirror row_mask:0xf bank_mask:0xa
    v_cndmask_b32 v32, v24, v18, s[58:59]
    v_cndmask_b32 v33, v18, v24, s[58:59]
    v_cndmask_b32 v34, v25, v19, s[58:59]
    v_cndmask_b32 v35, v19, v25, s[58:59]
    v_add_f32_dpp v26, v33, v32 quad_perm:[1,0,3,2] row_mask:0xf bank_mask:0xf
    s_nop 0
    v_add_f32_dpp v27, v35, v34 quad_perm:[1,0,3,2] row_mask:0xf bank_mask:0xf
    s_waitcnt vmcnt(4)
    buffer_load_dwordx4 v[144:147], v1, s[36:39], s44 offen offset:0 nt
    v_dot2_f32_bf16 v16, v176, v4, 0
    v_dot2_f32_bf16 v17, v180, v4, 0
    v_dot2_f32_bf16 v18, v184, v4, 0
    v_dot2_f32_bf16 v19, v188, v4, 0
    v_dot2c_f32_bf16 v16, v177, v5
    s_waitcnt vmcnt(4)
    buffer_load_dwordx4 v[148:151], v1, s[36:39], s44 offen offset:2048 nt
    s_add_u32 s44, s44, 4096
    v_dot2c_f32_bf16 v17, v181, v5
    v_dot2c_f32_bf16 v18, v185, v5
    v_dot2c_f32_bf16 v19, v189, v5
    v_dot2c_f32_bf16 v16, v178, v6
    v_dot2c_f32_bf16 v17, v182, v6
    v_dot2c_f32_bf16 v18, v186, v6
    s_waitcnt vmcnt(4)
    buffer_load_dwordx4 v[152:155], v1, s[36:39], s44 offen offset:0 nt
    v_dot2c_f32_bf16 v19, v190, v6
    v_dot2c_f32_bf16 v16, v179, v7
    v_dot2c_f32_bf16 v17, v183, v7
    v_dot2c_f32_bf16 v18, v187, v7
    v_dot2c_f32_bf16 v19, v191, v7
    v_add_f32_dpp v16, v16, v16 row_ror:8 row_mask:0xf bank_mask:0x3
    s_waitcnt vmcnt(4)
    buffer_load_dwordx4 v[156:159], v1, s[36:39], s44 offen offset:2048 nt
    s_add_u32 s44, s44, 12288
    v_add_f32_dpp v17, v17, v17 row_ror:8 row_mask:0xf bank_mask:0x3
    v_add_f32_dpp v16, v18, v18 row_ror:8 row_mask:0xf bank_mask:0xc
    v_add_f32_dpp v17, v19, v19 row_ror:8 row_mask:0xf bank_mask:0xc
    s_waitcnt vmcnt(4)
    buffer_load_dwordx4 v[160:163], v1, s[36:39], s44 offen offset:0 nt
    v_dot2_f32_bf16 v20, v192, v4, 0
    v_dot2_f32_bf16 v21, v196, v4, 0
    v_dot2_f32_bf16 v22, v200, v4, 0
    v_dot2_f32_bf16 v23, v204, v4, 0
    v_dot2c_f32_bf16 v20, v193, v5
    v_dot2c_f32_bf16 v21, v197, v5
    s_waitcnt vmcnt(4)
    buffer_load_dwordx4 v[164:167], v1, s[36:39], s44 offen offset:2048 nt
    s_add_u32 s44, s44, 4096
    v_dot2c_f32_bf16 v22, v201, v5
    v_dot2c_f32_bf16 v23, v205, v5
    v_dot2c_f32_bf16 v20, v194, v6
    v_dot2c_f32_bf16 v21, v198, v6
    v_dot2c_f32_bf16 v22, v202, v6
    v_dot2c_f32_bf16 v23, v206, v6
    s_waitcnt vmcnt(4)
    buffer_load_dwordx4 v[168:171], v1, s[36:39], s44 offen offset:0 nt
    v_dot2c_f32_bf16 v20, v195, v7
    v_dot2c_f32_bf16 v21, v199, v7
    v_dot2c_f32_bf16 v22, v203, v7
    v_dot2c_f32_bf16 v23, v207, v7
    v_add_f32_dpp v20, v20, v20 row_ror:8 row_mask:0xf bank_mask:0x3
    v_add_f32_dpp v21, v21, v21 row_ror:8 row_mask:0xf bank_mask:0x3
    s_waitcnt vmcnt(4)
    buffer_load_dwordx4 v[172:175], v1, s[36:39], s44 offen offset:2048 nt
    s_add_u32 s44, s44, 12288
    s_and_b32 s44, s44, 0xfffff
    v_add_f32_dpp v20, v22, v22 row_ror:8 row_mask:0xf bank_mask:0xc
    v_add_f32_dpp v21, v23, v23 row_ror:8 row_mask:0xf bank_mask:0xc
    v_add_f32_dpp v24, v16, v16 row_half_mirror row_mask:0xf bank_mask:0x5
    v_add_f32_dpp v25, v17, v17 row_half_mirror row_mask:0xf bank_mask:0x5
    v_add_f32_dpp v24, v20, v20 row_half_mirror row_mask:0xf bank_mask:0xa
    v_add_f32_dpp v25, v21, v21 row_half_mirror row_mask:0xf bank_mask:0xa
    s_waitcnt vmcnt(4)
    buffer_load_dwordx4 v[80:83], v1, s[40:43], s44 offen offset:0 nt
    v_dot2_f32_bf16 v16, v144, v4, 0
    v_dot2_f32_bf16 v17, v148, v4, 0
    v_dot2_f32_bf16 v18, v152, v4, 0
    v_dot2_f32_bf16 v19, v156, v4, 0
    v_dot2c_f32_bf16 v16, v145, v5
    v_dot2c_f32_bf16 v17, v149, v5
    v_dot2c_f32_bf16 v18, v153, v5
    s_waitcnt vmcnt(4)
    buffer_load_dwordx4 v[84:87], v1, s[40:43], s44 offen offset:2048 nt
    s_add_u32 s44, s44, 4096
    v_dot2c_f32_bf16 v19, v157, v5
    v_dot2c_f32_bf16 v16, v146, v6
    v_dot2c_f32_bf16 v17, v150, v6
    v_dot2c_f32_bf16 v18, v154, v6
    v_dot2c_f32_bf16 v19, v158, v6
    v_dot2c_f32_bf16 v16, v147, v7
    v_dot2c_f32_bf16 v17, v151, v7
    v_dot2c_f32_bf16 v18, v155, v7
    s_waitcnt vmcnt(4)
    buffer_load_dwordx4 v[88:91], v1, s[40:43], s44 offen offset:0 nt
    v_dot2c_f32_bf16 v19, v159, v7
    v_add_f32_dpp v16, v16, v16 row_ror:8 row_mask:0xf bank_mask:0x3
    v_add_f32_dpp v17, v17, v17 row_ror:8 row_mask:0xf bank_mask:0x3
    v_add_f32_dpp v16, v18, v18 row_ror:8 row_mask:0xf bank_mask:0xc
    v_add_f32_dpp v17, v19, v19 row_ror:8 row_mask:0xf bank_mask:0xc
    s_waitcnt vmcnt(4)
    buffer_load_dwordx4 v[92:95], v1, s[40:43], s44 offen offset:2048 nt
    s_add_u32 s44, s44, 12288
    s_waitcnt vmcnt(4)
    buffer_load_dwordx4 v[96:99], v1, s[40:43], s44 offen offset:0 nt
    v_dot2_f32_bf16 v20, v160, v4, 0
    v_dot2_f32_bf16 v21, v164, v4, 0
    v_dot2_f32_bf16 v22, v168, v4, 0
    v_dot2_f32_bf16 v23, v172, v4, 0
    v_dot2c_f32_bf16 v20, v161, v5
    v_dot2c_f32_bf16 v21, v165, v5
    v_dot2c_f32_bf16 v22, v169, v5
    v_dot2c_f32_bf16 v23, v173, v5
    v_dot2c_f32_bf16 v20, v162, v6
    s_waitcnt vmcnt(4)
    buffer_load_dwordx4 v[100:103], v1, s[40:43], s44 offen offset:2048 nt
    s_add_u32 s44, s44, 4096
    v_dot2c_f32_bf16 v21, v166, v6
    v_dot2c_f32_bf16 v22, v170, v6
    v_dot2c_f32_bf16 v23, v174, v6
    v_dot2c_f32_bf16 v20, v163, v7
    v_dot2c_f32_bf16 v21, v167, v7
    v_dot2c_f32_bf16 v22, v171, v7
    v_dot2c_f32_bf16 v23, v175, v7
    v_add_f32_dpp v20, v20, v20 row_ror:8 row_mask:0xf bank_mask:0x3
    v_add_f32_dpp v21, v21, v21 row_ror:8 row_mask:0xf bank_mask:0x3
    v_add_f32_dpp v20, v22, v22 row_ror:8 row_mask:0xf bank_mask:0xc
    s_waitcnt vmcnt(4)
    buffer_load_dwordx4 v[104:107], v1, s[40:43], s44 offen offset:0 nt
    v_add_f32_dpp v21, v23, v23 row_ror:8 row_mask:0xf bank_mask:0xc
    v_add_f32_dpp v18, v16, v16 row_half_mirror row_mask:0xf bank_mask:0x5
    v_add_f32_dpp v19, v17, v17 row_half_mirror row_mask:0xf bank_mask:0x5
    v_add_f32_dpp v18, v20, v20 row_half_mirror row_mask:0xf bank_mask:0xa
    v_add_f32_dpp v19, v21, v21 row_half_mirror row_mask:0xf bank_mask:0xa
    v_cndmask_b32 v32, v24, v18, s[58:59]
    v_cndmask_b32 v33, v18, v24, s[58:59]
    v_cndmask_b32 v34, v25, v19, s[58:59]
    v_cndmask_b32 v35, v19, v25, s[58:59]
    v_add_f32_dpp v22, v33, v32 quad_perm:[1,0,3,2] row_mask:0xf bank_mask:0xf
    s_waitcnt vmcnt(4)
    buffer_load_dwordx4 v[108:111], v1, s[40:43], s44 offen offset:2048 nt
    s_add_u32 s44, s44, 12288
    s_and_b32 s44, s44, 0xfffff
    v_add_f32_dpp v23, v35, v34 quad_perm:[1,0,3,2] row_mask:0xf bank_mask:0xf
    v_cndmask_b32 v32, v26, v22, s[60:61]
    v_cndmask_b32 v33, v22, v26, s[60:61]
    v_cndmask_b32 v34, v27, v23, s[60:61]
    v_cndmask_b32 v35, v23, v27, s[60:61]
    v_add_f32_dpp v28, v33, v32 quad_perm:[2,3,0,1] row_mask:0xf bank_mask:0xf
    s_nop 0
    v_add_f32_dpp v29, v35, v34 quad_perm:[2,3,0,1] row_mask:0xf bank_mask:0xf
    ds_write_b64 v2, v[28:29]
    v_max3_f32 v30, v28, v29, v30
    v_add_u32 v2, 0x200, v2
    s_waitcnt vmcnt(4)
    buffer_load_dwordx4 v[208:211], v1, s[40:43], s44 offen offset:0 nt
    v_subrev_u32 v2, 0x1000, v2
    ds_read_b64 v[32:33], v2 offset:0
    ds_read_b64 v[34:35], v2 offset:512
    ds_read_b64 v[36:37], v2 offset:1024
    ds_read_b64 v[38:39], v2 offset:1536
    ds_read_b64 v[40:41], v2 offset:2048
    ds_read_b64 v[42:43], v2 offset:2560
    ds_read_b64 v[44:45], v2 offset:3072
    ds_read_b64 v[46:47], v2 offset:3584
    v_max_f32_dpp v30, v30, v30 quad_perm:[1,0,3,2] row_mask:0xf bank_mask:0xf
    s_nop 1
    v_max_f32_dpp v30, v30, v30 quad_perm:[2,3,0,1] row_mask:0xf bank_mask:0xf
    s_nop 1
    v_max_f32_dpp v30, v30, v30 row_half_mirror row_mask:0xf bank_mask:0xf
    s_nop 1
    v_max_f32_dpp v30, v30, v30 row_mirror row_mask:0xf bank_mask:0xf
    v_mov_b32 v28, v30
    s_nop 1
    v_permlane32_swap_b32 v30, v28
    v_max_f32 v30, v30, v28
    v_mov_b32 v28, v30
    s_nop 1
    v_permlane16_swap_b32 v30, v28
    v_max_f32 v30, v30, v28
    v_mul_f32 v28, s48, v30
    s_waitcnt vmcnt(4)
    buffer_load_dwordx4 v[212:215], v1, s[40:43], s44 offen offset:2048 nt
    s_add_u32 s44, s44, 4096
    v_mov_b32 v31, 0
    s_waitcnt lgkmcnt(0)
    v_fma_f32 v32, v32, s48, -v28
    v_fma_f32 v33, v33, s48, -v28
    v_fma_f32 v34, v34, s48, -v28
    v_fma_f32 v35, v35, s48, -v28
    v_fma_f32 v36, v36, s48, -v28
    v_fma_f32 v37, v37, s48, -v28
    v_fma_f32 v38, v38, s48, -v28
    v_fma_f32 v39, v39, s48, -v28
    v_fma_f32 v40, v40, s48, -v28
    v_fma_f32 v41, v41, s48, -v28
    v_fma_f32 v42, v42, s48, -v28
    v_fma_f32 v43, v43, s48, -v28
    v_fma_f32 v44, v44, s48, -v28
    v_fma_f32 v45, v45, s48, -v28
    v_fma_f32 v46, v46, s48, -v28
    v_fma_f32 v47, v47, s48, -v28
    v_exp_f32 v32, v32
    v_exp_f32 v33, v33
    s_waitcnt vmcnt(4)
    buffer_load_dwordx4 v[216:219], v1, s[40:43], s44 offen offset:0 nt
    v_exp_f32 v34, v34
    v_exp_f32 v35, v35
    v_exp_f32 v36, v36
    v_exp_f32 v37, v37
    v_exp_f32 v38, v38
    v_exp_f32 v39, v39
    v_exp_f32 v40, v40
    v_exp_f32 v41, v41
    v_exp_f32 v42, v42
    v_exp_f32 v43, v43
    v_exp_f32 v44, v44
    v_exp_f32 v45, v45
    v_exp_f32 v46, v46
    v_exp_f32 v47, v47
    v_cvt_pk_bf16_f32 v16, v32, v33
    v_cvt_pk_bf16_f32 v17, v34, v35
    v_cvt_pk_bf16_f32 v18, v36, v37
    v_cvt_pk_bf16_f32 v19, v38, v39
    v_cvt_pk_bf16_f32 v20, v40, v41
    v_cvt_pk_bf16_f32 v21, v42, v43
    s_waitcnt vmcnt(4)
    buffer_load_dwordx4 v[220:223], v1, s[40:43], s44 offen offset:2048 nt
    s_add_u32 s44, s44, 12288
    v_cvt_pk_bf16_f32 v22, v44, v45
    v_cvt_pk_bf16_f32 v23, v46, v47
    v_dot2c_f32_bf16 v31, 0x3f803f80, v16
    v_dot2c_f32_bf16 v31, 0x3f803f80, v17
    v_dot2c_f32_bf16 v31, 0x3f803f80, v18
    v_dot2c_f32_bf16 v31, 0x3f803f80, v19
    v_dot2c_f32_bf16 v31, 0x3f803f80, v20
    v_dot2c_f32_bf16 v31, 0x3f803f80, v21
    v_dot2c_f32_bf16 v31, 0x3f803f80, v22
    v_dot2c_f32_bf16 v31, 0x3f803f80, v23
    s_nop 2
    v_add_f32_dpp v31, v31, v31 quad_perm:[1,0,3,2] row_mask:0xf bank_mask:0xf
    s_nop 1
    v_add_f32_dpp v31, v31, v31 quad_perm:[2,3,0,1] row_mask:0xf bank_mask:0xf
    s_nop 1
    v_add_f32_dpp v31, v31, v31 row_half_mirror row_mask:0xf bank_mask:0xf
    s_nop 1
    v_add_f32_dpp v31, v31, v31 row_mirror row_mask:0xf bank_mask:0xf
    v_mov_b32 v28, v31
    s_nop 1
    v_permlane32_swap_b32 v31, v28
    v_add_f32 v31, v31, v28
    v_mov_b32 v28, v31
    s_nop 1
    v_permlane16_swap_b32 v31, v28
    s_waitcnt vmcnt(4)
    buffer_load_dwordx4 v[224:227], v1, s[40:43], s44 offen offset:0 nt
    v_add_f32 v31, v31, v28
    s_lshl_b32 s35, s3, 2
    v_mov_b32 v3, s35
    v_mov_b32 v2, 0
    s_mov_b64 exec, 1
    ds_write_b32 v3, v30 offset:6144
    ds_write_b32 v3, v31 offset:6160
    s_mov_b64 exec, -1
    v_perm_b32 v32, v84, v80, s46
    v_perm_b32 v33, v84, v80, s47
    v_perm_b32 v34, v85, v81, s46
    v_perm_b32 v35, v85, v81, s47
    v_perm_b32 v36, v86, v82, s46
    v_perm_b32 v37, v86, v82, s47
    v_perm_b32 v38, v87, v83, s46
    v_perm_b32 v39, v87, v83, s47
    v_dot2c_f32_bf16_dpp v8, v16, v32 row_newbcast:0 row_mask:0xf bank_mask:0xf
    v_dot2c_f32_bf16_dpp v9, v16, v33 row_newbcast:0 row_mask:0xf bank_mask:0xf
    s_waitcnt vmcnt(4)
    buffer_load_dwordx4 v[228:231], v1, s[40:43], s44 offen offset:2048 nt
    s_add_u32 s44, s44, 4096
    v_dot2c_f32_bf16_dpp v10, v16, v34 row_newbcast:0 row_mask:0xf bank_mask:0xf
    v_dot2c_f32_bf16_dpp v11, v16, v35 row_newbcast:0 row_mask:0xf bank_mask:0xf
    v_dot2c_f32_bf16_dpp v12, v16, v36 row_newbcast:0 row_mask:0xf bank_mask:0xf
    v_dot2c_f32_bf16_dpp v13, v16, v37 row_newbcast:0 row_mask:0xf bank_mask:0xf
    v_dot2c_f32_bf16_dpp v14, v16, v38 row_newbcast:0 row_mask:0xf bank_mask:0xf
    v_dot2c_f32_bf16_dpp v15, v16, v39 row_newbcast:0 row_mask:0xf bank_mask:0xf
    v_perm_b32 v40, v92, v88, s46
    v_perm_b32 v41, v92, v88, s47
    v_perm_b32 v42, v93, v89, s46
    v_perm_b32 v43, v93, v89, s47
    v_perm_b32 v44, v94, v90, s46
    v_perm_b32 v45, v94, v90, s47
    v_perm_b32 v46, v95, v91, s46
    v_perm_b32 v47, v95, v91, s47
    v_dot2c_f32_bf16_dpp v8, v16, v40 row_newbcast:8 row_mask:0xf bank_mask:0xf
    v_dot2c_f32_bf16_dpp v9, v16, v41 row_newbcast:8 row_mask:0xf bank_mask:0xf
    v_dot2c_f32_bf16_dpp v10, v16, v42 row_newbcast:8 row_mask:0xf bank_mask:0xf
    v_dot2c_f32_bf16_dpp v11, v16, v43 row_newbcast:8 row_mask:0xf bank_mask:0xf
    s_waitcnt vmcnt(4)
    buffer_load_dwordx4 v[232:235], v1, s[40:43], s44 offen offset:0 nt
    v_dot2c_f32_bf16_dpp v12, v16, v44 row_newbcast:8 row_mask:0xf bank_mask:0xf
    v_dot2c_f32_bf16_dpp v13, v16, v45 row_newbcast:8 row_mask:0xf bank_mask:0xf
    v_dot2c_f32_bf16_dpp v14, v16, v46 row_newbcast:8 row_mask:0xf bank_mask:0xf
    v_dot2c_f32_bf16_dpp v15, v16, v47 row_newbcast:8 row_mask:0xf bank_mask:0xf
    v_perm_b32 v32, v100, v96, s46
    v_perm_b32 v33, v100, v96, s47
    v_perm_b32 v34, v101, v97, s46
    v_perm_b32 v35, v101, v97, s47
    v_perm_b32 v36, v102, v98, s46
    v_perm_b32 v37, v102, v98, s47
    v_perm_b32 v38, v103, v99, s46
    v_perm_b32 v39, v103, v99, s47
    v_dot2c_f32_bf16_dpp v8, v16, v32 row_newbcast:4 row_mask:0xf bank_mask:0xf
    v_dot2c_f32_bf16_dpp v9, v16, v33 row_newbcast:4 row_mask:0xf bank_mask:0xf
    v_dot2c_f32_bf16_dpp v10, v16, v34 row_newbcast:4 row_mask:0xf bank_mask:0xf
    v_dot2c_f32_bf16_dpp v11, v16, v35 row_newbcast:4 row_mask:0xf bank_mask:0xf
    v_dot2c_f32_bf16_dpp v12, v16, v36 row_newbcast:4 row_mask:0xf bank_mask:0xf
    v_dot2c_f32_bf16_dpp v13, v16, v37 row_newbcast:4 row_mask:0xf bank_mask:0xf
    s_waitcnt vmcnt(4)
    buffer_load_dwordx4 v[236:239], v1, s[40:43], s44 offen offset:2048 nt
    s_add_u32 s44, s44, 12288
    s_and_b32 s44, s44, 0xfffff
    v_dot2c_f32_bf16_dpp v14, v16, v38 row_newbcast:4 row_mask:0xf bank_mask:0xf
    v_dot2c_f32_bf16_dpp v15, v16, v39 row_newbcast:4 row_mask:0xf bank_mask:0xf
    v_perm_b32 v40, v108, v104, s46
    v_perm_b32 v41, v108, v104, s47
    v_perm_b32 v42, v109, v105, s46
    v_perm_b32 v43, v109, v105, s47
    v_perm_b32 v44, v110, v106, s46
    v_perm_b32 v45, v110, v106, s47
    v_perm_b32 v46, v111, v107, s46
    v_perm_b32 v47, v111, v107, s47
    v_dot2c_f32_bf16_dpp v8, v16, v40 row_newbcast:12 row_mask:0xf bank_mask:0xf
    v_dot2c_f32_bf16_dpp v9, v16, v41 row_newbcast:12 row_mask:0xf bank_mask:0xf
    v_dot2c_f32_bf16_dpp v10, v16, v42 row_newbcast:12 row_mask:0xf bank_mask:0xf
    v_dot2c_f32_bf16_dpp v11, v16, v43 row_newbcast:12 row_mask:0xf bank_mask:0xf
    v_dot2c_f32_bf16_dpp v12, v16, v44 row_newbcast:12 row_mask:0xf bank_mask:0xf
    v_dot2c_f32_bf16_dpp v13, v16, v45 row_newbcast:12 row_mask:0xf bank_mask:0xf
    v_dot2c_f32_bf16_dpp v14, v16, v46 row_newbcast:12 row_mask:0xf bank_mask:0xf
    v_dot2c_f32_bf16_dpp v15, v16, v47 row_newbcast:12 row_mask:0xf bank_mask:0xf
    s_waitcnt vmcnt(4)
    buffer_load_dwordx4 v[48:51], v1, s[40:43], s44 offen offset:0 nt
    v_perm_b32 v32, v212, v208, s46
    v_perm_b32 v33, v212, v208, s47
    v_perm_b32 v34, v213, v209, s46
    v_perm_b32 v35, v213, v209, s47
    v_perm_b32 v36, v214, v210, s46
    v_perm_b32 v37, v214, v210, s47
    v_perm_b32 v38, v215, v211, s46
    v_perm_b32 v39, v215, v211, s47
    s_waitcnt vmcnt(4)
    buffer_load_dwordx4 v[52:55], v1, s[40:43], s44 offen offset:2048 nt
    s_add_u32 s44, s44, 4096
    v_dot2c_f32_bf16_dpp v8, v16, v32 row_newbcast:1 row_mask:0xf bank_mask:0xf
    v_dot2c_f32_bf16_dpp v9, v16, v33 row_newbcast:1 row_mask:0xf bank_mask:0xf
    v_dot2c_f32_bf16_dpp v10, v16, v34 row_newbcast:1 row_mask:0xf bank_mask:0xf
    v_dot2c_f32_bf16_dpp v11, v16, v35 row_newbcast:1 row_mask:0xf bank_mask:0xf
    v_dot2c_f32_bf16_dpp v12, v16, v36 row_newbcast:1 row_mask:0xf bank_mask:0xf
    v_dot2c_f32_bf16_dpp v13, v16, v37 row_newbcast:1 row_mask:0xf bank_mask:0xf
    v_dot2c_f32_bf16_dpp v14, v16, v38 row_newbcast:1 row_mask:0xf bank_mask:0xf
    v_dot2c_f32_bf16_dpp v15, v16, v39 row_newbcast:1 row_mask:0xf bank_mask:0xf
    s_waitcnt vmcnt(4)
    buffer_load_dwordx4 v[56:59], v1, s[40:43], s44 offen offset:0 nt
    v_perm_b32 v40, v220, v216, s46
    v_perm_b32 v41, v220, v216, s47
    v_perm_b32 v42, v221, v217, s46
    v_perm_b32 v43, v221, v217, s47
    v_perm_b32 v44, v222, v218, s46
    v_perm_b32 v45, v222, v218, s47
    v_perm_b32 v46, v223, v219, s46
    v_perm_b32 v47, v223, v219, s47
    v_dot2c_f32_bf16_dpp v8, v16, v40 row_newbcast:9 row_mask:0xf bank_mask:0xf
    s_waitcnt vmcnt(4)
    buffer_load_dwordx4 v[60:63], v1, s[40:43], s44 offen offset:2048 nt
    s_add_u32 s44, s44, 12288
    v_dot2c_f32_bf16_dpp v9, v16, v41 row_newbcast:9 row_mask:0xf bank_mask:0xf
    v_dot2c_f32_bf16_dpp v10, v16, v42 row_newbcast:9 row_mask:0xf bank_mask:0xf
    v_dot2c_f32_bf16_dpp v11, v16, v43 row_newbcast:9 row_mask:0xf bank_mask:0xf
    v_dot2c_f32_bf16_dpp v12, v16, v44 row_newbcast:9 row_mask:0xf bank_mask:0xf
    v_dot2c_f32_bf16_dpp v13, v16, v45 row_newbcast:9 row_mask:0xf bank_mask:0xf
    v_dot2c_f32_bf16_dpp v14, v16, v46 row_newbcast:9 row_mask:0xf bank_mask:0xf
    v_dot2c_f32_bf16_dpp v15, v16, v47 row_newbcast:9 row_mask:0xf bank_mask:0xf
    v_perm_b32 v32, v228, v224, s46
    s_waitcnt vmcnt(4)
    buffer_load_dwordx4 v[64:67], v1, s[40:43], s44 offen offset:0 nt
    v_perm_b32 v33, v228, v224, s47
    v_perm_b32 v34, v229, v225, s46
    v_perm_b32 v35, v229, v225, s47
    v_perm_b32 v36, v230, v226, s46
    v_perm_b32 v37, v230, v226, s47
    v_perm_b32 v38, v231, v227, s46
    v_perm_b32 v39, v231, v227, s47
    v_dot2c_f32_bf16_dpp v8, v16, v32 row_newbcast:5 row_mask:0xf bank_mask:0xf
    s_waitcnt vmcnt(4)
    buffer_load_dwordx4 v[68:71], v1, s[40:43], s44 offen offset:2048 nt
    s_add_u32 s44, s44, 4096
    v_dot2c_f32_bf16_dpp v9, v16, v33 row_newbcast:5 row_mask:0xf bank_mask:0xf
    v_dot2c_f32_bf16_dpp v10, v16, v34 row_newbcast:5 row_mask:0xf bank_mask:0xf
    v_dot2c_f32_bf16_dpp v11, v16, v35 row_newbcast:5 row_mask:0xf bank_mask:0xf
    v_dot2c_f32_bf16_dpp v12, v16, v36 row_newbcast:5 row_mask:0xf bank_mask:0xf
    v_dot2c_f32_bf16_dpp v13, v16, v37 row_newbcast:5 row_mask:0xf bank_mask:0xf
    v_dot2c_f32_bf16_dpp v14, v16, v38 row_newbcast:5 row_mask:0xf bank_mask:0xf
    v_dot2c_f32_bf16_dpp v15, v16, v39 row_newbcast:5 row_mask:0xf bank_mask:0xf
    s_waitcnt vmcnt(4)
    buffer_load_dwordx4 v[72:75], v1, s[40:43], s44 offen offset:0 nt
    v_perm_b32 v40, v236, v232, s46
    v_perm_b32 v41, v236, v232, s47
    v_perm_b32 v42, v237, v233, s46
    v_perm_b32 v43, v237, v233, s47
    v_perm_b32 v44, v238, v234, s46
    v_perm_b32 v45, v238, v234, s47
    v_perm_b32 v46, v239, v235, s46
    v_perm_b32 v47, v239, v235, s47
    s_waitcnt vmcnt(4)
    buffer_load_dwordx4 v[76:79], v1, s[40:43], s44 offen offset:2048 nt
    s_add_u32 s44, s44, 12288
    s_and_b32 s44, s44, 0xfffff
    v_dot2c_f32_bf16_dpp v8, v16, v40 row_newbcast:13 row_mask:0xf bank_mask:0xf
    v_dot2c_f32_bf16_dpp v9, v16, v41 row_newbcast:13 row_mask:0xf bank_mask:0xf
    v_dot2c_f32_bf16_dpp v10, v16, v42 row_newbcast:13 row_mask:0xf bank_mask:0xf
    v_dot2c_f32_bf16_dpp v11, v16, v43 row_newbcast:13 row_mask:0xf bank_mask:0xf
    v_dot2c_f32_bf16_dpp v12, v16, v44 row_newbcast:13 row_mask:0xf bank_mask:0xf
    v_dot2c_f32_bf16_dpp v13, v16, v45 row_newbcast:13 row_mask:0xf bank_mask:0xf
    v_dot2c_f32_bf16_dpp v14, v16, v46 row_newbcast:13 row_mask:0xf bank_mask:0xf
    v_dot2c_f32_bf16_dpp v15, v16, v47 row_newbcast:13 row_mask:0xf bank_mask:0xf
    s_waitcnt vmcnt(4)
    buffer_load_dwordx4 v[112:115], v1, s[40:43], s44 offen offset:0 nt
    v_perm_b32 v32, v52, v48, s46
    v_perm_b32 v33, v52, v48, s47
    v_perm_b32 v34, v53, v49, s46
    v_perm_b32 v35, v53, v49, s47
    v_perm_b32 v36, v54, v50, s46
    v_perm_b32 v37, v54, v50, s47
    v_perm_b32 v38, v55, v51, s46
    v_perm_b32 v39, v55, v51, s47
    s_waitcnt vmcnt(4)
    buffer_load_dwordx4 v[116:119], v1, s[40:43], s44 offen offset:2048 nt
    s_add_u32 s44, s44, 4096
    v_dot2c_f32_bf16_dpp v8, v16, v32 row_newbcast:2 row_mask:0xf bank_mask:0xf
    v_dot2c_f32_bf16_dpp v9, v16, v33 row_newbcast:2 row_mask:0xf bank_mask:0xf
    v_dot2c_f32_bf16_dpp v10, v16, v34 row_newbcast:2 row_mask:0xf bank_mask:0xf
    v_dot2c_f32_bf16_dpp v11, v16, v35 row_newbcast:2 row_mask:0xf bank_mask:0xf
    v_dot2c_f32_bf16_dpp v12, v16, v36 row_newbcast:2 row_mask:0xf bank_mask:0xf
    v_dot2c_f32_bf16_dpp v13, v16, v37 row_newbcast:2 row_mask:0xf bank_mask:0xf
    v_dot2c_f32_bf16_dpp v14, v16, v38 row_newbcast:2 row_mask:0xf bank_mask:0xf
    v_dot2c_f32_bf16_dpp v15, v16, v39 row_newbcast:2 row_mask:0xf bank_mask:0xf
    s_waitcnt vmcnt(4)
    buffer_load_dwordx4 v[120:123], v1, s[40:43], s44 offen offset:0 nt
    v_perm_b32 v40, v60, v56, s46
    v_perm_b32 v41, v60, v56, s47
    v_perm_b32 v42, v61, v57, s46
    v_perm_b32 v43, v61, v57, s47
    v_perm_b32 v44, v62, v58, s46
    v_perm_b32 v45, v62, v58, s47
    v_perm_b32 v46, v63, v59, s46
    v_perm_b32 v47, v63, v59, s47
    v_dot2c_f32_bf16_dpp v8, v16, v40 row_newbcast:10 row_mask:0xf bank_mask:0xf
    s_waitcnt vmcnt(4)
    buffer_load_dwordx4 v[124:127], v1, s[40:43], s44 offen offset:2048 nt
    s_add_u32 s44, s44, 12288
    v_dot2c_f32_bf16_dpp v9, v16, v41 row_newbcast:10 row_mask:0xf bank_mask:0xf
    v_dot2c_f32_bf16_dpp v10, v16, v42 row_newbcast:10 row_mask:0xf bank_mask:0xf
    v_dot2c_f32_bf16_dpp v11, v16, v43 row_newbcast:10 row_mask:0xf bank_mask:0xf
    v_dot2c_f32_bf16_dpp v12, v16, v44 row_newbcast:10 row_mask:0xf bank_mask:0xf
    v_dot2c_f32_bf16_dpp v13, v16, v45 row_newbcast:10 row_mask:0xf bank_mask:0xf
    v_dot2c_f32_bf16_dpp v14, v16, v46 row_newbcast:10 row_mask:0xf bank_mask:0xf
    v_dot2c_f32_bf16_dpp v15, v16, v47 row_newbcast:10 row_mask:0xf bank_mask:0xf
    v_perm_b32 v32, v68, v64, s46
    s_waitcnt vmcnt(4)
    buffer_load_dwordx4 v[128:131], v1, s[40:43], s44 offen offset:0 nt
    v_perm_b32 v33, v68, v64, s47
    v_perm_b32 v34, v69, v65, s46
    v_perm_b32 v35, v69, v65, s47
    v_perm_b32 v36, v70, v66, s46
    v_perm_b32 v37, v70, v66, s47
    v_perm_b32 v38, v71, v67, s46
    v_perm_b32 v39, v71, v67, s47
    v_dot2c_f32_bf16_dpp v8, v16, v32 row_newbcast:6 row_mask:0xf bank_mask:0xf
    s_waitcnt vmcnt(4)
    buffer_load_dwordx4 v[132:135], v1, s[40:43], s44 offen offset:2048 nt
    s_add_u32 s44, s44, 4096
    v_dot2c_f32_bf16_dpp v9, v16, v33 row_newbcast:6 row_mask:0xf bank_mask:0xf
    v_dot2c_f32_bf16_dpp v10, v16, v34 row_newbcast:6 row_mask:0xf bank_mask:0xf
    v_dot2c_f32_bf16_dpp v11, v16, v35 row_newbcast:6 row_mask:0xf bank_mask:0xf
    v_dot2c_f32_bf16_dpp v12, v16, v36 row_newbcast:6 row_mask:0xf bank_mask:0xf
    v_dot2c_f32_bf16_dpp v13, v16, v37 row_newbcast:6 row_mask:0xf bank_mask:0xf
    v_dot2c_f32_bf16_dpp v14, v16, v38 row_newbcast:6 row_mask:0xf bank_mask:0xf
    v_dot2c_f32_bf16_dpp v15, v16, v39 row_newbcast:6 row_mask:0xf bank_mask:0xf
    s_waitcnt vmcnt(4)
    buffer_load_dwordx4 v[136:139], v1, s[40:43], s44 offen offset:0 nt
    v_perm_b32 v40, v76, v72, s46
    v_perm_b32 v41, v76, v72, s47
    v_perm_b32 v42, v77, v73, s46
    v_perm_b32 v43, v77, v73, s47
    v_perm_b32 v44, v78, v74, s46
    v_perm_b32 v45, v78, v74, s47
    v_perm_b32 v46, v79, v75, s46
    v_perm_b32 v47, v79, v75, s47
    s_waitcnt vmcnt(4)
    buffer_load_dwordx4 v[140:143], v1, s[40:43], s44 offen offset:2048 nt
    s_add_u32 s44, s44, 12288
    s_and_b32 s44, s44, 0xfffff
    v_dot2c_f32_bf16_dpp v8, v16, v40 row_newbcast:14 row_mask:0xf bank_mask:0xf
    v_dot2c_f32_bf16_dpp v9, v16, v41 row_newbcast:14 row_mask:0xf bank_mask:0xf
    v_dot2c_f32_bf16_dpp v10, v16, v42 row_newbcast:14 row_mask:0xf bank_mask:0xf
    v_dot2c_f32_bf16_dpp v11, v16, v43 row_newbcast:14 row_mask:0xf bank_mask:0xf
    v_dot2c_f32_bf16_dpp v12, v16, v44 row_newbcast:14 row_mask:0xf bank_mask:0xf
    v_dot2c_f32_bf16_dpp v13, v16, v45 row_newbcast:14 row_mask:0xf bank_mask:0xf
    v_dot2c_f32_bf16_dpp v14, v16, v46 row_newbcast:14 row_mask:0xf bank_mask:0xf
    v_dot2c_f32_bf16_dpp v15, v16, v47 row_newbcast:14 row_mask:0xf bank_mask:0xf
    s_waitcnt vmcnt(4)
    buffer_load_dwordx4 v[176:179], v1, s[40:43], s44 offen offset:0 nt
    v_perm_b32 v32, v116, v112, s46
    v_perm_b32 v33, v116, v112, s47
    v_perm_b32 v34, v117, v113, s46
    v_perm_b32 v35, v117, v113, s47
    v_perm_b32 v36, v118, v114, s46
    v_perm_b32 v37, v118, v114, s47
    v_perm_b32 v38, v119, v115, s46
    v_perm_b32 v39, v119, v115, s47
    v_dot2c_f32_bf16_dpp v8, v16, v32 row_newbcast:3 row_mask:0xf bank_mask:0xf
    s_waitcnt vmcnt(4)
    buffer_load_dwordx4 v[180:183], v1, s[40:43], s44 offen offset:2048 nt
    s_add_u32 s44, s44, 4096
    v_dot2c_f32_bf16_dpp v9, v16, v33 row_newbcast:3 row_mask:0xf bank_mask:0xf
    v_dot2c_f32_bf16_dpp v10, v16, v34 row_newbcast:3 row_mask:0xf bank_mask:0xf
    v_dot2c_f32_bf16_dpp v11, v16, v35 row_newbcast:3 row_mask:0xf bank_mask:0xf
    v_dot2c_f32_bf16_dpp v12, v16, v36 row_newbcast:3 row_mask:0xf bank_mask:0xf
    v_dot2c_f32_bf16_dpp v13, v16, v37 row_newbcast:3 row_mask:0xf bank_mask:0xf
    v_dot2c_f32_bf16_dpp v14, v16, v38 row_newbcast:3 row_mask:0xf bank_mask:0xf
    v_dot2c_f32_bf16_dpp v15, v16, v39 row_newbcast:3 row_mask:0xf bank_mask:0xf
    v_perm_b32 v40, v124, v120, s46
    v_perm_b32 v41, v124, v120, s47
    s_waitcnt vmcnt(4)
    buffer_load_dwordx4 v[184:187], v1, s[40:43], s44 offen offset:0 nt
    v_perm_b32 v42, v125, v121, s46
    v_perm_b32 v43, v125, v121, s47
    v_perm_b32 v44, v126, v122, s46
    v_perm_b32 v45, v126, v122, s47
    v_perm_b32 v46, v127, v123, s46
    v_perm_b32 v47, v127, v123, s47
    v_dot2c_f32_bf16_dpp v8, v16, v40 row_newbcast:11 row_mask:0xf bank_mask:0xf
    v_dot2c_f32_bf16_dpp v9, v16, v41 row_newbcast:11 row_mask:0xf bank_mask:0xf
    v_dot2c_f32_bf16_dpp v10, v16, v42 row_newbcast:11 row_mask:0xf bank_mask:0xf
    v_dot2c_f32_bf16_dpp v11, v16, v43 row_newbcast:11 row_mask:0xf bank_mask:0xf
    s_waitcnt vmcnt(4)
    buffer_load_dwordx4 v[188:191], v1, s[40:43], s44 offen offset:2048 nt
    s_add_u32 s44, s44, 12288
    v_dot2c_f32_bf16_dpp v12, v16, v44 row_newbcast:11 row_mask:0xf bank_mask:0xf
    v_dot2c_f32_bf16_dpp v13, v16, v45 row_newbcast:11 row_mask:0xf bank_mask:0xf
    v_dot2c_f32_bf16_dpp v14, v16, v46 row_newbcast:11 row_mask:0xf bank_mask:0xf
    v_dot2c_f32_bf16_dpp v15, v16, v47 row_newbcast:11 row_mask:0xf bank_mask:0xf
    v_perm_b32 v32, v132, v128, s46
    v_perm_b32 v33, v132, v128, s47
    v_perm_b32 v34, v133, v129, s46
    v_perm_b32 v35, v133, v129, s47
    s_waitcnt vmcnt(4)
    buffer_load_dwordx4 v[192:195], v1, s[40:43], s44 offen offset:0 nt
    v_perm_b32 v36, v134, v130, s46
    v_perm_b32 v37, v134, v130, s47
    v_perm_b32 v38, v135, v131, s46
    v_perm_b32 v39, v135, v131, s47
    v_dot2c_f32_bf16_dpp v8, v16, v32 row_newbcast:7 row_mask:0xf bank_mask:0xf
    v_dot2c_f32_bf16_dpp v9, v16, v33 row_newbcast:7 row_mask:0xf bank_mask:0xf
    v_dot2c_f32_bf16_dpp v10, v16, v34 row_newbcast:7 row_mask:0xf bank_mask:0xf
    v_dot2c_f32_bf16_dpp v11, v16, v35 row_newbcast:7 row_mask:0xf bank_mask:0xf
    v_dot2c_f32_bf16_dpp v12, v16, v36 row_newbcast:7 row_mask:0xf bank_mask:0xf
    s_waitcnt vmcnt(4)
    buffer_load_dwordx4 v[196:199], v1, s[40:43], s44 offen offset:2048 nt
    s_add_u32 s44, s44, 4096
    v_dot2c_f32_bf16_dpp v13, v16, v37 row_newbcast:7 row_mask:0xf bank_mask:0xf
    v_dot2c_f32_bf16_dpp v14, v16, v38 row_newbcast:7 row_mask:0xf bank_mask:0xf
    v_dot2c_f32_bf16_dpp v15, v16, v39 row_newbcast:7 row_mask:0xf bank_mask:0xf
    v_perm_b32 v40, v140, v136, s46
    v_perm_b32 v41, v140, v136, s47
    v_perm_b32 v42, v141, v137, s46
    v_perm_b32 v43, v141, v137, s47
    v_perm_b32 v44, v142, v138, s46
    s_waitcnt vmcnt(4)
    buffer_load_dwordx4 v[200:203], v1, s[40:43], s44 offen offset:0 nt
    v_perm_b32 v45, v142, v138, s47
    v_perm_b32 v46, v143, v139, s46
    v_perm_b32 v47, v143, v139, s47
    v_dot2c_f32_bf16_dpp v8, v16, v40 row_newbcast:15 row_mask:0xf bank_mask:0xf
    v_dot2c_f32_bf16_dpp v9, v16, v41 row_newbcast:15 row_mask:0xf bank_mask:0xf
    v_dot2c_f32_bf16_dpp v10, v16, v42 row_newbcast:15 row_mask:0xf bank_mask:0xf
    v_dot2c_f32_bf16_dpp v11, v16, v43 row_newbcast:15 row_mask:0xf bank_mask:0xf
    v_dot2c_f32_bf16_dpp v12, v16, v44 row_newbcast:15 row_mask:0xf bank_mask:0xf
    v_dot2c_f32_bf16_dpp v13, v16, v45 row_newbcast:15 row_mask:0xf bank_mask:0xf
    s_waitcnt vmcnt(4)
    buffer_load_dwordx4 v[204:207], v1, s[40:43], s44 offen offset:2048 nt
    s_add_u32 s44, s44, 12288
    s_and_b32 s44, s44, 0xfffff
    v_dot2c_f32_bf16_dpp v14, v16, v46 row_newbcast:15 row_mask:0xf bank_mask:0xf
    v_dot2c_f32_bf16_dpp v15, v16, v47 row_newbcast:15 row_mask:0xf bank_mask:0xf
    v_mov_b32 v16, v17
    v_mov_b32 v17, v18
    v_mov_b32 v18, v19
    v_mov_b32 v19, v20
    v_mov_b32 v20, v21
    v_mov_b32 v21, v22
    v_mov_b32 v22, v23
    s_mov_b32 s45, 6
L_topV:
    s_add_u32 s56, s56, s55
    s_cmp_ge_u32 s56, 9
    s_cbranch_scc1 L_BV
L_AV:
    s_waitcnt vmcnt(4)
    buffer_load_dwordx4 v[144:147], v1, s[40:43], s44 offen offset:0 nt
    v_perm_b32 v32, v180, v176, s46
    v_perm_b32 v33, v180, v176, s47
    v_perm_b32 v34, v181, v177, s46
    v_perm_b32 v35, v181, v177, s47
    v_perm_b32 v36, v182, v178, s46
    v_perm_b32 v37, v182, v178, s47
    v_perm_b32 v38, v183, v179, s46
    v_perm_b32 v39, v183, v179, s47
    s_waitcnt vmcnt(4)
    buffer_load_dwordx4 v[148:151], v1, s[40:43], s44 offen offset:2048 nt
    s_add_u32 s44, s44, 4096
    v_dot2c_f32_bf16_dpp v8, v16, v32 row_newbcast:0 row_mask:0xf bank_mask:0xf
    v_dot2c_f32_bf16_dpp v9, v16, v33 row_newbcast:0 row_mask:0xf bank_mask:0xf
    v_dot2c_f32_bf16_dpp v10, v16, v34 row_newbcast:0 row_mask:0xf bank_mask:0xf
    v_dot2c_f32_bf16_dpp v11, v16, v35 row_newbcast:0 row_mask:0xf bank_mask:0xf
    v_dot2c_f32_bf16_dpp v12, v16, v36 row_newbcast:0 row_mask:0xf bank_mask:0xf
    v_dot2c_f32_bf16_dpp v13, v16, v37 row_newbcast:0 row_mask:0xf bank_mask:0xf
    v_dot2c_f32_bf16_dpp v14, v16, v38 row_newbcast:0 row_mask:0xf bank_mask:0xf
    v_dot2c_f32_bf16_dpp v15, v16, v39 row_newbcast:0 row_mask:0xf bank_mask:0xf
    s_waitcnt vmcnt(4)
    buffer_load_dwordx4 v[152:155], v1, s[40:43], s44 offen offset:0 nt
    v_perm_b32 v40, v188, v184, s46
    v_perm_b32 v41, v188, v184, s47
    v_perm_b32 v42, v189, v185, s46
    v_perm_b32 v43, v189, v185, s47
    v_perm_b32 v44, v190, v186, s46
    v_perm_b32 v45, v190, v186, s47
    v_perm_b32 v46, v191, v187, s46
    v_perm_b32 v47, v191, v187, s47
    v_dot2c_f32_bf16_dpp v8, v16, v40 row_newbcast:8 row_mask:0xf bank_mask:0xf
    s_waitcnt vmcnt(4)
    buffer_load_dwordx4 v[156:159], v1, s[40:43], s44 offen offset:2048 nt
    s_add_u32 s44, s44, 12288
    v_dot2c_f32_bf16_dpp v9, v16, v41 row_newbcast:8 row_mask:0xf bank_mask:0xf
    v_dot2c_f32_bf16_dpp v10, v16, v42 row_newbcast:8 row_mask:0xf bank_mask:0xf
    v_dot2c_f32_bf16_dpp v11, v16, v43 row_newbcast:8 row_mask:0xf bank_mask:0xf
    v_dot2c_f32_bf16_dpp v12, v16, v44 row_newbcast:8 row_mask:0xf bank_mask:0xf
    v_dot2c_f32_bf16_dpp v13, v16, v45 row_newbcast:8 row_mask:0xf bank_mask:0xf
    v_dot2c_f32_bf16_dpp v14, v16, v46 row_newbcast:8 row_mask:0xf bank_mask:0xf
    v_dot2c_f32_bf16_dpp v15, v16, v47 row_newbcast:8 row_mask:0xf bank_mask:0xf
    v_perm_b32 v32, v196, v192, s46
    s_waitcnt vmcnt(4)
    buffer_load_dwordx4 v[160:163], v1, s[40:43], s44 offen offset:0 nt
    v_perm_b32 v33, v196, v192, s47
    v_perm_b32 v34, v197, v193, s46
    v_perm_b32 v35, v197, v193, s47
    v_perm_b32 v36, v198, v194, s46
    v_perm_b32 v37, v198, v194, s47
    v_perm_b32 v38, v199, v195, s46
    v_perm_b32 v39, v199, v195, s47
    v_dot2c_f32_bf16_dpp v8, v16, v32 row_newbcast:4 row_mask:0xf bank_mask:0xf
    s_waitcnt vmcnt(4)
    buffer_load_dwordx4 v[164:167], v1, s[40:43], s44 offen offset:2048 nt
    s_add_u32 s44, s44, 4096
    v_dot2c_f32_bf16_dpp v9, v16, v33 row_newbcast:4 row_mask:0xf bank_mask:0xf
    v_dot2c_f32_bf16_dpp v10, v16, v34 row_newbcast:4 row_mask:0xf bank_mask:0xf
    v_dot2c_f32_bf16_dpp v11, v16, v35 row_newbcast:4 row_mask:0xf bank_mask:0xf
    v_dot2c_f32_bf16_dpp v12, v16, v36 row_newbcast:4 row_mask:0xf bank_mask:0xf
    v_dot2c_f32_bf16_dpp v13, v16, v37 row_newbcast:4 row_mask:0xf bank_mask:0xf
    v_dot2c_f32_bf16_dpp v14, v16, v38 row_newbcast:4 row_mask:0xf bank_mask:0xf
    v_dot2c_f32_bf16_dpp v15, v16, v39 row_newbcast:4 row_mask:0xf bank_mask:0xf
    s_waitcnt vmcnt(4)
    buffer_load_dwordx4 v[168:171], v1, s[40:43], s44 offen offset:0 nt
    v_perm_b32 v40, v204, v200, s46
    v_perm_b32 v41, v204, v200, s47
    v_perm_b32 v42, v205, v201, s46
    v_perm_b32 v43, v205, v201, s47
    v_perm_b32 v44, v206, v202, s46
    v_perm_b32 v45, v206, v202, s47
    v_perm_b32 v46, v207, v203, s46
    v_perm_b32 v47, v207, v203, s47
    s_waitcnt vmcnt(4)
    buffer_load_dwordx4 v[172:175], v1, s[40:43], s44 offen offset:2048 nt
    s_add_u32 s44, s44, 12288
    s_and_b32 s44, s44, 0xfffff
    v_dot2c_f32_bf16_dpp v8, v16, v40 row_newbcast:12 row_mask:0xf bank_mask:0xf
    v_dot2c_f32_bf16_dpp v9, v16, v41 row_newbcast:12 row_mask:0xf bank_mask:0xf
    v_dot2c_f32_bf16_dpp v10, v16, v42 row_newbcast:12 row_mask:0xf bank_mask:0xf
    v_dot2c_f32_bf16_dpp v11, v16, v43 row_newbcast:12 row_mask:0xf bank_mask:0xf
    v_dot2c_f32_bf16_dpp v12, v16, v44 row_newbcast:12 row_mask:0xf bank_mask:0xf
    v_dot2c_f32_bf16_dpp v13, v16, v45 row_newbcast:12 row_mask:0xf bank_mask:0xf
    v_dot2c_f32_bf16_dpp v14, v16, v46 row_newbcast:12 row_mask:0xf bank_mask:0xf
    v_dot2c_f32_bf16_dpp v15, v16, v47 row_newbcast:12 row_mask:0xf bank_mask:0xf
    s_waitcnt vmcnt(4)
    buffer_load_dwordx4 v[176:179], v1, s[40:43], s44 offen offset:0 nt
    v_perm_b32 v32, v148, v144, s46
    v_perm_b32 v33, v148, v144, s47
    v_perm_b32 v34, v149, v145, s46
    v_perm_b32 v35, v149, v145, s47
    v_perm_b32 v36, v150, v146, s46
    v_perm_b32 v37, v150, v146, s47
    v_perm_b32 v38, v151, v147, s46
    v_perm_b32 v39, v151, v147, s47
    s_waitcnt vmcnt(4)
    buffer_load_dwordx4 v[180:183], v1, s[40:43], s44 offen offset:2048 nt
    s_add_u32 s44, s44, 4096
    v_dot2c_f32_bf16_dpp v8, v16, v32 row_newbcast:1 row_mask:0xf bank_mask:0xf
    v_dot2c_f32_bf16_dpp v9, v16, v33 row_newbcast:1 row_mask:0xf bank_mask:0xf
    v_dot2c_f32_bf16_dpp v10, v16, v34 row_newbcast:1 row_mask:0xf bank_mask:0xf
    v_dot2c_f32_bf16_dpp v11, v16, v35 row_newbcast:1 row_mask:0xf bank_mask:0xf
    v_dot2c_f32_bf16_dpp v12, v16, v36 row_newbcast:1 row_mask:0xf bank_mask:0xf
    v_dot2c_f32_bf16_dpp v13, v16, v37 row_newbcast:1 row_mask:0xf bank_mask:0xf
    v_dot2c_f32_bf16_dpp v14, v16, v38 row_newbcast:1 row_mask:0xf bank_mask:0xf
    v_dot2c_f32_bf16_dpp v15, v16, v39 row_newbcast:1 row_mask:0xf bank_mask:0xf
    s_waitcnt vmcnt(4)
    buffer_load_dwordx4 v[184:187], v1, s[40:43], s44 offen offset:0 nt
    v_perm_b32 v40, v156, v152, s46
    v_perm_b32 v41, v156, v152, s47
    v_perm_b32 v42, v157, v153, s46
    v_perm_b32 v43, v157, v153, s47
    v_perm_b32 v44, v158, v154, s46
    v_perm_b32 v45, v158, v154, s47
    v_perm_b32 v46, v159, v155, s46
    v_perm_b32 v47, v159, v155, s47
    v_dot2c_f32_bf16_dpp v8, v16, v40 row_newbcast:9 row_mask:0xf bank_mask:0xf
    s_waitcnt vmcnt(4)
    buffer_load_dwordx4 v[188:191], v1, s[40:43], s44 offen offset:2048 nt
    s_add_u32 s44, s44, 12288
    v_dot2c_f32_bf16_dpp v9, v16, v41 row_newbcast:9 row_mask:0xf bank_mask:0xf
    v_dot2c_f32_bf16_dpp v10, v16, v42 row_newbcast:9 row_mask:0xf bank_mask:0xf
    v_dot2c_f32_bf16_dpp v11, v16, v43 row_newbcast:9 row_mask:0xf bank_mask:0xf
    v_dot2c_f32_bf16_dpp v12, v16, v44 row_newbcast:9 row_mask:0xf bank_mask:0xf
    v_dot2c_f32_bf16_dpp v13, v16, v45 row_newbcast:9 row_mask:0xf bank_mask:0xf
    v_dot2c_f32_bf16_dpp v14, v16, v46 row_newbcast:9 row_mask:0xf bank_mask:0xf
    v_dot2c_f32_bf16_dpp v15, v16, v47 row_newbcast:9 row_mask:0xf bank_mask:0xf
    v_perm_b32 v32, v164, v160, s46
    s_waitcnt vmcnt(4)
    buffer_load_dwordx4 v[192:195], v1, s[40:43], s44 offen offset:0 nt
    v_perm_b32 v33, v164, v160, s47
    v_perm_b32 v34, v165, v161, s46
    v_perm_b32 v35, v165, v161, s47
    v_perm_b32 v36, v166, v162, s46
    v_perm_b32 v37, v166, v162, s47
    v_perm_b32 v38, v167, v163, s46
    v_perm_b32 v39, v167, v163, s47
    v_dot2c_f32_bf16_dpp v8, v16, v32 row_newbcast:5 row_mask:0xf bank_mask:0xf
    s_waitcnt vmcnt(4)
    buffer_load_dwordx4 v[196:199], v1, s[40:43], s44 offen offset:2048 nt
    s_add_u32 s44, s44, 4096
    v_dot2c_f32_bf16_dpp v9, v16, v33 row_newbcast:5 row_mask:0xf bank_mask:0xf
    v_dot2c_f32_bf16_dpp v10, v16, v34 row_newbcast:5 row_mask:0xf bank_mask:0xf
    v_dot2c_f32_bf16_dpp v11, v16, v35 row_newbcast:5 row_mask:0xf bank_mask:0xf
    v_dot2c_f32_bf16_dpp v12, v16, v36 row_newbcast:5 row_mask:0xf bank_mask:0xf
    v_dot2c_f32_bf16_dpp v13, v16, v37 row_newbcast:5 row_mask:0xf bank_mask:0xf
    v_dot2c_f32_bf16_dpp v14, v16, v38 row_newbcast:5 row_mask:0xf bank_mask:0xf
    v_dot2c_f32_bf16_dpp v15, v16, v39 row_newbcast:5 row_mask:0xf bank_mask:0xf
    s_waitcnt vmcnt(4)
    buffer_load_dwordx4 v[200:203], v1, s[40:43], s44 offen offset:0 nt
    v_perm_b32 v40, v172, v168, s46
    v_perm_b32 v41, v172, v168, s47
    v_perm_b32 v42, v173, v169, s46
    v_perm_b32 v43, v173, v169, s47
    v_perm_b32 v44, v174, v170, s46
    v_perm_b32 v45, v174, v170, s47
    v_perm_b32 v46, v175, v171, s46
    v_perm_b32 v47, v175, v171, s47
    s_waitcnt vmcnt(4)
    buffer_load_dwordx4 v[204:207], v1, s[40:43], s44 offen offset:2048 nt
    s_add_u32 s44, s44, 12288
    s_and_b32 s44, s44, 0xfffff
    v_dot2c_f32_bf16_dpp v8, v16, v40 row_newbcast:13 row_mask:0xf bank_mask:0xf
    v_dot2c_f32_bf16_dpp v9, v16, v41 row_newbcast:13 row_mask:0xf bank_mask:0xf
    v_dot2c_f32_bf16_dpp v10, v16, v42 row_newbcast:13 row_mask:0xf bank_mask:0xf
    v_dot2c_f32_bf16_dpp v11, v16, v43 row_newbcast:13 row_mask:0xf bank_mask:0xf
    v_dot2c_f32_bf16_dpp v12, v16, v44 row_newbcast:13 row_mask:0xf bank_mask:0xf
    v_dot2c_f32_bf16_dpp v13, v16, v45 row_newbcast:13 row_mask:0xf bank_mask:0xf
    v_dot2c_f32_bf16_dpp v14, v16, v46 row_newbcast:13 row_mask:0xf bank_mask:0xf
    v_dot2c_f32_bf16_dpp v15, v16, v47 row_newbcast:13 row_mask:0xf bank_mask:0xf
    s_waitcnt vmcnt(4)
    buffer_load_dwordx4 v[144:147], v1, s[40:43], s44 offen offset:0 nt
    v_perm_b32 v32, v180, v176, s46
    v_perm_b32 v33, v180, v176, s47
    v_perm_b32 v34, v181, v177, s46
    v_perm_b32 v35, v181, v177, s47
    v_perm_b32 v36, v182, v178, s46
    v_perm_b32 v37, v182, v178, s47
    v_perm_b32 v38, v183, v179, s46
    v_perm_b32 v39, v183, v179, s47
    s_waitcnt vmcnt(4)
    buffer_load_dwordx4 v[148:151], v1, s[40:43], s44 offen offset:2048 nt
    s_add_u32 s44, s44, 4096
    v_dot2c_f32_bf16_dpp v8, v16, v32 row_newbcast:2 row_mask:0xf bank_mask:0xf
    v_dot2c_f32_bf16_dpp v9, v16, v33 row_newbcast:2 row_mask:0xf bank_mask:0xf
    v_dot2c_f32_bf16_dpp v10, v16, v34 row_newbcast:2 row_mask:0xf bank_mask:0xf
    v_dot2c_f32_bf16_dpp v11, v16, v35 row_newbcast:2 row_mask:0xf bank_mask:0xf
    v_dot2c_f32_bf16_dpp v12, v16, v36 row_newbcast:2 row_mask:0xf bank_mask:0xf
    v_dot2c_f32_bf16_dpp v13, v16, v37 row_newbcast:2 row_mask:0xf bank_mask:0xf
    v_dot2c_f32_bf16_dpp v14, v16, v38 row_newbcast:2 row_mask:0xf bank_mask:0xf
    v_dot2c_f32_bf16_dpp v15, v16, v39 row_newbcast:2 row_mask:0xf bank_mask:0xf
    s_waitcnt vmcnt(4)
    buffer_load_dwordx4 v[152:155], v1, s[40:43], s44 offen offset:0 nt
    v_perm_b32 v40, v188, v184, s46
    v_perm_b32 v41, v188, v184, s47
    v_perm_b32 v42, v189, v185, s46
    v_perm_b32 v43, v189, v185, s47
    v_perm_b32 v44, v190, v186, s46
    v_perm_b32 v45, v190, v186, s47
    v_perm_b32 v46, v191, v187, s46
    v_perm_b32 v47, v191, v187, s47
    v_dot2c_f32_bf16_dpp v8, v16, v40 row_newbcast:10 row_mask:0xf bank_mask:0xf
    s_waitcnt vmcnt(4)
    buffer_load_dwordx4 v[156:159], v1, s[40:43], s44 offen offset:2048 nt
    s_add_u32 s44, s44, 12288
    v_dot2c_f32_bf16_dpp v9, v16, v41 row_newbcast:10 row_mask:0xf bank_mask:0xf
    v_dot2c_f32_bf16_dpp v10, v16, v42 row_newbcast:10 row_mask:0xf bank_mask:0xf
    v_dot2c_f32_bf16_dpp v11, v16, v43 row_newbcast:10 row_mask:0xf bank_mask:0xf
    v_dot2c_f32_bf16_dpp v12, v16, v44 row_newbcast:10 row_mask:0xf bank_mask:0xf
    v_dot2c_f32_bf16_dpp v13, v16, v45 row_newbcast:10 row_mask:0xf bank_mask:0xf
    v_dot2c_f32_bf16_dpp v14, v16, v46 row_newbcast:10 row_mask:0xf bank_mask:0xf
    v_dot2c_f32_bf16_dpp v15, v16, v47 row_newbcast:10 row_mask:0xf bank_mask:0xf
    v_perm_b32 v32, v196, v192, s46
    s_waitcnt vmcnt(4)
    buffer_load_dwordx4 v[160:163], v1, s[40:43], s44 offen offset:0 nt
    v_perm_b32 v33, v196, v192, s47
    v_perm_b32 v34, v197, v193, s46
    v_perm_b32 v35, v197, v193, s47
    v_perm_b32 v36, v198, v194, s46
    v_perm_b32 v37, v198, v194, s47
    v_perm_b32 v38, v199, v195, s46
    v_perm_b32 v39, v199, v195, s47
    v_dot2c_f32_bf16_dpp v8, v16, v32 row_newbcast:6 row_mask:0xf bank_mask:0xf
    s_waitcnt vmcnt(4)
    buffer_load_dwordx4 v[164:167], v1, s[40:43], s44 offen offset:2048 nt
    s_add_u32 s44, s44, 4096
    v_dot2c_f32_bf16_dpp v9, v16, v33 row_newbcast:6 row_mask:0xf bank_mask:0xf
    v_dot2c_f32_bf16_dpp v10, v16, v34 row_newbcast:6 row_mask:0xf bank_mask:0xf
    v_dot2c_f32_bf16_dpp v11, v16, v35 row_newbcast:6 row_mask:0xf bank_mask:0xf
    v_dot2c_f32_bf16_dpp v12, v16, v36 row_newbcast:6 row_mask:0xf bank_mask:0xf
    v_dot2c_f32_bf16_dpp v13, v16, v37 row_newbcast:6 row_mask:0xf bank_mask:0xf
    v_dot2c_f32_bf16_dpp v14, v16, v38 row_newbcast:6 row_mask:0xf bank_mask:0xf
    v_dot2c_f32_bf16_dpp v15, v16, v39 row_newbcast:6 row_mask:0xf bank_mask:0xf
    s_waitcnt vmcnt(4)
    buffer_load_dwordx4 v[168:171], v1, s[40:43], s44 offen offset:0 nt
    v_perm_b32 v40, v204, v200, s46
    v_perm_b32 v41, v204, v200, s47
    v_perm_b32 v42, v205, v201, s46
    v_perm_b32 v43, v205, v201, s47
    v_perm_b32 v44, v206, v202, s46
    v_perm_b32 v45, v206, v202, s47
    v_perm_b32 v46, v207, v203, s46
    v_perm_b32 v47, v207, v203, s47
    s_waitcnt vmcnt(4)
    buffer_load_dwordx4 v[172:175], v1, s[40:43], s44 offen offset:2048 nt
    s_add_u32 s44, s44, 12288
    s_and_b32 s44, s44, 0xfffff
    v_dot2c_f32_bf16_dpp v8, v16, v40 row_newbcast:14 row_mask:0xf bank_mask:0xf
    v_dot2c_f32_bf16_dpp v9, v16, v41 row_newbcast:14 row_mask:0xf bank_mask:0xf
    v_dot2c_f32_bf16_dpp v10, v16, v42 row_newbcast:14 row_mask:0xf bank_mask:0xf
    v_dot2c_f32_bf16_dpp v11, v16, v43 row_newbcast:14 row_mask:0xf bank_mask:0xf
    v_dot2c_f32_bf16_dpp v12, v16, v44 row_newbcast:14 row_mask:0xf bank_mask:0xf
    v_dot2c_f32_bf16_dpp v13, v16, v45 row_newbcast:14 row_mask:0xf bank_mask:0xf
    v_dot2c_f32_bf16_dpp v14, v16, v46 row_newbcast:14 row_mask:0xf bank_mask:0xf
    v_dot2c_f32_bf16_dpp v15, v16, v47 row_newbcast:14 row_mask:0xf bank_mask:0xf
    s_waitcnt vmcnt(4)
    buffer_load_dwordx4 v[176:179], v1, s[40:43], s44 offen offset:0 nt
    v_perm_b32 v32, v148, v144, s46
    v_perm_b32 v33, v148, v144, s47
    v_perm_b32 v34, v149, v145, s46
    v_perm_b32 v35, v149, v145, s47
    v_perm_b32 v36, v150, v146, s46
    v_perm_b32 v37, v150, v146, s47
    v_perm_b32 v38, v151, v147, s46
    v_perm_b32 v39, v151, v147, s47
    v_dot2c_f32_bf16_dpp v8, v16, v32 row_newbcast:3 row_mask:0xf bank_mask:0xf
    s_waitcnt vmcnt(4)
    buffer_load_dwordx4 v[180:183], v1, s[40:43], s44 offen offset:2048 nt
    s_add_u32 s44, s44, 4096
    v_dot2c_f32_bf16_dpp v9, v16, v33 row_newbcast:3 row_mask:0xf bank_mask:0xf
    v_dot2c_f32_bf16_dpp v10, v16, v34 row_newbcast:3 row_mask:0xf bank_mask:0xf
    v_dot2c_f32_bf16_dpp v11, v16, v35 row_newbcast:3 row_mask:0xf bank_mask:0xf
    v_dot2c_f32_bf16_dpp v12, v16, v36 row_newbcast:3 row_mask:0xf bank_mask:0xf
    v_dot2c_f32_bf16_dpp v13, v16, v37 row_newbcast:3 row_mask:0xf bank_mask:0xf
    v_dot2c_f32_bf16_dpp v14, v16, v38 row_newbcast:3 row_mask:0xf bank_mask:0xf
    v_dot2c_f32_bf16_dpp v15, v16, v39 row_newbcast:3 row_mask:0xf bank_mask:0xf
    v_perm_b32 v40, v156, v152, s46
    v_perm_b32 v41, v156, v152, s47
    s_waitcnt vmcnt(4)
    buffer_load_dwordx4 v[184:187], v1, s[40:43], s44 offen offset:0 nt
    v_perm_b32 v42, v157, v153, s46
    v_perm_b32 v43, v157, v153, s47
    v_perm_b32 v44, v158, v154, s46
    v_perm_b32 v45, v158, v154, s47
    v_perm_b32 v46, v159, v155, s46
    v_perm_b32 v47, v159, v155, s47
    v_dot2c_f32_bf16_dpp v8, v16, v40 row_newbcast:11 row_mask:0xf bank_mask:0xf
    v_dot2c_f32_bf16_dpp v9, v16, v41 row_newbcast:11 row_mask:0xf bank_mask:0xf
    v_dot2c_f32_bf16_dpp v10, v16, v42 row_newbcast:11 row_mask:0xf bank_mask:0xf
    v_dot2c_f32_bf16_dpp v11, v16, v43 row_newbcast:11 row_mask:0xf bank_mask:0xf
    s_waitcnt vmcnt(4)
    buffer_load_dwordx4 v[188:191], v1, s[40:43], s44 offen offset:2048 nt
    s_add_u32 s44, s44, 12288
    v_dot2c_f32_bf16_dpp v12, v16, v44 row_newbcast:11 row_mask:0xf bank_mask:0xf
    v_dot2c_f32_bf16_dpp v13, v16, v45 row_newbcast:11 row_mask:0xf bank_mask:0xf
    v_dot2c_f32_bf16_dpp v14, v16, v46 row_newbcast:11 row_mask:0xf bank_mask:0xf
    v_dot2c_f32_bf16_dpp v15, v16, v47 row_newbcast:11 row_mask:0xf bank_mask:0xf
    v_perm_b32 v32, v164, v160, s46
    v_perm_b32 v33, v164, v160, s47
    v_perm_b32 v34, v165, v161, s46
    v_perm_b32 v35, v165, v161, s47
    s_waitcnt vmcnt(4)
    buffer_load_dwordx4 v[192:195], v1, s[40:43], s44 offen offset:0 nt
    v_perm_b32 v36, v166, v162, s46
    v_perm_b32 v37, v166, v162, s47
    v_perm_b32 v38, v167, v163, s46
    v_perm_b32 v39, v167, v163, s47
    v_dot2c_f32_bf16_dpp v8, v16, v32 row_newbcast:7 row_mask:0xf bank_mask:0xf
    v_dot2c_f32_bf16_dpp v9, v16, v33 row_newbcast:7 row_mask:0xf bank_mask:0xf
    v_dot2c_f32_bf16_dpp v10, v16, v34 row_newbcast:7 row_mask:0xf bank_mask:0xf
    v_dot2c_f32_bf16_dpp v11, v16, v35 row_newbcast:7 row_mask:0xf bank_mask:0xf
    v_dot2c_f32_bf16_dpp v12, v16, v36 row_newbcast:7 row_mask:0xf bank_mask:0xf
    s_waitcnt vmcnt(4)
    buffer_load_dwordx4 v[196:199], v1, s[40:43], s44 offen offset:2048 nt
    s_add_u32 s44, s44, 4096
    v_dot2c_f32_bf16_dpp v13, v16, v37 row_newbcast:7 row_mask:0xf bank_mask:0xf
    v_dot2c_f32_bf16_dpp v14, v16, v38 row_newbcast:7 row_mask:0xf bank_mask:0xf
    v_dot2c_f32_bf16_dpp v15, v16, v39 row_newbcast:7 row_mask:0xf bank_mask:0xf
    v_perm_b32 v40, v172, v168, s46
    v_perm_b32 v41, v172, v168, s47
    v_perm_b32 v42, v173, v169, s46
    v_perm_b32 v43, v173, v169, s47
    v_perm_b32 v44, v174, v170, s46
    s_waitcnt vmcnt(4)
    buffer_load_dwordx4 v[200:203], v1, s[40:43], s44 offen offset:0 nt
    v_perm_b32 v45, v174, v170, s47
    v_perm_b32 v46, v175, v171, s46
    v_perm_b32 v47, v175, v171, s47
    v_dot2c_f32_bf16_dpp v8, v16, v40 row_newbcast:15 row_mask:0xf bank_mask:0xf
    v_dot2c_f32_bf16_dpp v9, v16, v41 row_newbcast:15 row_mask:0xf bank_mask:0xf
    v_dot2c_f32_bf16_dpp v10, v16, v42 row_newbcast:15 row_mask:0xf bank_mask:0xf
    v_dot2c_f32_bf16_dpp v11, v16, v43 row_newbcast:15 row_mask:0xf bank_mask:0xf
    v_dot2c_f32_bf16_dpp v12, v16, v44 row_newbcast:15 row_mask:0xf bank_mask:0xf
    v_dot2c_f32_bf16_dpp v13, v16, v45 row_newbcast:15 row_mask:0xf bank_mask:0xf
    s_waitcnt vmcnt(4)
    buffer_load_dwordx4 v[204:207], v1, s[40:43], s44 offen offset:2048 nt
    s_add_u32 s44, s44, 12288
    s_and_b32 s44, s44, 0xfffff
    v_dot2c_f32_bf16_dpp v14, v16, v46 row_newbcast:15 row_mask:0xf bank_mask:0xf
    v_dot2c_f32_bf16_dpp v15, v16, v47 row_newbcast:15 row_mask:0xf bank_mask:0xf
    v_mov_b32 v16, v17
    v_mov_b32 v17, v18
    v_mov_b32 v18, v19
    v_mov_b32 v19, v20
    v_mov_b32 v20, v21
    v_mov_b32 v21, v22
    v_mov_b32 v22, v23
    s_sub_u32 s45, s45, 1
    s_cmp_lg_u32 s45, 0
    s_cbranch_scc1 L_topV
    s_branch L_xV
L_BV:
    s_sub_u32 s56, s56, 9
    s_waitcnt vmcnt(4)
    buffer_load_dwordx4 v[144:147], v1, s[40:43], s44 offen offset:0 nt
    v_perm_b32 v32, v180, v176, s46
    v_perm_b32 v33, v180, v176, s47
    v_perm_b32 v34, v181, v177, s46
    v_perm_b32 v35, v181, v177, s47
    v_perm_b32 v36, v182, v178, s46
    v_perm_b32 v37, v182, v178, s47
    v_perm_b32 v38, v183, v179, s46
    v_perm_b32 v39, v183, v179, s47
    buffer_load_dwordx4 v[148:151], v1, s[40:43], s44 offen offset:2048 nt
    s_add_u32 s44, s44, 4096
    v_dot2c_f32_bf16_dpp v8, v16, v32 row_newbcast:0 row_mask:0xf bank_mask:0xf
    v_dot2c_f32_bf16_dpp v9, v16, v33 row_newbcast:0 row_mask:0xf bank_mask:0xf
    v_dot2c_f32_bf16_dpp v10, v16, v34 row_newbcast:0 row_mask:0xf bank_mask:0xf
    v_dot2c_f32_bf16_dpp v11, v16, v35 row_newbcast:0 row_mask:0xf bank_mask:0xf
    v_dot2c_f32_bf16_dpp v12, v16, v36 row_newbcast:0 row_mask:0xf bank_mask:0xf
    v_dot2c_f32_bf16_dpp v13, v16, v37 row_newbcast:0 row_mask:0xf bank_mask:0xf
    v_dot2c_f32_bf16_dpp v14, v16, v38 row_newbcast:0 row_mask:0xf bank_mask:0xf
    v_dot2c_f32_bf16_dpp v15, v16, v39 row_newbcast:0 row_mask:0xf bank_mask:0xf
    s_waitcnt vmcnt(4)
    buffer_load_dwordx4 v[152:155], v1, s[40:43], s44 offen offset:0 nt
    v_perm_b32 v40, v188, v184, s46
    v_perm_b32 v41, v188, v184, s47
    v_perm_b32 v42, v189, v185, s46
    v_perm_b32 v43, v189, v185, s47
    v_perm_b32 v44, v190, v186, s46
    v_perm_b32 v45, v190, v186, s47
    v_perm_b32 v46, v191, v187, s46
    v_perm_b32 v47, v191, v187, s47
    v_dot2c_f32_bf16_dpp v8, v16, v40 row_newbcast:8 row_mask:0xf bank_mask:0xf
    buffer_load_dwordx4 v[156:159], v1, s[40:43], s44 offen offset:2048 nt
    s_add_u32 s44, s44, 12288
    v_dot2c_f32_bf16_dpp v9, v16, v41 row_newbcast:8 row_mask:0xf bank_mask:0xf
    v_dot2c_f32_bf16_dpp v10, v16, v42 row_newbcast:8 row_mask:0xf bank_mask:0xf
    v_dot2c_f32_bf16_dpp v11, v16, v43 row_newbcast:8 row_mask:0xf bank_mask:0xf
    v_dot2c_f32_bf16_dpp v12, v16, v44 row_newbcast:8 row_mask:0xf bank_mask:0xf
    v_dot2c_f32_bf16_dpp v13, v16, v45 row_newbcast:8 row_mask:0xf bank_mask:0xf
    v_dot2c_f32_bf16_dpp v14, v16, v46 row_newbcast:8 row_mask:0xf bank_mask:0xf
    v_dot2c_f32_bf16_dpp v15, v16, v47 row_newbcast:8 row_mask:0xf bank_mask:0xf
    v_perm_b32 v32, v196, v192, s46
    s_waitcnt vmcnt(4)
    buffer_load_dwordx4 v[160:163], v1, s[40:43], s44 offen offset:0 nt
    v_perm_b32 v33, v196, v192, s47
    v_perm_b32 v34, v197, v193, s46
    v_perm_b32 v35, v197, v193, s47
    v_perm_b32 v36, v198, v194, s46
    v_perm_b32 v37, v198, v194, s47
    v_perm_b32 v38, v199, v195, s46
    v_perm_b32 v39, v199, v195, s47
    v_dot2c_f32_bf16_dpp v8, v16, v32 row_newbcast:4 row_mask:0xf bank_mask:0xf
    buffer_load_dwordx4 v[164:167], v1, s[40:43], s44 offen offset:2048 nt
    s_add_u32 s44, s44, 4096
    v_dot2c_f32_bf16_dpp v9, v16, v33 row_newbcast:4 row_mask:0xf bank_mask:0xf
    v_dot2c_f32_bf16_dpp v10, v16, v34 row_newbcast:4 row_mask:0xf bank_mask:0xf
    v_dot2c_f32_bf16_dpp v11, v16, v35 row_newbcast:4 row_mask:0xf bank_mask:0xf
    v_dot2c_f32_bf16_dpp v12, v16, v36 row_newbcast:4 row_mask:0xf bank_mask:0xf
    v_dot2c_f32_bf16_dpp v13, v16, v37 row_newbcast:4 row_mask:0xf bank_mask:0xf
    v_dot2c_f32_bf16_dpp v14, v16, v38 row_newbcast:4 row_mask:0xf bank_mask:0xf
    v_dot2c_f32_bf16_dpp v15, v16, v39 row_newbcast:4 row_mask:0xf bank_mask:0xf
    s_waitcnt vmcnt(4)
    buffer_load_dwordx4 v[168:171], v1, s[40:43], s44 offen offset:0 nt
    v_perm_b32 v40, v204, v200, s46
    v_perm_b32 v41, v204, v200, s47
    v_perm_b32 v42, v205, v201, s46
    v_perm_b32 v43, v205, v201, s47
    v_perm_b32 v44, v206, v202, s46
    v_perm_b32 v45, v206, v202, s47
    v_perm_b32 v46, v207, v203, s46
    v_perm_b32 v47, v207, v203, s47
    buffer_load_dwordx4 v[172:175], v1, s[40:43], s44 offen offset:2048 nt
    s_add_u32 s44, s44, 12288
    s_and_b32 s44, s44, 0xfffff
    v_dot2c_f32_bf16_dpp v8, v16, v40 row_newbcast:12 row_mask:0xf bank_mask:0xf
    v_dot2c_f32_bf16_dpp v9, v16, v41 row_newbcast:12 row_mask:0xf bank_mask:0xf
    v_dot2c_f32_bf16_dpp v10, v16, v42 row_newbcast:12 row_mask:0xf bank_mask:0xf
    v_dot2c_f32_bf16_dpp v11, v16, v43 row_newbcast:12 row_mask:0xf bank_mask:0xf
    v_dot2c_f32_bf16_dpp v12, v16, v44 row_newbcast:12 row_mask:0xf bank_mask:0xf
    v_dot2c_f32_bf16_dpp v13, v16, v45 row_newbcast:12 row_mask:0xf bank_mask:0xf
    v_dot2c_f32_bf16_dpp v14, v16, v46 row_newbcast:12 row_mask:0xf bank_mask:0xf
    v_dot2c_f32_bf16_dpp v15, v16, v47 row_newbcast:12 row_mask:0xf bank_mask:0xf
    s_waitcnt vmcnt(4)
    buffer_load_dwordx4 v[176:179], v1, s[40:43], s44 offen offset:0 nt
    v_perm_b32 v32, v148, v144, s46
    v_perm_b32 v33, v148, v144, s47
    v_perm_b32 v34, v149, v145, s46
    v_perm_b32 v35, v149, v145, s47
    v_perm_b32 v36, v150, v146, s46
    v_perm_b32 v37, v150, v146, s47
    v_perm_b32 v38, v151, v147, s46
    v_perm_b32 v39, v151, v147, s47
    buffer_load_dwordx4 v[180:183], v1, s[40:43], s44 offen offset:2048 nt
    s_add_u32 s44, s44, 4096
    v_dot2c_f32_bf16_dpp v8, v16, v32 row_newbcast:1 row_mask:0xf bank_mask:0xf
    v_dot2c_f32_bf16_dpp v9, v16, v33 row_newbcast:1 row_mask:0xf bank_mask:0xf
    v_dot2c_f32_bf16_dpp v10, v16, v34 row_newbcast:1 row_mask:0xf bank_mask:0xf
    v_dot2c_f32_bf16_dpp v11, v16, v35 row_newbcast:1 row_mask:0xf bank_mask:0xf
    v_dot2c_f32_bf16_dpp v12, v16, v36 row_newbcast:1 row_mask:0xf bank_mask:0xf
    v_dot2c_f32_bf16_dpp v13, v16, v37 row_newbcast:1 row_mask:0xf bank_mask:0xf
    v_dot2c_f32_bf16_dpp v14, v16, v38 row_newbcast:1 row_mask:0xf bank_mask:0xf
    v_dot2c_f32_bf16_dpp v15, v16, v39 row_newbcast:1 row_mask:0xf bank_mask:0xf
    s_waitcnt vmcnt(4)
    buffer_load_dwordx4 v[184:187], v1, s[40:43], s44 offen offset:0 nt
    v_perm_b32 v40, v156, v152, s46
    v_perm_b32 v41, v156, v152, s47
    v_perm_b32 v42, v157, v153, s46
    v_perm_b32 v43, v157, v153, s47
    v_perm_b32 v44, v158, v154, s46
    v_perm_b32 v45, v158, v154, s47
    v_perm_b32 v46, v159, v155, s46
    v_perm_b32 v47, v159, v155, s47
    v_dot2c_f32_bf16_dpp v8, v16, v40 row_newbcast:9 row_mask:0xf bank_mask:0xf
    buffer_load_dwordx4 v[188:191], v1, s[40:43], s44 offen offset:2048 nt
    s_add_u32 s44, s44, 12288
    v_dot2c_f32_bf16_dpp v9, v16, v41 row_newbcast:9 row_mask:0xf bank_mask:0xf
    v_dot2c_f32_bf16_dpp v10, v16, v42 row_newbcast:9 row_mask:0xf bank_mask:0xf
    v_dot2c_f32_bf16_dpp v11, v16, v43 row_newbcast:9 row_mask:0xf bank_mask:0xf
    v_dot2c_f32_bf16_dpp v12, v16, v44 row_newbcast:9 row_mask:0xf bank_mask:0xf
    v_dot2c_f32_bf16_dpp v13, v16, v45 row_newbcast:9 row_mask:0xf bank_mask:0xf
    v_dot2c_f32_bf16_dpp v14, v16, v46 row_newbcast:9 row_mask:0xf bank_mask:0xf
    v_dot2c_f32_bf16_dpp v15, v16, v47 row_newbcast:9 row_mask:0xf bank_mask:0xf
    v_perm_b32 v32, v164, v160, s46
    s_waitcnt vmcnt(4)
    buffer_load_dwordx4 v[192:195], v1, s[40:43], s44 offen offset:0 nt
    v_perm_b32 v33, v164, v160, s47
    v_perm_b32 v34, v165, v161, s46
    v_perm_b32 v35, v165, v161, s47
    v_perm_b32 v36, v166, v162, s46
    v_perm_b32 v37, v166, v162, s47
    v_perm_b32 v38, v167, v163, s46
    v_perm_b32 v39, v167, v163, s47
    v_dot2c_f32_bf16_dpp v8, v16, v32 row_newbcast:5 row_mask:0xf bank_mask:0xf
    buffer_load_dwordx4 v[196:199], v1, s[40:43], s44 offen offset:2048 nt
    s_add_u32 s44, s44, 4096
    v_dot2c_f32_bf16_dpp v9, v16, v33 row_newbcast:5 row_mask:0xf bank_mask:0xf
    v_dot2c_f32_bf16_dpp v10, v16, v34 row_newbcast:5 row_mask:0xf bank_mask:0xf
    v_dot2c_f32_bf16_dpp v11, v16, v35 row_newbcast:5 row_mask:0xf bank_mask:0xf
    v_dot2c_f32_bf16_dpp v12, v16, v36 row_newbcast:5 row_mask:0xf bank_mask:0xf
    v_dot2c_f32_bf16_dpp v13, v16, v37 row_newbcast:5 row_mask:0xf bank_mask:0xf
    v_dot2c_f32_bf16_dpp v14, v16, v38 row_newbcast:5 row_mask:0xf bank_mask:0xf
    v_dot2c_f32_bf16_dpp v15, v16, v39 row_newbcast:5 row_mask:0xf bank_mask:0xf
    s_waitcnt vmcnt(4)
    buffer_load_dwordx4 v[200:203], v1, s[40:43], s44 offen offset:0 nt
    v_perm_b32 v40, v172, v168, s46
    v_perm_b32 v41, v172, v168, s47
    v_perm_b32 v42, v173, v169, s46
    v_perm_b32 v43, v173, v169, s47
    v_perm_b32 v44, v174, v170, s46
    v_perm_b32 v45, v174, v170, s47
    v_perm_b32 v46, v175, v171, s46
    v_perm_b32 v47, v175, v171, s47
    buffer_load_dwordx4 v[204:207], v1, s[40:43], s44 offen offset:2048 nt
    s_add_u32 s44, s44, 12288
    s_and_b32 s44, s44, 0xfffff
    v_dot2c_f32_bf16_dpp v8, v16, v40 row_newbcast:13 row_mask:0xf bank_mask:0xf
    v_dot2c_f32_bf16_dpp v9, v16, v41 row_newbcast:13 row_mask:0xf bank_mask:0xf
    v_dot2c_f32_bf16_dpp v10, v16, v42 row_newbcast:13 row_mask:0xf bank_mask:0xf
    v_dot2c_f32_bf16_dpp v11, v16, v43 row_newbcast:13 row_mask:0xf bank_mask:0xf
    v_dot2c_f32_bf16_dpp v12, v16, v44 row_newbcast:13 row_mask:0xf bank_mask:0xf
    v_dot2c_f32_bf16_dpp v13, v16, v45 row_newbcast:13 row_mask:0xf bank_mask:0xf
    v_dot2c_f32_bf16_dpp v14, v16, v46 row_newbcast:13 row_mask:0xf bank_mask:0xf
    v_dot2c_f32_bf16_dpp v15, v16, v47 row_newbcast:13 row_mask:0xf bank_mask:0xf
    s_waitcnt vmcnt(4)
    buffer_load_dwordx4 v[144:147], v1, s[40:43], s44 offen offset:0 nt
    v_perm_b32 v32, v180, v176, s46
    v_perm_b32 v33, v180, v176, s47
    v_perm_b32 v34, v181, v177, s46
    v_perm_b32 v35, v181, v177, s47
    v_perm_b32 v36, v182, v178, s46
    v_perm_b32 v37, v182, v178, s47
    v_perm_b32 v38, v183, v179, s46
    v_perm_b32 v39, v183, v179, s47
    buffer_load_dwordx4 v[148:151], v1, s[40:43], s44 offen offset:2048 nt
    s_add_u32 s44, s44, 4096
    v_dot2c_f32_bf16_dpp v8, v16, v32 row_newbcast:2 row_mask:0xf bank_mask:0xf
    v_dot2c_f32_bf16_dpp v9, v16, v33 row_newbcast:2 row_mask:0xf bank_mask:0xf
    v_dot2c_f32_bf16_dpp v10, v16, v34 row_newbcast:2 row_mask:0xf bank_mask:0xf
    v_dot2c_f32_bf16_dpp v11, v16, v35 row_newbcast:2 row_mask:0xf bank_mask:0xf
    v_dot2c_f32_bf16_dpp v12, v16, v36 row_newbcast:2 row_mask:0xf bank_mask:0xf
    v_dot2c_f32_bf16_dpp v13, v16, v37 row_newbcast:2 row_mask:0xf bank_mask:0xf
    v_dot2c_f32_bf16_dpp v14, v16, v38 row_newbcast:2 row_mask:0xf bank_mask:0xf
    v_dot2c_f32_bf16_dpp v15, v16, v39 row_newbcast:2 row_mask:0xf bank_mask:0xf
    s_waitcnt vmcnt(4)
    buffer_load_dwordx4 v[152:155], v1, s[40:43], s44 offen offset:0 nt
    v_perm_b32 v40, v188, v184, s46
    v_perm_b32 v41, v188, v184, s47
    v_perm_b32 v42, v189, v185, s46
    v_perm_b32 v43, v189, v185, s47
    v_perm_b32 v44, v190, v186, s46
    v_perm_b32 v45, v190, v186, s47
    v_perm_b32 v46, v191, v187, s46
    v_perm_b32 v47, v191, v187, s47
    v_dot2c_f32_bf16_dpp v8, v16, v40 row_newbcast:10 row_mask:0xf bank_mask:0xf
    buffer_load_dwordx4 v[156:159], v1, s[40:43], s44 offen offset:2048 nt
    s_add_u32 s44, s44, 12288
    v_dot2c_f32_bf16_dpp v9, v16, v41 row_newbcast:10 row_mask:0xf bank_mask:0xf
    v_dot2c_f32_bf16_dpp v10, v16, v42 row_newbcast:10 row_mask:0xf bank_mask:0xf
    v_dot2c_f32_bf16_dpp v11, v16, v43 row_newbcast:10 row_mask:0xf bank_mask:0xf
    v_dot2c_f32_bf16_dpp v12, v16, v44 row_newbcast:10 row_mask:0xf bank_mask:0xf
    v_dot2c_f32_bf16_dpp v13, v16, v45 row_newbcast:10 row_mask:0xf bank_mask:0xf
    v_dot2c_f32_bf16_dpp v14, v16, v46 row_newbcast:10 row_mask:0xf bank_mask:0xf
    v_dot2c_f32_bf16_dpp v15, v16, v47 row_newbcast:10 row_mask:0xf bank_mask:0xf
    v_perm_b32 v32, v196, v192, s46
    s_waitcnt vmcnt(4)
    buffer_load_dwordx4 v[160:163], v1, s[40:43], s44 offen offset:0 nt
    v_perm_b32 v33, v196, v192, s47
    v_perm_b32 v34, v197, v193, s46
    v_perm_b32 v35, v197, v193, s47
    v_perm_b32 v36, v198, v194, s46
    v_perm_b32 v37, v198, v194, s47
    v_perm_b32 v38, v199, v195, s46
    v_perm_b32 v39, v199, v195, s47
    v_dot2c_f32_bf16_dpp v8, v16, v32 row_newbcast:6 row_mask:0xf bank_mask:0xf
    buffer_load_dwordx4 v[164:167], v1, s[40:43], s44 offen offset:2048 nt
    s_add_u32 s44, s44, 4096
    v_dot2c_f32_bf16_dpp v9, v16, v33 row_newbcast:6 row_mask:0xf bank_mask:0xf
    v_dot2c_f32_bf16_dpp v10, v16, v34 row_newbcast:6 row_mask:0xf bank_mask:0xf
    v_dot2c_f32_bf16_dpp v11, v16, v35 row_newbcast:6 row_mask:0xf bank_mask:0xf
    v_dot2c_f32_bf16_dpp v12, v16, v36 row_newbcast:6 row_mask:0xf bank_mask:0xf
    v_dot2c_f32_bf16_dpp v13, v16, v37 row_newbcast:6 row_mask:0xf bank_mask:0xf
    v_dot2c_f32_bf16_dpp v14, v16, v38 row_newbcast:6 row_mask:0xf bank_mask:0xf
    v_dot2c_f32_bf16_dpp v15, v16, v39 row_newbcast:6 row_mask:0xf bank_mask:0xf
    s_waitcnt vmcnt(4)
    buffer_load_dwordx4 v[168:171], v1, s[40:43], s44 offen offset:0 nt
    v_perm_b32 v40, v204, v200, s46
    v_perm_b32 v41, v204, v200, s47
    v_perm_b32 v42, v205, v201, s46
    v_perm_b32 v43, v205, v201, s47
    v_perm_b32 v44, v206, v202, s46
    v_perm_b32 v45, v206, v202, s47
    v_perm_b32 v46, v207, v203, s46
    v_perm_b32 v47, v207, v203, s47
    buffer_load_dwordx4 v[172:175], v1, s[40:43], s44 offen offset:2048 nt
    s_add_u32 s44, s44, 12288
    s_and_b32 s44, s44, 0xfffff
    v_dot2c_f32_bf16_dpp v8, v16, v40 row_newbcast:14 row_mask:0xf bank_mask:0xf
    v_dot2c_f32_bf16_dpp v9, v16, v41 row_newbcast:14 row_mask:0xf bank_mask:0xf
    v_dot2c_f32_bf16_dpp v10, v16, v42 row_newbcast:14 row_mask:0xf bank_mask:0xf
    v_dot2c_f32_bf16_dpp v11, v16, v43 row_newbcast:14 row_mask:0xf bank_mask:0xf
    v_dot2c_f32_bf16_dpp v12, v16, v44 row_newbcast:14 row_mask:0xf bank_mask:0xf
    v_dot2c_f32_bf16_dpp v13, v16, v45 row_newbcast:14 row_mask:0xf bank_mask:0xf
    v_dot2c_f32_bf16_dpp v14, v16, v46 row_newbcast:14 row_mask:0xf bank_mask:0xf
    v_dot2c_f32_bf16_dpp v15, v16, v47 row_newbcast:14 row_mask:0xf bank_mask:0xf
    s_waitcnt vmcnt(4)
    buffer_load_dwordx4 v[176:179], v1, s[40:43], s44 offen offset:0 nt
    v_perm_b32 v32, v148, v144, s46
    v_perm_b32 v33, v148, v144, s47
    v_perm_b32 v34, v149, v145, s46
    v_perm_b32 v35, v149, v145, s47
    v_perm_b32 v36, v150, v146, s46
    v_perm_b32 v37, v150, v146, s47
    v_perm_b32 v38, v151, v147, s46
    v_perm_b32 v39, v151, v147, s47
    v_dot2c_f32_bf16_dpp v8, v16, v32 row_newbcast:3 row_mask:0xf bank_mask:0xf
    buffer_load_dwordx4 v[180:183], v1, s[40:43], s44 offen offset:2048 nt
    s_add_u32 s44, s44, 4096
    v_dot2c_f32_bf16_dpp v9, v16, v33 row_newbcast:3 row_mask:0xf bank_mask:0xf
    v_dot2c_f32_bf16_dpp v10, v16, v34 row_newbcast:3 row_mask:0xf bank_mask:0xf
    v_dot2c_f32_bf16_dpp v11, v16, v35 row_newbcast:3 row_mask:0xf bank_mask:0xf
    v_dot2c_f32_bf16_dpp v12, v16, v36 row_newbcast:3 row_mask:0xf bank_mask:0xf
    v_dot2c_f32_bf16_dpp v13, v16, v37 row_newbcast:3 row_mask:0xf bank_mask:0xf
    v_dot2c_f32_bf16_dpp v14, v16, v38 row_newbcast:3 row_mask:0xf bank_mask:0xf
    v_dot2c_f32_bf16_dpp v15, v16, v39 row_newbcast:3 row_mask:0xf bank_mask:0xf
    v_perm_b32 v40, v156, v152, s46
    v_perm_b32 v41, v156, v152, s47
    s_waitcnt vmcnt(4)
    buffer_load_dwordx4 v[184:187], v1, s[40:43], s44 offen offset:0 nt
    v_perm_b32 v42, v157, v153, s46
    v_perm_b32 v43, v157, v153, s47
    v_perm_b32 v44, v158, v154, s46
    v_perm_b32 v45, v158, v154, s47
    v_perm_b32 v46, v159, v155, s46
    v_perm_b32 v47, v159, v155, s47
    v_dot2c_f32_bf16_dpp v8, v16, v40 row_newbcast:11 row_mask:0xf bank_mask:0xf
    v_dot2c_f32_bf16_dpp v9, v16, v41 row_newbcast:11 row_mask:0xf bank_mask:0xf
    v_dot2c_f32_bf16_dpp v10, v16, v42 row_newbcast:11 row_mask:0xf bank_mask:0xf
    v_dot2c_f32_bf16_dpp v11, v16, v43 row_newbcast:11 row_mask:0xf bank_mask:0xf
    buffer_load_dwordx4 v[188:191], v1, s[40:43], s44 offen offset:2048 nt
    s_add_u32 s44, s44, 12288
    v_dot2c_f32_bf16_dpp v12, v16, v44 row_newbcast:11 row_mask:0xf bank_mask:0xf
    v_dot2c_f32_bf16_dpp v13, v16, v45 row_newbcast:11 row_mask:0xf bank_mask:0xf
    v_dot2c_f32_bf16_dpp v14, v16, v46 row_newbcast:11 row_mask:0xf bank_mask:0xf
    v_dot2c_f32_bf16_dpp v15, v16, v47 row_newbcast:11 row_mask:0xf bank_mask:0xf
    v_perm_b32 v32, v164, v160, s46
    v_perm_b32 v33, v164, v160, s47
    v_perm_b32 v34, v165, v161, s46
    v_perm_b32 v35, v165, v161, s47
    s_waitcnt vmcnt(4)
    buffer_load_dwordx4 v[192:195], v1, s[40:43], s44 offen offset:0 nt
    v_perm_b32 v36, v166, v162, s46
    v_perm_b32 v37, v166, v162, s47
    v_perm_b32 v38, v167, v163, s46
    v_perm_b32 v39, v167, v163, s47
    v_dot2c_f32_bf16_dpp v8, v16, v32 row_newbcast:7 row_mask:0xf bank_mask:0xf
    v_dot2c_f32_bf16_dpp v9, v16, v33 row_newbcast:7 row_mask:0xf bank_mask:0xf
    v_dot2c_f32_bf16_dpp v10, v16, v34 row_newbcast:7 row_mask:0xf bank_mask:0xf
    v_dot2c_f32_bf16_dpp v11, v16, v35 row_newbcast:7 row_mask:0xf bank_mask:0xf
    v_dot2c_f32_bf16_dpp v12, v16, v36 row_newbcast:7 row_mask:0xf bank_mask:0xf
    buffer_load_dwordx4 v[196:199], v1, s[40:43], s44 offen offset:2048 nt
    s_add_u32 s44, s44, 4096
    v_dot2c_f32_bf16_dpp v13, v16, v37 row_newbcast:7 row_mask:0xf bank_mask:0xf
    v_dot2c_f32_bf16_dpp v14, v16, v38 row_newbcast:7 row_mask:0xf bank_mask:0xf
    v_dot2c_f32_bf16_dpp v15, v16, v39 row_newbcast:7 row_mask:0xf bank_mask:0xf
    v_perm_b32 v40, v172, v168, s46
    v_perm_b32 v41, v172, v168, s47
    v_perm_b32 v42, v173, v169, s46
    v_perm_b32 v43, v173, v169, s47
    v_perm_b32 v44, v174, v170, s46
    s_waitcnt vmcnt(4)
    buffer_load_dwordx4 v[200:203], v1, s[40:43], s44 offen offset:0 nt
    v_perm_b32 v45, v174, v170, s47
    v_perm_b32 v46, v175, v171, s46
    v_perm_b32 v47, v175, v171, s47
    v_dot2c_f32_bf16_dpp v8, v16, v40 row_newbcast:15 row_mask:0xf bank_mask:0xf
    v_dot2c_f32_bf16_dpp v9, v16, v41 row_newbcast:15 row_mask:0xf bank_mask:0xf
    v_dot2c_f32_bf16_dpp v10, v16, v42 row_newbcast:15 row_mask:0xf bank_mask:0xf
    v_dot2c_f32_bf16_dpp v11, v16, v43 row_newbcast:15 row_mask:0xf bank_mask:0xf
    v_dot2c_f32_bf16_dpp v12, v16, v44 row_newbcast:15 row_mask:0xf bank_mask:0xf
    v_dot2c_f32_bf16_dpp v13, v16, v45 row_newbcast:15 row_mask:0xf bank_mask:0xf
    buffer_load_dwordx4 v[204:207], v1, s[40:43], s44 offen offset:2048 nt
    s_add_u32 s44, s44, 12288
    s_and_b32 s44, s44, 0xfffff
    v_dot2c_f32_bf16_dpp v14, v16, v46 row_newbcast:15 row_mask:0xf bank_mask:0xf
    v_dot2c_f32_bf16_dpp v15, v16, v47 row_newbcast:15 row_mask:0xf bank_mask:0xf
    v_mov_b32 v16, v17
    v_mov_b32 v17, v18
    v_mov_b32 v18, v19
    v_mov_b32 v19, v20
    v_mov_b32 v20, v21
    v_mov_b32 v21, v22
    v_mov_b32 v22, v23
    s_sub_u32 s45, s45, 1
    s_cmp_lg_u32 s45, 0
    s_cbranch_scc1 L_topV
L_xV:
    buffer_load_dwordx4 v[144:147], v1, s[40:43], s44 offen offset:0 nt
    v_perm_b32 v32, v180, v176, s46
    v_perm_b32 v33, v180, v176, s47
    v_perm_b32 v34, v181, v177, s46
    v_perm_b32 v35, v181, v177, s47
    v_perm_b32 v36, v182, v178, s46
    v_perm_b32 v37, v182, v178, s47
    v_perm_b32 v38, v183, v179, s46
    v_perm_b32 v39, v183, v179, s47
    buffer_load_dwordx4 v[148:151], v1, s[40:43], s44 offen offset:2048 nt
    s_add_u32 s44, s44, 4096
    v_dot2c_f32_bf16_dpp v8, v16, v32 row_newbcast:0 row_mask:0xf bank_mask:0xf
    v_dot2c_f32_bf16_dpp v9, v16, v33 row_newbcast:0 row_mask:0xf bank_mask:0xf
    v_dot2c_f32_bf16_dpp v10, v16, v34 row_newbcast:0 row_mask:0xf bank_mask:0xf
    v_dot2c_f32_bf16_dpp v11, v16, v35 row_newbcast:0 row_mask:0xf bank_mask:0xf
    v_dot2c_f32_bf16_dpp v12, v16, v36 row_newbcast:0 row_mask:0xf bank_mask:0xf
    v_dot2c_f32_bf16_dpp v13, v16, v37 row_newbcast:0 row_mask:0xf bank_mask:0xf
    v_dot2c_f32_bf16_dpp v14, v16, v38 row_newbcast:0 row_mask:0xf bank_mask:0xf
    v_dot2c_f32_bf16_dpp v15, v16, v39 row_newbcast:0 row_mask:0xf bank_mask:0xf
    s_waitcnt vmcnt(7)
    buffer_load_dwordx4 v[152:155], v1, s[40:43], s44 offen offset:0 nt
    s_waitcnt vmcnt(7)
    buffer_load_dwordx4 v[156:159], v1, s[40:43], s44 offen offset:2048 nt
    s_add_u32 s44, s44, 12288
    v_perm_b32 v40, v188, v184, s46
    v_perm_b32 v41, v188, v184, s47
    v_perm_b32 v42, v189, v185, s46
    v_perm_b32 v43, v189, v185, s47
    v_perm_b32 v44, v190, v186, s46
    v_perm_b32 v45, v190, v186, s47
    v_perm_b32 v46, v191, v187, s46
    v_perm_b32 v47, v191, v187, s47
    v_dot2c_f32_bf16_dpp v8, v16, v40 row_newbcast:8 row_mask:0xf bank_mask:0xf
    v_dot2c_f32_bf16_dpp v9, v16, v41 row_newbcast:8 row_mask:0xf bank_mask:0xf
    s_waitcnt vmcnt(7)
    buffer_load_dwordx4 v[160:163], v1, s[40:43], s44 offen offset:0 nt
    v_dot2c_f32_bf16_dpp v10, v16, v42 row_newbcast:8 row_mask:0xf bank_mask:0xf
    v_dot2c_f32_bf16_dpp v11, v16, v43 row_newbcast:8 row_mask:0xf bank_mask:0xf
    v_dot2c_f32_bf16_dpp v12, v16, v44 row_newbcast:8 row_mask:0xf bank_mask:0xf
    v_dot2c_f32_bf16_dpp v13, v16, v45 row_newbcast:8 row_mask:0xf bank_mask:0xf
    v_dot2c_f32_bf16_dpp v14, v16, v46 row_newbcast:8 row_mask:0xf bank_mask:0xf
    v_dot2c_f32_bf16_dpp v15, v16, v47 row_newbcast:8 row_mask:0xf bank_mask:0xf
    s_waitcnt vmcnt(7)
    buffer_load_dwordx4 v[164:167], v1, s[40:43], s44 offen offset:2048 nt
    s_add_u32 s44, s44, 4096
    v_perm_b32 v32, v196, v192, s46
    v_perm_b32 v33, v196, v192, s47
    v_perm_b32 v34, v197, v193, s46
    v_perm_b32 v35, v197, v193, s47
    v_perm_b32 v36, v198, v194, s46
    v_perm_b32 v37, v198, v194, s47
    v_perm_b32 v38, v199, v195, s46
    v_perm_b32 v39, v199, v195, s47
    v_dot2c_f32_bf16_dpp v8, v16, v32 row_newbcast:4 row_mask:0xf bank_mask:0xf
    v_dot2c_f32_bf16_dpp v9, v16, v33 row_newbcast:4 row_mask:0xf bank_mask:0xf
    v_dot2c_f32_bf16_dpp v10, v16, v34 row_newbcast:4 row_mask:0xf bank_mask:0xf
    s_waitcnt vmcnt(7)
    buffer_load_dwordx4 v[168:171], v1, s[40:43], s44 offen offset:0 nt
    v_dot2c_f32_bf16_dpp v11, v16, v35 row_newbcast:4 row_mask:0xf bank_mask:0xf
    v_dot2c_f32_bf16_dpp v12, v16, v36 row_newbcast:4 row_mask:0xf bank_mask:0xf
    v_dot2c_f32_bf16_dpp v13, v16, v37 row_newbcast:4 row_mask:0xf bank_mask:0xf
    v_dot2c_f32_bf16_dpp v14, v16, v38 row_newbcast:4 row_mask:0xf bank_mask:0xf
    v_dot2c_f32_bf16_dpp v15, v16, v39 row_newbcast:4 row_mask:0xf bank_mask:0xf
    s_waitcnt vmcnt(7)
    buffer_load_dwordx4 v[172:175], v1, s[40:43], s44 offen offset:2048 nt
    s_add_u32 s44, s44, 12288
    s_and_b32 s44, s44, 0xfffff
    v_perm_b32 v40, v204, v200, s46
    v_perm_b32 v41, v204, v200, s47
    v_perm_b32 v42, v205, v201, s46
    v_perm_b32 v43, v205, v201, s47
    v_perm_b32 v44, v206, v202, s46
    v_perm_b32 v45, v206, v202, s47
    v_perm_b32 v46, v207, v203, s46
    v_perm_b32 v47, v207, v203, s47
    v_dot2c_f32_bf16_dpp v8, v16, v40 row_newbcast:12 row_mask:0xf bank_mask:0xf
    v_dot2c_f32_bf16_dpp v9, v16, v41 row_newbcast:12 row_mask:0xf bank_mask:0xf
    v_dot2c_f32_bf16_dpp v10, v16, v42 row_newbcast:12 row_mask:0xf bank_mask:0xf
    v_dot2c_f32_bf16_dpp v11, v16, v43 row_newbcast:12 row_mask:0xf bank_mask:0xf
    v_dot2c_f32_bf16_dpp v12, v16, v44 row_newbcast:12 row_mask:0xf bank_mask:0xf
    v_dot2c_f32_bf16_dpp v13, v16, v45 row_newbcast:12 row_mask:0xf bank_mask:0xf
    v_dot2c_f32_bf16_dpp v14, v16, v46 row_newbcast:12 row_mask:0xf bank_mask:0xf
    v_dot2c_f32_bf16_dpp v15, v16, v47 row_newbcast:12 row_mask:0xf bank_mask:0xf
    s_waitcnt vmcnt(7)
    buffer_load_dwordx4 v[80:83], v1, s[40:43], s44 offen offset:0 nt
    s_waitcnt vmcnt(7)
    buffer_load_dwordx4 v[84:87], v1, s[40:43], s44 offen offset:2048 nt
    s_add_u32 s44, s44, 4096
    v_perm_b32 v32, v148, v144, s46
    v_perm_b32 v33, v148, v144, s47
    v_perm_b32 v34, v149, v145, s46
    v_perm_b32 v35, v149, v145, s47
    v_perm_b32 v36, v150, v146, s46
    v_perm_b32 v37, v150, v146, s47
    v_perm_b32 v38, v151, v147, s46
    v_perm_b32 v39, v151, v147, s47
    v_dot2c_f32_bf16_dpp v8, v16, v32 row_newbcast:1 row_mask:0xf bank_mask:0xf
    s_waitcnt vmcnt(7)
    buffer_load_dwordx4 v[88:91], v1, s[40:43], s44 offen offset:0 nt
    v_dot2c_f32_bf16_dpp v9, v16, v33 row_newbcast:1 row_mask:0xf bank_mask:0xf
    v_dot2c_f32_bf16_dpp v10, v16, v34 row_newbcast:1 row_mask:0xf bank_mask:0xf
    v_dot2c_f32_bf16_dpp v11, v16, v35 row_newbcast:1 row_mask:0xf bank_mask:0xf
    v_dot2c_f32_bf16_dpp v12, v16, v36 row_newbcast:1 row_mask:0xf bank_mask:0xf
    v_dot2c_f32_bf16_dpp v13, v16, v37 row_newbcast:1 row_mask:0xf bank_mask:0xf
    v_dot2c_f32_bf16_dpp v14, v16, v38 row_newbcast:1 row_mask:0xf bank_mask:0xf
    v_dot2c_f32_bf16_dpp v15, v16, v39 row_newbcast:1 row_mask:0xf bank_mask:0xf
    s_waitcnt vmcnt(7)
    buffer_load_dwordx4 v[92:95], v1, s[40:43], s44 offen offset:2048 nt
    s_add_u32 s44, s44, 12288
    v_perm_b32 v40, v156, v152, s46
    v_perm_b32 v41, v156, v152, s47
    v_perm_b32 v42, v157, v153, s46
    v_perm_b32 v43, v157, v153, s47
    v_perm_b32 v44, v158, v154, s46
    v_perm_b32 v45, v158, v154, s47
    v_perm_b32 v46, v159, v155, s46
    v_perm_b32 v47, v159, v155, s47
    v_dot2c_f32_bf16_dpp v8, v16, v40 row_newbcast:9 row_mask:0xf bank_mask:0xf
    v_dot2c_f32_bf16_dpp v9, v16, v41 row_newbcast:9 row_mask:0xf bank_mask:0xf
    s_waitcnt vmcnt(7)
    buffer_load_dwordx4 v[96:99], v1, s[40:43], s44 offen offset:0 nt
    v_dot2c_f32_bf16_dpp v10, v16, v42 row_newbcast:9 row_mask:0xf bank_mask:0xf
    v_dot2c_f32_bf16_dpp v11, v16, v43 row_newbcast:9 row_mask:0xf bank_mask:0xf
    v_dot2c_f32_bf16_dpp v12, v16, v44 row_newbcast:9 row_mask:0xf bank_mask:0xf
    v_dot2c_f32_bf16_dpp v13, v16, v45 row_newbcast:9 row_mask:0xf bank_mask:0xf
    v_dot2c_f32_bf16_dpp v14, v16, v46 row_newbcast:9 row_mask:0xf bank_mask:0xf
    v_dot2c_f32_bf16_dpp v15, v16, v47 row_newbcast:9 row_mask:0xf bank_mask:0xf
    s_waitcnt vmcnt(7)
    buffer_load_dwordx4 v[100:103], v1, s[40:43], s44 offen offset:2048 nt
    s_add_u32 s44, s44, 4096
    v_perm_b32 v32, v164, v160, s46
    v_perm_b32 v33, v164, v160, s47
    v_perm_b32 v34, v165, v161, s46
    v_perm_b32 v35, v165, v161, s47
    v_perm_b32 v36, v166, v162, s46
    v_perm_b32 v37, v166, v162, s47
    v_perm_b32 v38, v167, v163, s46
    v_perm_b32 v39, v167, v163, s47
    v_dot2c_f32_bf16_dpp v8, v16, v32 row_newbcast:5 row_mask:0xf bank_mask:0xf
    v_dot2c_f32_bf16_dpp v9, v16, v33 row_newbcast:5 row_mask:0xf bank_mask:0xf
    v_dot2c_f32_bf16_dpp v10, v16, v34 row_newbcast:5 row_mask:0xf bank_mask:0xf
    s_waitcnt vmcnt(7)
    buffer_load_dwordx4 v[104:107], v1, s[40:43], s44 offen offset:0 nt
    v_dot2c_f32_bf16_dpp v11, v16, v35 row_newbcast:5 row_mask:0xf bank_mask:0xf
    v_dot2c_f32_bf16_dpp v12, v16, v36 row_newbcast:5 row_mask:0xf bank_mask:0xf
    v_dot2c_f32_bf16_dpp v13, v16, v37 row_newbcast:5 row_mask:0xf bank_mask:0xf
    v_dot2c_f32_bf16_dpp v14, v16, v38 row_newbcast:5 row_mask:0xf bank_mask:0xf
    v_dot2c_f32_bf16_dpp v15, v16, v39 row_newbcast:5 row_mask:0xf bank_mask:0xf
    s_waitcnt vmcnt(7)
    buffer_load_dwordx4 v[108:111], v1, s[40:43], s44 offen offset:2048 nt
    s_add_u32 s44, s44, 12288
    s_and_b32 s44, s44, 0xfffff
    v_perm_b32 v40, v172, v168, s46
    v_perm_b32 v41, v172, v168, s47
    v_perm_b32 v42, v173, v169, s46
    v_perm_b32 v43, v173, v169, s47
    v_perm_b32 v44, v174, v170, s46
    v_perm_b32 v45, v174, v170, s47
    v_perm_b32 v46, v175, v171, s46
    v_perm_b32 v47, v175, v171, s47
    v_dot2c_f32_bf16_dpp v8, v16, v40 row_newbcast:13 row_mask:0xf bank_mask:0xf
    v_dot2c_f32_bf16_dpp v9, v16, v41 row_newbcast:13 row_mask:0xf bank_mask:0xf
    v_dot2c_f32_bf16_dpp v10, v16, v42 row_newbcast:13 row_mask:0xf bank_mask:0xf
    v_dot2c_f32_bf16_dpp v11, v16, v43 row_newbcast:13 row_mask:0xf bank_mask:0xf
    v_dot2c_f32_bf16_dpp v12, v16, v44 row_newbcast:13 row_mask:0xf bank_mask:0xf
    v_dot2c_f32_bf16_dpp v13, v16, v45 row_newbcast:13 row_mask:0xf bank_mask:0xf
    v_dot2c_f32_bf16_dpp v14, v16, v46 row_newbcast:13 row_mask:0xf bank_mask:0xf
    v_dot2c_f32_bf16_dpp v15, v16, v47 row_newbcast:13 row_mask:0xf bank_mask:0xf
    s_waitcnt vmcnt(7)
    buffer_load_dwordx4 v[208:211], v1, s[40:43], s44 offen offset:0 nt
    s_cmp_lg_u32 s3, 0
    s_cbranch_scc1 L_tk1
    s_mov_b32 s57, 0x1000000
L_tk0:
    s_sub_u32 s57, s57, 1
    s_cbranch_scc1 L_tk3
    ds_read_b32 v3, v2 offset:6208
    s_waitcnt lgkmcnt(0)
    v_readfirstlane_b32 s50, v3
    s_cmp_lt_u32 s50, 4
    s_cbranch_scc1 L_tk0
L_tk3:
    s_mov_b32 s50, 1
    s_atomic_add s50, s[52:53], 0 glc
L_tk1:
    s_waitcnt vmcnt(7)
    buffer_load_dwordx4 v[212:215], v1, s[40:43], s44 offen offset:2048 nt
    s_add_u32 s44, s44, 4096
    v_perm_b32 v32, v84, v80, s46
    v_perm_b32 v33, v84, v80, s47
    v_perm_b32 v34, v85, v81, s46
    v_perm_b32 v35, v85, v81, s47
    v_perm_b32 v36, v86, v82, s46
    v_perm_b32 v37, v86, v82, s47
    v_perm_b32 v38, v87, v83, s46
    v_perm_b32 v39, v87, v83, s47
    v_dot2c_f32_bf16_dpp v8, v16, v32 row_newbcast:2 row_mask:0xf bank_mask:0xf
    s_waitcnt vmcnt(7)
    buffer_load_dwordx4 v[216:219], v1, s[40:43], s44 offen offset:0 nt
    v_dot2c_f32_bf16_dpp v9, v16, v33 row_newbcast:2 row_mask:0xf bank_mask:0xf
    v_dot2c_f32_bf16_dpp v10, v16, v34 row_newbcast:2 row_mask:0xf bank_mask:0xf
    v_dot2c_f32_bf16_dpp v11, v16, v35 row_newbcast:2 row_mask:0xf bank_mask:0xf
    v_dot2c_f32_bf16_dpp v12, v16, v36 row_newbcast:2 row_mask:0xf bank_mask:0xf
    v_dot2c_f32_bf16_dpp v13, v16, v37 row_newbcast:2 row_mask:0xf bank_mask:0xf
    v_dot2c_f32_bf16_dpp v14, v16, v38 row_newbcast:2 row_mask:0xf bank_mask:0xf
    v_dot2c_f32_bf16_dpp v15, v16, v39 row_newbcast:2 row_mask:0xf bank_mask:0xf
    s_waitcnt vmcnt(7)
    buffer_load_dwordx4 v[220:223], v1, s[40:43], s44 offen offset:2048 nt
    s_add_u32 s44, s44, 12288
    v_perm_b32 v40, v92, v88, s46
    v_perm_b32 v41, v92, v88, s47
    v_perm_b32 v42, v93, v89, s46
    v_perm_b32 v43, v93, v89, s47
    v_perm_b32 v44, v94, v90, s46
    v_perm_b32 v45, v94, v90, s47
    v_perm_b32 v46, v95, v91, s46
    v_perm_b32 v47, v95, v91, s47
    v_dot2c_f32_bf16_dpp v8, v16, v40 row_newbcast:10 row_mask:0xf bank_mask:0xf
    v_dot2c_f32_bf16_dpp v9, v16, v41 row_newbcast:10 row_mask:0xf bank_mask:0xf
    s_waitcnt vmcnt(7)
    buffer_load_dwordx4 v[224:227], v1, s[40:43], s44 offen offset:0 nt
    v_dot2c_f32_bf16_dpp v10, v16, v42 row_newbcast:10 row_mask:0xf bank_mask:0xf
    v_dot2c_f32_bf16_dpp v11, v16, v43 row_newbcast:10 row_mask:0xf bank_mask:0xf
    v_dot2c_f32_bf16_dpp v12, v16, v44 row_newbcast:10 row_mask:0xf bank_mask:0xf
    v_dot2c_f32_bf16_dpp v13, v16, v45 row_newbcast:10 row_mask:0xf bank_mask:0xf
    v_dot2c_f32_bf16_dpp v14, v16, v46 row_newbcast:10 row_mask:0xf bank_mask:0xf
    v_dot2c_f32_bf16_dpp v15, v16, v47 row_newbcast:10 row_mask:0xf bank_mask:0xf
    s_waitcnt vmcnt(7)
    buffer_load_dwordx4 v[228:231], v1, s[40:43], s44 offen offset:2048 nt
    s_add_u32 s44, s44, 4096
    v_perm_b32 v32, v100, v96, s46
    v_perm_b32 v33, v100, v96, s47
    v_perm_b32 v34, v101, v97, s46
    v_perm_b32 v35, v101, v97, s47
    v_perm_b32 v36, v102, v98, s46
    v_perm_b32 v37, v102, v98, s47
    v_perm_b32 v38, v103, v99, s46
    v_perm_b32 v39, v103, v99, s47
    v_dot2c_f32_bf16_dpp v8, v16, v32 row_newbcast:6 row_mask:0xf bank_mask:0xf
    v_dot2c_f32_bf16_dpp v9, v16, v33 row_newbcast:6 row_mask:0xf bank_mask:0xf
    v_dot2c_f32_bf16_dpp v10, v16, v34 row_newbcast:6 row_mask:0xf bank_mask:0xf
    s_waitcnt vmcnt(7)
    buffer_load_dwordx4 v[232:235], v1, s[40:43], s44 offen offset:0 nt
    v_dot2c_f32_bf16_dpp v11, v16, v35 row_newbcast:6 row_mask:0xf bank_mask:0xf
    v_dot2c_f32_bf16_dpp v12, v16, v36 row_newbcast:6 row_mask:0xf bank_mask:0xf
    v_dot2c_f32_bf16_dpp v13, v16, v37 row_newbcast:6 row_mask:0xf bank_mask:0xf
    v_dot2c_f32_bf16_dpp v14, v16, v38 row_newbcast:6 row_mask:0xf bank_mask:0xf
    v_dot2c_f32_bf16_dpp v15, v16, v39 row_newbcast:6 row_mask:0xf bank_mask:0xf
    s_waitcnt vmcnt(7)
    buffer_load_dwordx4 v[236:239], v1, s[40:43], s44 offen offset:2048 nt
    s_add_u32 s44, s44, 12288
    s_and_b32 s44, s44, 0xfffff
    v_perm_b32 v40, v108, v104, s46
    v_perm_b32 v41, v108, v104, s47
    v_perm_b32 v42, v109, v105, s46
    v_perm_b32 v43, v109, v105, s47
    v_perm_b32 v44, v110, v106, s46
    v_perm_b32 v45, v110, v106, s47
    v_perm_b32 v46, v111, v107, s46
    v_perm_b32 v47, v111, v107, s47
    v_dot2c_f32_bf16_dpp v8, v16, v40 row_newbcast:14 row_mask:0xf bank_mask:0xf
    v_dot2c_f32_bf16_dpp v9, v16, v41 row_newbcast:14 row_mask:0xf bank_mask:0xf
    v_dot2c_f32_bf16_dpp v10, v16, v42 row_newbcast:14 row_mask:0xf bank_mask:0xf
    v_dot2c_f32_bf16_dpp v11, v16, v43 row_newbcast:14 row_mask:0xf bank_mask:0xf
    v_dot2c_f32_bf16_dpp v12, v16, v44 row_newbcast:14 row_mask:0xf bank_mask:0xf
    v_dot2c_f32_bf16_dpp v13, v16, v45 row_newbcast:14 row_mask:0xf bank_mask:0xf
    v_dot2c_f32_bf16_dpp v14, v16, v46 row_newbcast:14 row_mask:0xf bank_mask:0xf
    v_dot2c_f32_bf16_dpp v15, v16, v47 row_newbcast:14 row_mask:0xf bank_mask:0xf
    s_waitcnt vmcnt(6)
    v_perm_b32 v32, v212, v208, s46
    v_perm_b32 v33, v212, v208, s47
    v_perm_b32 v34, v213, v209, s46
    v_perm_b32 v35, v213, v209, s47
    v_perm_b32 v36, v214, v210, s46
    v_perm_b32 v37, v214, v210, s47
    v_perm_b32 v38, v215, v211, s46
    v_perm_b32 v39, v215, v211, s47
    v_dot2c_f32_bf16_dpp v8, v16, v32 row_newbcast:3 row_mask:0xf bank_mask:0xf
    v_dot2c_f32_bf16_dpp v9, v16, v33 row_newbcast:3 row_mask:0xf bank_mask:0xf
    v_dot2c_f32_bf16_dpp v10, v16, v34 row_newbcast:3 row_mask:0xf bank_mask:0xf
    v_dot2c_f32_bf16_dpp v11, v16, v35 row_newbcast:3 row_mask:0xf bank_mask:0xf
    v_dot2c_f32_bf16_dpp v12, v16, v36 row_newbcast:3 row_mask:0xf bank_mask:0xf
    v_dot2c_f32_bf16_dpp v13, v16, v37 row_newbcast:3 row_mask:0xf bank_mask:0xf
    v_dot2c_f32_bf16_dpp v14, v16, v38 row_newbcast:3 row_mask:0xf bank_mask:0xf
    v_dot2c_f32_bf16_dpp v15, v16, v39 row_newbcast:3 row_mask:0xf bank_mask:0xf
    s_waitcnt vmcnt(4)
    v_perm_b32 v40, v220, v216, s46
    v_perm_b32 v41, v220, v216, s47
    v_perm_b32 v42, v221, v217, s46
    v_perm_b32 v43, v221, v217, s47
    v_perm_b32 v44, v222, v218, s46
    v_perm_b32 v45, v222, v218, s47
    v_perm_b32 v46, v223, v219, s46
    v_perm_b32 v47, v223, v219, s47
    v_dot2c_f32_bf16_dpp v8, v16, v40 row_newbcast:11 row_mask:0xf bank_mask:0xf
    v_dot2c_f32_bf16_dpp v9, v16, v41 row_newbcast:11 row_mask:0xf bank_mask:0xf
    v_dot2c_f32_bf16_dpp v10, v16, v42 row_newbcast:11 row_mask:0xf bank_mask:0xf
    v_dot2c_f32_bf16_dpp v11, v16, v43 row_newbcast:11 row_mask:0xf bank_mask:0xf
    v_dot2c_f32_bf16_dpp v12, v16, v44 row_newbcast:11 row_mask:0xf bank_mask:0xf
    v_dot2c_f32_bf16_dpp v13, v16, v45 row_newbcast:11 row_mask:0xf bank_mask:0xf
    v_dot2c_f32_bf16_dpp v14, v16, v46 row_newbcast:11 row_mask:0xf bank_mask:0xf
    v_dot2c_f32_bf16_dpp v15, v16, v47 row_newbcast:11 row_mask:0xf bank_mask:0xf
    s_cmp_lg_u32 s3, 0
    s_cbranch_scc1 L_tk2
    s_waitcnt lgkmcnt(0)
    v_mov_b32 v3, s50
    ds_write_b32 v2, v3 offset:6176
L_tk2:
    s_waitcnt lgkmcnt(0)
    s_barrier
    ds_read_b128 v[240:243], v2 offset:6144
    ds_read_b128 v[244:247], v2 offset:6160
    s_lshl_b32 s35, s3, 9
    v_lshl_add_u32 v3, v0, 3, s35
    s_waitcnt lgkmcnt(1)
    v_max3_f32 v248, v240, v241, v242
    v_max_f32 v248, v248, v243
    v_mul_f32 v248, s48, v248
    v_fma_f32 v240, v240, s48, -v248
    v_fma_f32 v241, v241, s48, -v248
    v_fma_f32 v242, v242, s48, -v248
    v_fma_f32 v243, v243, s48, -v248
    v_fma_f32 v28, v30, s48, -v248
    v_exp_f32 v240, v240
    v_exp_f32 v241, v241
    v_exp_f32 v242, v242
    v_exp_f32 v243, v243
    v_exp_f32 v28, v28
    s_waitcnt lgkmcnt(0)
    v_mul_f32 v31, v240, v244
    v_fmac_f32 v31, v241, v245
    v_fmac_f32 v31, v242, v246
    v_fmac_f32 v31, v243, v247
    v_rcp_f32 v31, v31
    s_nop 0
    v_mul_f32 v28, v28, v31
    s_waitcnt vmcnt(2)
    v_perm_b32 v32, v228, v224, s46
    v_perm_b32 v33, v228, v224, s47
    v_perm_b32 v34, v229, v225, s46
    v_perm_b32 v35, v229, v225, s47
    v_perm_b32 v36, v230, v226, s46
    v_perm_b32 v37, v230, v226, s47
    v_perm_b32 v38, v231, v227, s46
    v_perm_b32 v39, v231, v227, s47
    v_dot2c_f32_bf16_dpp v8, v16, v32 row_newbcast:7 row_mask:0xf bank_mask:0xf
    v_dot2c_f32_bf16_dpp v9, v16, v33 row_newbcast:7 row_mask:0xf bank_mask:0xf
    v_dot2c_f32_bf16_dpp v10, v16, v34 row_newbcast:7 row_mask:0xf bank_mask:0xf
    v_dot2c_f32_bf16_dpp v11, v16, v35 row_newbcast:7 row_mask:0xf bank_mask:0xf
    v_dot2c_f32_bf16_dpp v12, v16, v36 row_newbcast:7 row_mask:0xf bank_mask:0xf
    v_dot2c_f32_bf16_dpp v13, v16, v37 row_newbcast:7 row_mask:0xf bank_mask:0xf
    v_dot2c_f32_bf16_dpp v14, v16, v38 row_newbcast:7 row_mask:0xf bank_mask:0xf
    v_dot2c_f32_bf16_dpp v15, v16, v39 row_newbcast:7 row_mask:0xf bank_mask:0xf
    s_waitcnt vmcnt(0)
    v_perm_b32 v40, v236, v232, s46
    v_perm_b32 v41, v236, v232, s47
    v_perm_b32 v42, v237, v233, s46
    v_perm_b32 v43, v237, v233, s47
    v_perm_b32 v44, v238, v234, s46
    v_perm_b32 v45, v238, v234, s47
    v_perm_b32 v46, v239, v235, s46
    v_perm_b32 v47, v239, v235, s47
    v_dot2c_f32_bf16_dpp v8, v16, v40 row_newbcast:15 row_mask:0xf bank_mask:0xf
    v_dot2c_f32_bf16_dpp v9, v16, v41 row_newbcast:15 row_mask:0xf bank_mask:0xf
    v_dot2c_f32_bf16_dpp v10, v16, v42 row_newbcast:15 row_mask:0xf bank_mask:0xf
    v_dot2c_f32_bf16_dpp v11, v16, v43 row_newbcast:15 row_mask:0xf bank_mask:0xf
    v_dot2c_f32_bf16_dpp v12, v16, v44 row_newbcast:15 row_mask:0xf bank_mask:0xf
    v_dot2c_f32_bf16_dpp v13, v16, v45 row_newbcast:15 row_mask:0xf bank_mask:0xf
    v_dot2c_f32_bf16_dpp v14, v16, v46 row_newbcast:15 row_mask:0xf bank_mask:0xf
    v_dot2c_f32_bf16_dpp v15, v16, v47 row_newbcast:15 row_mask:0xf bank_mask:0xf
    v_permlane32_swap_b32 v8, v12
    v_permlane32_swap_b32 v9, v13
    v_permlane32_swap_b32 v10, v14
    v_permlane32_swap_b32 v11, v15
    v_pk_add_f32 v[8:9], v[8:9], v[12:13]
    v_pk_add_f32 v[10:11], v[10:11], v[14:15]
    s_nop 1
    v_permlane16_swap_b32 v8, v10
    v_permlane16_swap_b32 v9, v11
    v_pk_add_f32 v[8:9], v[8:9], v[10:11]
    v_pk_mul_f32 v[8:9], v[8:9], v[28:29] op_sel_hi:[1,0]
    ds_write_b64 v3, v[8:9] offset:4096
    s_waitcnt lgkmcnt(0)
    s_barrier
    s_endpgm
L_helper:
    s_mov_b32 s60, s22
    s_mov_b32 s61, s23
    s_mov_b32 s62, 0x1c0000
    s_mov_b32 s63, 0x20000
    s_mov_b32 s64, s12
    s_mov_b32 s65, s13
    s_mov_b32 s66, 0x400000
    s_mov_b32 s67, 0x20000
    s_mov_b32 s68, s16
    s_mov_b32 s69, s17
    s_mov_b32 s70, 1024
    s_mov_b32 s71, 0x20000
    s_mov_b32 s72, s24
    s_mov_b32 s73, s25
    s_mov_b32 s74, 1024
    s_mov_b32 s75, 0x20000
    s_mul_i32 s35, s32, 0x10100
    s_add_u32 s76, s30, s35
    s_addc_u32 s77, s31, 0
    s_mov_b32 s78, 0x10100
    s_mov_b32 s79, 0x20000
    s_lshl_b32 s35, s32, 10
    s_add_u32 s80, s26, s35
    s_addc_u32 s81, s27, 0
    s_mov_b32 s82, 1024
    s_mov_b32 s83, 0x20000
    s_mov_b32 s84, s28
    s_mov_b32 s85, s29
    s_mov_b32 s86, 256
    s_mov_b32 s87, 0x20000
    s_lshl_b32 s35, s3, 8
    s_lshl_b32 s50, s33, 16
    s_add_u32 s50, s50, s35
    s_lshl_b32 s51, s33, 17
    s_add_u32 s51, s51, s35
    v_lshlrev_b32 v7, 11, v3
    v_lshl_add_u32 v7, v2, 4, v7
    s_lshl_b32 s49, s33, 11
    s_lshl_b32 s35, s3, 9
    s_add_u32 s49, s49, s35
    v_mov_b32 v28, 0x10000
    v_lshlrev_b32 v29, 4, v0
    s_cmp_lg_u32 s3, 0
    s_cbranch_scc1 L_noep
    s_mov_b64 exec, 1
    buffer_load_dword v27, v28, s[76:79], 0 offen sc1
    s_mov_b64 exec, -1
L_noep:
    s_mov_b32 exec_hi, 0
    buffer_load_dwordx4 v[120:123], v29, s[76:79], s49 offen sc1
    s_mov_b64 exec, -1
    v_mov_b32 v8, 0
    v_mov_b32 v9, 0
    v_mov_b32 v10, 0
    v_mov_b32 v11, 0
    v_mov_b32 v12, 0
    v_mov_b32 v13, 0
    v_mov_b32 v14, 0
    v_mov_b32 v15, 0
    v_mov_b32 v25, 6208
    ds_write_b32 v25, v8
    v_lshlrev_b32 v4, 5, v2
    v_lshl_add_u32 v4, v3, 3, v4
    s_lshl_b32 s35, s3, 9
    v_add_u32 v1, s35, v4
    s_waitcnt vmcnt(2)
    buffer_load_dwordx4 v[68:71], v6, s[40:43], s44 offen offset:0 nt
    s_add_u32 s44, s44, 262144
    v_perm_b32 v40, v60, v56, s46
    v_perm_b32 v41, v60, v56, s47
    v_perm_b32 v42, v61, v57, s46
    v_perm_b32 v43, v61, v57, s47
    v_perm_b32 v44, v62, v58, s46
    v_perm_b32 v45, v62, v58, s47
    v_perm_b32 v46, v63, v59, s46
    v_perm_b32 v47, v63, v59, s47
    v_dot2c_f32_bf16_dpp v8, v16, v40 row_newbcast:0 row_mask:0xf bank_mask:0xf
    v_dot2c_f32_bf16_dpp v9, v16, v41 row_newbcast:0 row_mask:0xf bank_mask:0xf
    v_dot2c_f32_bf16_dpp v10, v16, v42 row_newbcast:0 row_mask:0xf bank_mask:0xf
    v_dot2c_f32_bf16_dpp v11, v16, v43 row_newbcast:0 row_mask:0xf bank_mask:0xf
    v_dot2c_f32_bf16_dpp v12, v16, v44 row_newbcast:0 row_mask:0xf bank_mask:0xf
    v_dot2c_f32_bf16_dpp v13, v16, v45 row_newbcast:0 row_mask:0xf bank_mask:0xf
    v_dot2c_f32_bf16_dpp v14, v16, v46 row_newbcast:0 row_mask:0xf bank_mask:0xf
    v_dot2c_f32_bf16_dpp v15, v16, v47 row_newbcast:0 row_mask:0xf bank_mask:0xf
    s_waitcnt vmcnt(1)
    buffer_load_dwordx4 v[72:75], v5, s[40:43], s44 offen offset:0 nt
    buffer_load_dwordx4 v[76:79], v6, s[40:43], s44 offen offset:0 nt
    s_add_u32 s44, s44, 262144
    s_waitcnt vmcnt(1)
    buffer_load_dwordx4 v[80:83], v5, s[40:43], s44 offen offset:0 nt
    v_perm_b32 v48, v68, v64, s46
    v_perm_b32 v49, v68, v64, s47
    v_perm_b32 v50, v69, v65, s46
    v_perm_b32 v51, v69, v65, s47
    v_perm_b32 v52, v70, v66, s46
    v_perm_b32 v53, v70, v66, s47
    v_perm_b32 v54, v71, v67, s46
    v_perm_b32 v55, v71, v67, s47
    v_dot2c_f32_bf16_dpp v8, v16, v48 row_newbcast:1 row_mask:0xf bank_mask:0xf
    v_dot2c_f32_bf16_dpp v9, v16, v49 row_newbcast:1 row_mask:0xf bank_mask:0xf
    v_dot2c_f32_bf16_dpp v10, v16, v50 row_newbcast:1 row_mask:0xf bank_mask:0xf
    v_dot2c_f32_bf16_dpp v11, v16, v51 row_newbcast:1 row_mask:0xf bank_mask:0xf
    v_dot2c_f32_bf16_dpp v12, v16, v52 row_newbcast:1 row_mask:0xf bank_mask:0xf
    v_dot2c_f32_bf16_dpp v13, v16, v53 row_newbcast:1 row_mask:0xf bank_mask:0xf
    v_dot2c_f32_bf16_dpp v14, v16, v54 row_newbcast:1 row_mask:0xf bank_mask:0xf
    v_dot2c_f32_bf16_dpp v15, v16, v55 row_newbcast:1 row_mask:0xf bank_mask:0xf
    buffer_load_dwordx4 v[84:87], v6, s[40:43], s44 offen offset:0 nt
    s_add_u32 s44, s44, 262144
    s_waitcnt vmcnt(1)
    buffer_load_dwordx4 v[88:91], v5, s[40:43], s44 offen offset:0 nt
    v_perm_b32 v40, v76, v72, s46
    v_perm_b32 v41, v76, v72, s47
    v_perm_b32 v42, v77, v73, s46
    v_perm_b32 v43, v77, v73, s47
    v_perm_b32 v44, v78, v74, s46
    v_perm_b32 v45, v78, v74, s47
    v_perm_b32 v46, v79, v75, s46
    v_perm_b32 v47, v79, v75, s47
    v_dot2c_f32_bf16_dpp v8, v16, v40 row_newbcast:2 row_mask:0xf bank_mask:0xf
    v_dot2c_f32_bf16_dpp v9, v16, v41 row_newbcast:2 row_mask:0xf bank_mask:0xf
    v_dot2c_f32_bf16_dpp v10, v16, v42 row_newbcast:2 row_mask:0xf bank_mask:0xf
    v_dot2c_f32_bf16_dpp v11, v16, v43 row_newbcast:2 row_mask:0xf bank_mask:0xf
    v_dot2c_f32_bf16_dpp v12, v16, v44 row_newbcast:2 row_mask:0xf bank_mask:0xf
    v_dot2c_f32_bf16_dpp v13, v16, v45 row_newbcast:2 row_mask:0xf bank_mask:0xf
    v_dot2c_f32_bf16_dpp v14, v16, v46 row_newbcast:2 row_mask:0xf bank_mask:0xf
    v_dot2c_f32_bf16_dpp v15, v16, v47 row_newbcast:2 row_mask:0xf bank_mask:0xf
    buffer_load_dwordx4 v[92:95], v6, s[40:43], s44 offen offset:0 nt
    s_add_u32 s44, s44, 262144
    s_waitcnt vmcnt(1)
    buffer_load_dwordx4 v[96:99], v5, s[40:43], s44 offen offset:0 nt
    v_perm_b32 v48, v84, v80, s46
    v_perm_b32 v49, v84, v80, s47
    v_perm_b32 v50, v85, v81, s46
    v_perm_b32 v51, v85, v81, s47
    v_perm_b32 v52, v86, v82, s46
    v_perm_b32 v53, v86, v82, s47
    v_perm_b32 v54, v87, v83, s46
    v_perm_b32 v55, v87, v83, s47
    v_dot2c_f32_bf16_dpp v8, v16, v48 row_newbcast:3 row_mask:0xf bank_mask:0xf
    v_dot2c_f32_bf16_dpp v9, v16, v49 row_newbcast:3 row_mask:0xf bank_mask:0xf
    v_dot2c_f32_bf16_dpp v10, v16, v50 row_newbcast:3 row_mask:0xf bank_mask:0xf
    v_dot2c_f32_bf16_dpp v11, v16, v51 row_newbcast:3 row_mask:0xf bank_mask:0xf
    v_dot2c_f32_bf16_dpp v12, v16, v52 row_newbcast:3 row_mask:0xf bank_mask:0xf
    v_dot2c_f32_bf16_dpp v13, v16, v53 row_newbcast:3 row_mask:0xf bank_mask:0xf
    v_dot2c_f32_bf16_dpp v14, v16, v54 row_newbcast:3 row_mask:0xf bank_mask:0xf
    v_dot2c_f32_bf16_dpp v15, v16, v55 row_newbcast:3 row_mask:0xf bank_mask:0xf
    buffer_load_dwordx4 v[100:103], v6, s[40:43], s44 offen offset:0 nt
    s_add_u32 s44, s44, 262144
    s_waitcnt vmcnt(1)
    buffer_load_dwordx4 v[104:107], v5, s[40:43], s44 offen offset:0 nt
    v_perm_b32 v40, v92, v88, s46
    v_perm_b32 v41, v92, v88, s47
    v_perm_b32 v42, v93, v89, s46
    v_perm_b32 v43, v93, v89, s47
    v_perm_b32 v44, v94, v90, s46
    v_perm_b32 v45, v94, v90, s47
    v_perm_b32 v46, v95, v91, s46
    v_perm_b32 v47, v95, v91, s47
    v_dot2c_f32_bf16_dpp v8, v16, v40 row_newbcast:4 row_mask:0xf bank_mask:0xf
    v_dot2c_f32_bf16_dpp v9, v16, v41 row_newbcast:4 row_mask:0xf bank_mask:0xf
    v_dot2c_f32_bf16_dpp v10, v16, v42 row_newbcast:4 row_mask:0xf bank_mask:0xf
    v_dot2c_f32_bf16_dpp v11, v16, v43 row_newbcast:4 row_mask:0xf bank_mask:0xf
    v_dot2c_f32_bf16_dpp v12, v16, v44 row_newbcast:4 row_mask:0xf bank_mask:0xf
    v_dot2c_f32_bf16_dpp v13, v16, v45 row_newbcast:4 row_mask:0xf bank_mask:0xf
    v_dot2c_f32_bf16_dpp v14, v16, v46 row_newbcast:4 row_mask:0xf bank_mask:0xf
    v_dot2c_f32_bf16_dpp v15, v16, v47 row_newbcast:4 row_mask:0xf bank_mask:0xf
    buffer_load_dwordx4 v[108:111], v6, s[40:43], s44 offen offset:0 nt
    s_add_u32 s44, s44, 262144
    s_waitcnt vmcnt(1)
    buffer_load_dwordx4 v[112:115], v5, s[40:43], s44 offen offset:0 nt
    v_perm_b32 v48, v100, v96, s46
    v_perm_b32 v49, v100, v96, s47
    v_perm_b32 v50, v101, v97, s46
    v_perm_b32 v51, v101, v97, s47
    v_perm_b32 v52, v102, v98, s46
    v_perm_b32 v53, v102, v98, s47
    v_perm_b32 v54, v103, v99, s46
    v_perm_b32 v55, v103, v99, s47
    v_dot2c_f32_bf16_dpp v8, v16, v48 row_newbcast:5 row_mask:0xf bank_mask:0xf
    v_dot2c_f32_bf16_dpp v9, v16, v49 row_newbcast:5 row_mask:0xf bank_mask:0xf
    v_dot2c_f32_bf16_dpp v10, v16, v50 row_newbcast:5 row_mask:0xf bank_mask:0xf
    v_dot2c_f32_bf16_dpp v11, v16, v51 row_newbcast:5 row_mask:0xf bank_mask:0xf
    v_dot2c_f32_bf16_dpp v12, v16, v52 row_newbcast:5 row_mask:0xf bank_mask:0xf
    v_dot2c_f32_bf16_dpp v13, v16, v53 row_newbcast:5 row_mask:0xf bank_mask:0xf
    v_dot2c_f32_bf16_dpp v14, v16, v54 row_newbcast:5 row_mask:0xf bank_mask:0xf
    v_dot2c_f32_bf16_dpp v15, v16, v55 row_newbcast:5 row_mask:0xf bank_mask:0xf
    buffer_load_dwordx4 v[116:119], v6, s[40:43], s44 offen offset:0 nt
    s_add_u32 s44, s44, 262144
    s_waitcnt vmcnt(1)
    buffer_load_dwordx4 v[56:59], v5, s[40:43], s44 offen offset:0 nt
    v_perm_b32 v40, v108, v104, s46
    v_perm_b32 v41, v108, v104, s47
    v_perm_b32 v42, v109, v105, s46
    v_perm_b32 v43, v109, v105, s47
    v_perm_b32 v44, v110, v106, s46
    v_perm_b32 v45, v110, v106, s47
    v_perm_b32 v46, v111, v107, s46
    v_perm_b32 v47, v111, v107, s47
    v_dot2c_f32_bf16_dpp v8, v16, v40 row_newbcast:6 row_mask:0xf bank_mask:0xf
    v_dot2c_f32_bf16_dpp v9, v16, v41 row_newbcast:6 row_mask:0xf bank_mask:0xf
    v_dot2c_f32_bf16_dpp v10, v16, v42 row_newbcast:6 row_mask:0xf bank_mask:0xf
    v_dot2c_f32_bf16_dpp v11, v16, v43 row_newbcast:6 row_mask:0xf bank_mask:0xf
    v_dot2c_f32_bf16_dpp v12, v16, v44 row_newbcast:6 row_mask:0xf bank_mask:0xf
    v_dot2c_f32_bf16_dpp v13, v16, v45 row_newbcast:6 row_mask:0xf bank_mask:0xf
    v_dot2c_f32_bf16_dpp v14, v16, v46 row_newbcast:6 row_mask:0xf bank_mask:0xf
    v_dot2c_f32_bf16_dpp v15, v16, v47 row_newbcast:6 row_mask:0xf bank_mask:0xf
    buffer_load_dwordx4 v[60:63], v6, s[40:43], s44 offen offset:0 nt
    s_add_u32 s44, s44, 262144
    s_waitcnt vmcnt(1)
    buffer_load_dwordx4 v[64:67], v5, s[40:43], s44 offen offset:0 nt
    v_perm_b32 v48, v116, v112, s46
    v_perm_b32 v49, v116, v112, s47
    v_perm_b32 v50, v117, v113, s46
    v_perm_b32 v51, v117, v113, s47
    v_perm_b32 v52, v118, v114, s46
    v_perm_b32 v53, v118, v114, s47
    v_perm_b32 v54, v119, v115, s46
    v_perm_b32 v55, v119, v115, s47
    v_dot2c_f32_bf16_dpp v8, v16, v48 row_newbcast:7 row_mask:0xf bank_mask:0xf
    v_dot2c_f32_bf16_dpp v9, v16, v49 row_newbcast:7 row_mask:0xf bank_mask:0xf
    v_dot2c_f32_bf16_dpp v10, v16, v50 row_newbcast:7 row_mask:0xf bank_mask:0xf
    v_dot2c_f32_bf16_dpp v11, v16, v51 row_newbcast:7 row_mask:0xf bank_mask:0xf
    v_dot2c_f32_bf16_dpp v12, v16, v52 row_newbcast:7 row_mask:0xf bank_mask:0xf
    v_dot2c_f32_bf16_dpp v13, v16, v53 row_newbcast:7 row_mask:0xf bank_mask:0xf
    v_dot2c_f32_bf16_dpp v14, v16, v54 row_newbcast:7 row_mask:0xf bank_mask:0xf
    v_dot2c_f32_bf16_dpp v15, v16, v55 row_newbcast:7 row_mask:0xf bank_mask:0xf
    buffer_load_dwordx4 v[68:71], v6, s[40:43], s44 offen offset:0 nt
    s_add_u32 s44, s44, 262144
    s_waitcnt vmcnt(1)
    buffer_load_dwordx4 v[72:75], v5, s[40:43], s44 offen offset:0 nt
    v_perm_b32 v40, v60, v56, s46
    v_perm_b32 v41, v60, v56, s47
    v_perm_b32 v42, v61, v57, s46
    v_perm_b32 v43, v61, v57, s47
    v_perm_b32 v44, v62, v58, s46
    v_perm_b32 v45, v62, v58, s47
    v_perm_b32 v46, v63, v59, s46
    v_perm_b32 v47, v63, v59, s47
    v_dot2c_f32_bf16_dpp v8, v16, v40 row_newbcast:8 row_mask:0xf bank_mask:0xf
    v_dot2c_f32_bf16_dpp v9, v16, v41 row_newbcast:8 row_mask:0xf bank_mask:0xf
    v_dot2c_f32_bf16_dpp v10, v16, v42 row_newbcast:8 row_mask:0xf bank_mask:0xf
    v_dot2c_f32_bf16_dpp v11, v16, v43 row_newbcast:8 row_mask:0xf bank_mask:0xf
    v_dot2c_f32_bf16_dpp v12, v16, v44 row_newbcast:8 row_mask:0xf bank_mask:0xf
    v_dot2c_f32_bf16_dpp v13, v16, v45 row_newbcast:8 row_mask:0xf bank_mask:0xf
    v_dot2c_f32_bf16_dpp v14, v16, v46 row_newbcast:8 row_mask:0xf bank_mask:0xf
    v_dot2c_f32_bf16_dpp v15, v16, v47 row_newbcast:8 row_mask:0xf bank_mask:0xf
    buffer_load_dwordx4 v[76:79], v6, s[40:43], s44 offen offset:0 nt
    s_add_u32 s44, s44, 262144
    s_waitcnt vmcnt(1)
    buffer_load_dwordx4 v[80:83], v5, s[40:43], s44 offen offset:0 nt
    v_perm_b32 v48, v68, v64, s46
    v_perm_b32 v49, v68, v64, s47
    v_perm_b32 v50, v69, v65, s46
    v_perm_b32 v51, v69, v65, s47
    v_perm_b32 v52, v70, v66, s46
    v_perm_b32 v53, v70, v66, s47
    v_perm_b32 v54, v71, v67, s46
    v_perm_b32 v55, v71, v67, s47
    v_dot2c_f32_bf16_dpp v8, v16, v48 row_newbcast:9 row_mask:0xf bank_mask:0xf
    v_dot2c_f32_bf16_dpp v9, v16, v49 row_newbcast:9 row_mask:0xf bank_mask:0xf
    v_dot2c_f32_bf16_dpp v10, v16, v50 row_newbcast:9 row_mask:0xf bank_mask:0xf
    v_dot2c_f32_bf16_dpp v11, v16, v51 row_newbcast:9 row_mask:0xf bank_mask:0xf
    v_dot2c_f32_bf16_dpp v12, v16, v52 row_newbcast:9 row_mask:0xf bank_mask:0xf
    v_dot2c_f32_bf16_dpp v13, v16, v53 row_newbcast:9 row_mask:0xf bank_mask:0xf
    v_dot2c_f32_bf16_dpp v14, v16, v54 row_newbcast:9 row_mask:0xf bank_mask:0xf
    v_dot2c_f32_bf16_dpp v15, v16, v55 row_newbcast:9 row_mask:0xf bank_mask:0xf
    buffer_load_dwordx4 v[84:87], v6, s[40:43], s44 offen offset:0 nt
    s_add_u32 s44, s44, 262144
    s_waitcnt vmcnt(1)
    buffer_load_dwordx4 v[88:91], v5, s[40:43], s44 offen offset:0 nt
    v_perm_b32 v40, v76, v72, s46
    v_perm_b32 v41, v76, v72, s47
    v_perm_b32 v42, v77, v73, s46
    v_perm_b32 v43, v77, v73, s47
    v_perm_b32 v44, v78, v74, s46
    v_perm_b32 v45, v78, v74, s47
    v_perm_b32 v46, v79, v75, s46
    v_perm_b32 v47, v79, v75, s47
    v_dot2c_f32_bf16_dpp v8, v16, v40 row_newbcast:10 row_mask:0xf bank_mask:0xf
    v_dot2c_f32_bf16_dpp v9, v16, v41 row_newbcast:10 row_mask:0xf bank_mask:0xf
    v_dot2c_f32_bf16_dpp v10, v16, v42 row_newbcast:10 row_mask:0xf bank_mask:0xf
    v_dot2c_f32_bf16_dpp v11, v16, v43 row_newbcast:10 row_mask:0xf bank_mask:0xf
    v_dot2c_f32_bf16_dpp v12, v16, v44 row_newbcast:10 row_mask:0xf bank_mask:0xf
    v_dot2c_f32_bf16_dpp v13, v16, v45 row_newbcast:10 row_mask:0xf bank_mask:0xf
    v_dot2c_f32_bf16_dpp v14, v16, v46 row_newbcast:10 row_mask:0xf bank_mask:0xf
    v_dot2c_f32_bf16_dpp v15, v16, v47 row_newbcast:10 row_mask:0xf bank_mask:0xf
    buffer_load_dwordx4 v[92:95], v6, s[40:43], s44 offen offset:0 nt
    s_add_u32 s44, s44, 262144
    s_waitcnt vmcnt(1)
    buffer_load_dwordx4 v[96:99], v5, s[40:43], s44 offen offset:0 nt
    v_perm_b32 v48, v84, v80, s46
    v_perm_b32 v49, v84, v80, s47
    v_perm_b32 v50, v85, v81, s46
    v_perm_b32 v51, v85, v81, s47
    v_perm_b32 v52, v86, v82, s46
    v_perm_b32 v53, v86, v82, s47
    v_perm_b32 v54, v87, v83, s46
    v_perm_b32 v55, v87, v83, s47
    v_dot2c_f32_bf16_dpp v8, v16, v48 row_newbcast:11 row_mask:0xf bank_mask:0xf
    v_dot2c_f32_bf16_dpp v9, v16, v49 row_newbcast:11 row_mask:0xf bank_mask:0xf
    v_dot2c_f32_bf16_dpp v10, v16, v50 row_newbcast:11 row_mask:0xf bank_mask:0xf
    v_dot2c_f32_bf16_dpp v11, v16, v51 row_newbcast:11 row_mask:0xf bank_mask:0xf
    v_dot2c_f32_bf16_dpp v12, v16, v52 row_newbcast:11 row_mask:0xf bank_mask:0xf
    v_dot2c_f32_bf16_dpp v13, v16, v53 row_newbcast:11 row_mask:0xf bank_mask:0xf
    v_dot2c_f32_bf16_dpp v14, v16, v54 row_newbcast:11 row_mask:0xf bank_mask:0xf
    v_dot2c_f32_bf16_dpp v15, v16, v55 row_newbcast:11 row_mask:0xf bank_mask:0xf
    buffer_load_dwordx4 v[100:103], v6, s[40:43], s44 offen offset:0 nt
    s_add_u32 s44, s44, 262144
    s_waitcnt vmcnt(1)
    buffer_load_dwordx4 v[104:107], v5, s[40:43], s44 offen offset:0 nt
    v_perm_b32 v40, v92, v88, s46
    v_perm_b32 v41, v92, v88, s47
    v_perm_b32 v42, v93, v89, s46
    v_perm_b32 v43, v93, v89, s47
    v_perm_b32 v44, v94, v90, s46
    v_perm_b32 v45, v94, v90, s47
    v_perm_b32 v46, v95, v91, s46
    v_perm_b32 v47, v95, v91, s47
    v_dot2c_f32_bf16_dpp v8, v16, v40 row_newbcast:12 row_mask:0xf bank_mask:0xf
    v_dot2c_f32_bf16_dpp v9, v16, v41 row_newbcast:12 row_mask:0xf bank_mask:0xf
    v_dot2c_f32_bf16_dpp v10, v16, v42 row_newbcast:12 row_mask:0xf bank_mask:0xf
    v_dot2c_f32_bf16_dpp v11, v16, v43 row_newbcast:12 row_mask:0xf bank_mask:0xf
    v_dot2c_f32_bf16_dpp v12, v16, v44 row_newbcast:12 row_mask:0xf bank_mask:0xf
    v_dot2c_f32_bf16_dpp v13, v16, v45 row_newbcast:12 row_mask:0xf bank_mask:0xf
    v_dot2c_f32_bf16_dpp v14, v16, v46 row_newbcast:12 row_mask:0xf bank_mask:0xf
    v_dot2c_f32_bf16_dpp v15, v16, v47 row_newbcast:12 row_mask:0xf bank_mask:0xf
    buffer_load_dwordx4 v[108:111], v6, s[40:43], s44 offen offset:0 nt
    s_add_u32 s44, s44, 262144
    s_waitcnt vmcnt(1)
    buffer_load_dwordx4 v[112:115], v5, s[40:43], s44 offen offset:0 nt
    v_perm_b32 v48, v100, v96, s46
    v_perm_b32 v49, v100, v96, s47
    v_perm_b32 v50, v101, v97, s46
    v_perm_b32 v51, v101, v97, s47
    v_perm_b32 v52, v102, v98, s46
    v_perm_b32 v53, v102, v98, s47
    v_perm_b32 v54, v103, v99, s46
    v_perm_b32 v55, v103, v99, s47
    v_dot2c_f32_bf16_dpp v8, v16, v48 row_newbcast:13 row_mask:0xf bank_mask:0xf
    v_dot2c_f32_bf16_dpp v9, v16, v49 row_newbcast:13 row_mask:0xf bank_mask:0xf
    v_dot2c_f32_bf16_dpp v10, v16, v50 row_newbcast:13 row_mask:0xf bank_mask:0xf
    v_dot2c_f32_bf16_dpp v11, v16, v51 row_newbcast:13 row_mask:0xf bank_mask:0xf
    v_dot2c_f32_bf16_dpp v12, v16, v52 row_newbcast:13 row_mask:0xf bank_mask:0xf
    v_dot2c_f32_bf16_dpp v13, v16, v53 row_newbcast:13 row_mask:0xf bank_mask:0xf
    v_dot2c_f32_bf16_dpp v14, v16, v54 row_newbcast:13 row_mask:0xf bank_mask:0xf
    v_dot2c_f32_bf16_dpp v15, v16, v55 row_newbcast:13 row_mask:0xf bank_mask:0xf
    buffer_load_dwordx4 v[116:119], v6, s[40:43], s44 offen offset:0 nt
    s_add_u32 s44, s44, 262144
    s_waitcnt vmcnt(1)
    buffer_load_dwordx4 v[56:59], v7, s[64:67], s51 offen offset:0 nt
    v_perm_b32 v40, v108, v104, s46
    v_perm_b32 v41, v108, v104, s47
    v_perm_b32 v42, v109, v105, s46
    v_perm_b32 v43, v109, v105, s47
    v_perm_b32 v44, v110, v106, s46
    v_perm_b32 v45, v110, v106, s47
    v_perm_b32 v46, v111, v107, s46
    v_perm_b32 v47, v111, v107, s47
    v_dot2c_f32_bf16_dpp v8, v16, v40 row_newbcast:14 row_mask:0xf bank_mask:0xf
    v_dot2c_f32_bf16_dpp v9, v16, v41 row_newbcast:14 row_mask:0xf bank_mask:0xf
    v_dot2c_f32_bf16_dpp v10, v16, v42 row_newbcast:14 row_mask:0xf bank_mask:0xf
    v_dot2c_f32_bf16_dpp v11, v16, v43 row_newbcast:14 row_mask:0xf bank_mask:0xf
    v_dot2c_f32_bf16_dpp v12, v16, v44 row_newbcast:14 row_mask:0xf bank_mask:0xf
    v_dot2c_f32_bf16_dpp v13, v16, v45 row_newbcast:14 row_mask:0xf bank_mask:0xf
    v_dot2c_f32_bf16_dpp v14, v16, v46 row_newbcast:14 row_mask:0xf bank_mask:0xf
    v_dot2c_f32_bf16_dpp v15, v16, v47 row_newbcast:14 row_mask:0xf bank_mask:0xf
    s_waitcnt vmcnt(1)
    buffer_load_dwordx4 v[60:63], v7, s[64:67], s51 offen offset:1024 nt
    s_add_u32 s51, s51, 8192
    v_perm_b32 v48, v116, v112, s46
    v_perm_b32 v49, v116, v112, s47
    v_perm_b32 v50, v117, v113, s46
    v_perm_b32 v51, v117, v113, s47
    v_perm_b32 v52, v118, v114, s46
    v_perm_b32 v53, v118, v114, s47
    v_perm_b32 v54, v119, v115, s46
    v_perm_b32 v55, v119, v115, s47
    v_dot2c_f32_bf16_dpp v8, v16, v48 row_newbcast:15 row_mask:0xf bank_mask:0xf
    v_dot2c_f32_bf16_dpp v9, v16, v49 row_newbcast:15 row_mask:0xf bank_mask:0xf
    v_dot2c_f32_bf16_dpp v10, v16, v50 row_newbcast:15 row_mask:0xf bank_mask:0xf
    v_dot2c_f32_bf16_dpp v11, v16, v51 row_newbcast:15 row_mask:0xf bank_mask:0xf
    v_dot2c_f32_bf16_dpp v12, v16, v52 row_newbcast:15 row_mask:0xf bank_mask:0xf
    v_dot2c_f32_bf16_dpp v13, v16, v53 row_newbcast:15 row_mask:0xf bank_mask:0xf
    v_dot2c_f32_bf16_dpp v14, v16, v54 row_newbcast:15 row_mask:0xf bank_mask:0xf
    v_dot2c_f32_bf16_dpp v15, v16, v55 row_newbcast:15 row_mask:0xf bank_mask:0xf
    v_permlane32_swap_b32 v8, v12
    v_permlane32_swap_b32 v9, v13
    v_permlane32_swap_b32 v10, v14
    v_permlane32_swap_b32 v11, v15
    v_pk_add_f32 v[8:9], v[8:9], v[12:13]
    v_pk_add_f32 v[10:11], v[10:11], v[14:15]
    s_nop 1
    v_permlane16_swap_b32 v8, v10
    v_permlane16_swap_b32 v9, v11
    v_pk_add_f32 v[8:9], v[8:9], v[10:11]
    ds_write_b64 v1, v[8:9] offset:0
    s_cmp_lg_u32 s3, 0
    s_cbranch_scc1 L_noep2
    s_mov_b64 exec, 1
    ds_write_b32 v25, v27 offset:4
    s_mov_b64 exec, -1
L_noep2:
    s_waitcnt lgkmcnt(0)
    s_barrier
    ds_read_b32 v27, v25 offset:4
    s_waitcnt lgkmcnt(0)
    v_add_u32 v27, 1, v27
    s_nop 0
    v_readfirstlane_b32 s53, v27
    v_and_b32 v27, 0xff, v27
    v_xor_b32 v28, v120, v27
    v_bitop3_b32 v28, v28, v121, v27 bitop3:0xf6
    v_bitop3_b32 v28, v28, v122, v27 bitop3:0xf6
    v_bitop3_b32 v28, v28, v123, v27 bitop3:0xf6
    v_and_b32 v28, 0xff, v28
    s_mov_b32 exec_hi, 0
    v_cmp_eq_u32 vcc, 0, v28
    s_cbranch_vccz L_nostale
    v_xor_b32 v120, 0xff, v27
    v_xor_b32 v121, 0xff, v27
    v_xor_b32 v122, 0xff, v27
    v_xor_b32 v123, 0xff, v27
    buffer_store_dwordx4 v[120:123], v29, s[76:79], s49 offen sc1
    s_waitcnt vmcnt(0)
L_nostale:
    s_mov_b64 exec, -1
    s_mov_b32 s52, 0xffffff00
    s_waitcnt vmcnt(1)
    buffer_load_dwordx4 v[64:67], v7, s[64:67], s51 offen offset:0 nt
    s_waitcnt vmcnt(1)
    buffer_load_dwordx4 v[68:71], v7, s[64:67], s51 offen offset:1024 nt
    s_add_u32 s51, s51, 8192
    v_perm_b32 v120, v60, v56, s46
    v_perm_b32 v121, v60, v56, s47
    v_perm_b32 v122, v61, v57, s46
    v_perm_b32 v123, v61, v57, s47
    v_perm_b32 v124, v62, v58, s46
    v_perm_b32 v125, v62, v58, s47
    v_perm_b32 v126, v63, v59, s46
    v_perm_b32 v127, v63, v59, s47
    s_waitcnt vmcnt(1)
    buffer_load_dwordx4 v[72:75], v7, s[64:67], s51 offen offset:0 nt
    s_waitcnt vmcnt(1)
    buffer_load_dwordx4 v[76:79], v7, s[64:67], s51 offen offset:1024 nt
    s_add_u32 s51, s51, 8192
    v_perm_b32 v128, v68, v64, s46
    v_perm_b32 v129, v68, v64, s47
    v_perm_b32 v130, v69, v65, s46
    v_perm_b32 v131, v69, v65, s47
    v_perm_b32 v132, v70, v66, s46
    v_perm_b32 v133, v70, v66, s47
    v_perm_b32 v134, v71, v67, s46
    v_perm_b32 v135, v71, v67, s47
    s_waitcnt vmcnt(1)
    buffer_load_dwordx4 v[80:83], v7, s[64:67], s51 offen offset:0 nt
    s_waitcnt vmcnt(1)
    buffer_load_dwordx4 v[84:87], v7, s[64:67], s51 offen offset:1024 nt
    s_add_u32 s51, s51, 8192
    v_perm_b32 v136, v76, v72, s46
    v_perm_b32 v137, v76, v72, s47
    v_perm_b32 v138, v77, v73, s46
    v_perm_b32 v139, v77, v73, s47
    v_perm_b32 v140, v78, v74, s46
    v_perm_b32 v141, v78, v74, s47
    v_perm_b32 v142, v79, v75, s46
    v_perm_b32 v143, v79, v75, s47
    s_waitcnt vmcnt(1)
    buffer_load_dwordx4 v[88:91], v7, s[64:67], s51 offen offset:0 nt
    s_waitcnt vmcnt(1)
    buffer_load_dwordx4 v[92:95], v7, s[64:67], s51 offen offset:1024 nt
    s_add_u32 s51, s51, 8192
    v_perm_b32 v144, v84, v80, s46
    v_perm_b32 v145, v84, v80, s47
    v_perm_b32 v146, v85, v81, s46
    v_perm_b32 v147, v85, v81, s47
    v_perm_b32 v148, v86, v82, s46
    v_perm_b32 v149, v86, v82, s47
    v_perm_b32 v150, v87, v83, s46
    v_perm_b32 v151, v87, v83, s47
    s_waitcnt vmcnt(1)
    buffer_load_dwordx4 v[96:99], v7, s[64:67], s51 offen offset:0 nt
    s_waitcnt vmcnt(1)
    buffer_load_dwordx4 v[100:103], v7, s[64:67], s51 offen offset:1024 nt
    s_add_u32 s51, s51, 8192
    v_perm_b32 v152, v92, v88, s46
    v_perm_b32 v153, v92, v88, s47
    v_perm_b32 v154, v93, v89, s46
    v_perm_b32 v155, v93, v89, s47
    v_perm_b32 v156, v94, v90, s46
    v_perm_b32 v157, v94, v90, s47
    v_perm_b32 v158, v95, v91, s46
    v_perm_b32 v159, v95, v91, s47
    s_waitcnt vmcnt(1)
    buffer_load_dwordx4 v[104:107], v7, s[64:67], s51 offen offset:0 nt
    s_waitcnt vmcnt(1)
    buffer_load_dwordx4 v[108:111], v7, s[64:67], s51 offen offset:1024 nt
    s_add_u32 s51, s51, 8192
    v_perm_b32 v160, v100, v96, s46
    v_perm_b32 v161, v100, v96, s47
    v_perm_b32 v162, v101, v97, s46
    v_perm_b32 v163, v101, v97, s47
    v_perm_b32 v164, v102, v98, s46
    v_perm_b32 v165, v102, v98, s47
    v_perm_b32 v166, v103, v99, s46
    v_perm_b32 v167, v103, v99, s47
    s_waitcnt vmcnt(1)
    buffer_load_dwordx4 v[112:115], v7, s[64:67], s51 offen offset:0 nt
    s_waitcnt vmcnt(1)
    buffer_load_dwordx4 v[116:119], v7, s[64:67], s51 offen offset:1024 nt
    s_add_u32 s51, s51, 8192
    v_perm_b32 v168, v108, v104, s46
    v_perm_b32 v169, v108, v104, s47
    v_perm_b32 v170, v109, v105, s46
    v_perm_b32 v171, v109, v105, s47
    v_perm_b32 v172, v110, v106, s46
    v_perm_b32 v173, v110, v106, s47
    v_perm_b32 v174, v111, v107, s46
    v_perm_b32 v175, v111, v107, s47
    s_waitcnt vmcnt(1)
    buffer_load_dwordx4 v[56:59], v7, s[64:67], s51 offen offset:0 nt
    s_waitcnt vmcnt(1)
    buffer_load_dwordx4 v[60:63], v7, s[64:67], s51 offen offset:1024 nt
    s_add_u32 s51, s51, 8192
    v_perm_b32 v176, v116, v112, s46
    v_perm_b32 v177, v116, v112, s47
    v_perm_b32 v178, v117, v113, s46
    v_perm_b32 v179, v117, v113, s47
    v_perm_b32 v180, v118, v114, s46
    v_perm_b32 v181, v118, v114, s47
    v_perm_b32 v182, v119, v115, s46
    v_perm_b32 v183, v119, v115, s47
    s_waitcnt vmcnt(1)
    buffer_load_dwordx4 v[64:67], v7, s[64:67], s51 offen offset:0 nt
    s_waitcnt vmcnt(1)
    buffer_load_dwordx4 v[68:71], v7, s[64:67], s51 offen offset:1024 nt
    s_add_u32 s51, s51, 8192
    v_perm_b32 v184, v60, v56, s46
    v_perm_b32 v185, v60, v56, s47
    v_perm_b32 v186, v61, v57, s46
    v_perm_b32 v187, v61, v57, s47
    v_perm_b32 v188, v62, v58, s46
    v_perm_b32 v189, v62, v58, s47
    v_perm_b32 v190, v63, v59, s46
    v_perm_b32 v191, v63, v59, s47
    s_waitcnt vmcnt(1)
    buffer_load_dwordx4 v[72:75], v7, s[64:67], s51 offen offset:0 nt
    s_waitcnt vmcnt(1)
    buffer_load_dwordx4 v[76:79], v7, s[64:67], s51 offen offset:1024 nt
    s_add_u32 s51, s51, 8192
    v_perm_b32 v192, v68, v64, s46
    v_perm_b32 v193, v68, v64, s47
    v_perm_b32 v194, v69, v65, s46
    v_perm_b32 v195, v69, v65, s47
    v_perm_b32 v196, v70, v66, s46
    v_perm_b32 v197, v70, v66, s47
    v_perm_b32 v198, v71, v67, s46
    v_perm_b32 v199, v71, v67, s47
    s_waitcnt vmcnt(1)
    buffer_load_dwordx4 v[80:83], v7, s[64:67], s51 offen offset:0 nt
    s_waitcnt vmcnt(1)
    buffer_load_dwordx4 v[84:87], v7, s[64:67], s51 offen offset:1024 nt
    s_add_u32 s51, s51, 8192
    v_perm_b32 v200, v76, v72, s46
    v_perm_b32 v201, v76, v72, s47
    v_perm_b32 v202, v77, v73, s46
    v_perm_b32 v203, v77, v73, s47
    v_perm_b32 v204, v78, v74, s46
    v_perm_b32 v205, v78, v74, s47
    v_perm_b32 v206, v79, v75, s46
    v_perm_b32 v207, v79, v75, s47
    s_waitcnt vmcnt(1)
    buffer_load_dwordx4 v[88:91], v7, s[64:67], s51 offen offset:0 nt
    s_waitcnt vmcnt(1)
    buffer_load_dwordx4 v[92:95], v7, s[64:67], s51 offen offset:1024 nt
    s_add_u32 s51, s51, 8192
    v_perm_b32 v208, v84, v80, s46
    v_perm_b32 v209, v84, v80, s47
    v_perm_b32 v210, v85, v81, s46
    v_perm_b32 v211, v85, v81, s47
    v_perm_b32 v212, v86, v82, s46
    v_perm_b32 v213, v86, v82, s47
    v_perm_b32 v214, v87, v83, s46
    v_perm_b32 v215, v87, v83, s47
    s_waitcnt vmcnt(1)
    buffer_load_dwordx4 v[96:99], v7, s[64:67], s51 offen offset:0 nt
    s_waitcnt vmcnt(1)
    buffer_load_dwordx4 v[100:103], v7, s[64:67], s51 offen offset:1024 nt
    s_add_u32 s51, s51, 8192
    v_perm_b32 v216, v92, v88, s46
    v_perm_b32 v217, v92, v88, s47
    v_perm_b32 v218, v93, v89, s46
    v_perm_b32 v219, v93, v89, s47
    v_perm_b32 v220, v94, v90, s46
    v_perm_b32 v221, v94, v90, s47
    v_perm_b32 v222, v95, v91, s46
    v_perm_b32 v223, v95, v91, s47
    s_waitcnt vmcnt(1)
    buffer_load_dwordx4 v[104:107], v7, s[64:67], s51 offen offset:0 nt
    s_waitcnt vmcnt(1)
    buffer_load_dwordx4 v[108:111], v7, s[64:67], s51 offen offset:1024 nt
    s_add_u32 s51, s51, 8192
    v_perm_b32 v224, v100, v96, s46
    v_perm_b32 v225, v100, v96, s47
    v_perm_b32 v226, v101, v97, s46
    v_perm_b32 v227, v101, v97, s47
    v_perm_b32 v228, v102, v98, s46
    v_perm_b32 v229, v102, v98, s47
    v_perm_b32 v230, v103, v99, s46
    v_perm_b32 v231, v103, v99, s47
    s_waitcnt vmcnt(1)
    buffer_load_dwordx4 v[112:115], v7, s[64:67], s51 offen offset:0 nt
    s_waitcnt vmcnt(1)
    buffer_load_dwordx4 v[116:119], v7, s[64:67], s51 offen offset:1024 nt
    s_add_u32 s51, s51, 8192
    v_perm_b32 v232, v108, v104, s46
    v_perm_b32 v233, v108, v104, s47
    v_perm_b32 v234, v109, v105, s46
    v_perm_b32 v235, v109, v105, s47
    v_perm_b32 v236, v110, v106, s46
    v_perm_b32 v237, v110, v106, s47
    v_perm_b32 v238, v111, v107, s46
    v_perm_b32 v239, v111, v107, s47
    s_waitcnt vmcnt(0)
    v_perm_b32 v240, v116, v112, s46
    v_perm_b32 v241, v116, v112, s47
    v_perm_b32 v242, v117, v113, s46
    v_perm_b32 v243, v117, v113, s47
    v_perm_b32 v244, v118, v114, s46
    v_perm_b32 v245, v118, v114, s47
    v_perm_b32 v246, v119, v115, s46
    v_perm_b32 v247, v119, v115, s47
    v_lshlrev_b32 v5, 4, v0
    buffer_load_dwordx4 v[56:59], v5, s[36:39], 0 offen
    buffer_load_dwordx4 v[60:63], v5, s[72:75], 0 offen
    buffer_load_dwordx4 v[64:67], v5, s[68:71], 0 offen
    v_lshrrev_b32 v6, 1, v4
    s_lshl_b32 s35, s3, 8
    buffer_load_dword v26, v6, s[36:39], s35 offen
    v_cmp_gt_u32 vcc, 8, v2
    v_mov_b32 v28, s20
    v_mov_b32 v29, s18
    v_cndmask_b32 v18, v28, v29, vcc
    v_mov_b32 v28, s21
    v_mov_b32 v29, s19
    v_cndmask_b32 v19, v28, v29, vcc
    s_mul_i32 s35, s3, 28672
    s_lshl_b32 s45, s33, 7
    s_add_u32 s35, s35, s45
    v_mul_u32_u24 v28, 7168, v3
    v_and_b32 v29, 7, v2
    v_lshl_add_u32 v28, v29, 4, v28
    v_add_u32 v28, s35, v28
    v_add_co_u32 v18, vcc, v28, v18
    s_nop 1
    v_addc_co_u32 v19, vcc, 0, v19, vcc
    v_mov_b32 v8, 0
    v_mov_b32 v9, 0
    v_mov_b32 v10, 0
    v_mov_b32 v11, 0
    v_mov_b32 v12, 0
    v_mov_b32 v13, 0
    v_mov_b32 v14, 0
    v_mov_b32 v15, 0
    s_waitcnt vmcnt(0)
    v_lshlrev_b32 v72, 16, v56
    v_and_b32 v73, 0xffff0000, v56
    v_lshlrev_b32 v74, 16, v60
    v_and_b32 v75, 0xffff0000, v60
    v_mul_f32 v72, v72, v74
    v_mul_f32 v73, v73, v75
    v_cvt_pk_bf16_f32 v76, v72, v73
    v_lshlrev_b32 v72, 16, v57
    v_and_b32 v73, 0xffff0000, v57
    v_lshlrev_b32 v74, 16, v61
    v_and_b32 v75, 0xffff0000, v61
    v_mul_f32 v72, v72, v74
    v_mul_f32 v73, v73, v75
    v_cvt_pk_bf16_f32 v77, v72, v73
    v_lshlrev_b32 v72, 16, v58
    v_and_b32 v73, 0xffff0000, v58
    v_lshlrev_b32 v74, 16, v62
    v_and_b32 v75, 0xffff0000, v62
    v_mul_f32 v72, v72, v74
    v_mul_f32 v73, v73, v75
    v_cvt_pk_bf16_f32 v78, v72, v73
    v_lshlrev_b32 v72, 16, v59
    v_and_b32 v73, 0xffff0000, v59
    v_lshlrev_b32 v74, 16, v63
    v_and_b32 v75, 0xffff0000, v63
    v_mul_f32 v72, v72, v74
    v_mul_f32 v73, v73, v75
    v_cvt_pk_bf16_f32 v79, v72, v73
    v_mov_b32 v80, 0
    v_mov_b32 v81, 0
    v_dot2c_f32_bf16 v80, 0x3f803f80, v76
    v_dot2c_f32_bf16 v81, v56, v64
    v_dot2c_f32_bf16 v80, 0x3f803f80, v77
    v_dot2c_f32_bf16 v81, v57, v65
    v_dot2c_f32_bf16 v80, 0x3f803f80, v78
    v_dot2c_f32_bf16 v81, v58, v66
    v_dot2c_f32_bf16 v80, 0x3f803f80, v79
    v_dot2c_f32_bf16 v81, v59, v67
    s_nop 1
    v_add_f32_dpp v80, v80, v80 quad_perm:[1,0,3,2] row_mask:0xf bank_mask:0xf
    v_add_f32_dpp v81, v81, v81 quad_perm:[1,0,3,2] row_mask:0xf bank_mask:0xf
    s_nop 0
    v_add_f32_dpp v80, v80, v80 quad_perm:[2,3,0,1] row_mask:0xf bank_mask:0xf
    v_add_f32_dpp v81, v81, v81 quad_perm:[2,3,0,1] row_mask:0xf bank_mask:0xf
    s_nop 0
    v_add_f32_dpp v80, v80, v80 row_half_mirror row_mask:0xf bank_mask:0xf
    v_add_f32_dpp v81, v81, v81 row_half_mirror row_mask:0xf bank_mask:0xf
    s_nop 0
    v_add_f32_dpp v80, v80, v80 row_mirror row_mask:0xf bank_mask:0xf
    v_add_f32_dpp v81, v81, v81 row_mirror row_mask:0xf bank_mask:0xf
    v_mov_b32 v82, v80
    v_mov_b32 v83, v81
    s_nop 0
    v_permlane32_swap_b32 v80, v82
    v_permlane32_swap_b32 v81, v83
    v_add_f32 v80, v80, v82
    v_add_f32 v81, v81, v83
    v_mov_b32 v82, v80
    v_mov_b32 v83, v81
    s_nop 0
    v_permlane16_swap_b32 v80, v82
    v_permlane16_swap_b32 v81, v83
    v_add_f32 v80, v80, v82
    v_add_f32 v81, v81, v83
    v_cvt_pk_bf16_f32 v72, v80, v81
    v_lshlrev_b32 v80, 16, v72
    v_and_b32 v81, 0xffff0000, v72
    v_mul_f32 v80, 0xbfb8aa3b, v80
    v_exp_f32 v80, v80
    s_nop 0
    v_add_f32 v80, 1.0, v80
    v_rcp_f32 v80, v80
    v_mul_f32 v81, 0xbfb8aa3b, v81
    v_exp_f32 v81, v81
    s_nop 0
    v_add_f32 v81, 1.0, v81
    v_rcp_f32 v81, v81
    s_nop 0
    v_cvt_pk_bf16_f32 v72, v80, v81
    v_lshlrev_b32 v80, 16, v72
    v_and_b32 v81, 0xffff0000, v72
    v_mov_b32 v20, v80
    v_sub_f32 v73, 1.0, v80
    v_cvt_pk_bf16_f32 v72, v73, v73
    v_lshlrev_b32 v73, 16, v72
    v_mul_f32 v21, v73, v81
    s_cmp_eq_u32 s33, 28
    s_cselect_b32 s35, 1.0, 0
    v_mul_f32 v73, s35, v73
    v_lshlrev_b32 v22, 16, v26
    v_and_b32 v23, 0xffff0000, v26
    v_mul_f32 v22, v22, v73
    v_mul_f32 v23, v23, v73
    v_mov_b32 v28, 1
    s_cmp_lt_u32 s33, 28
    s_cbranch_scc1 L_ffn
    s_mov_b64 exec, 1
    ds_add_u32 v25, v28
    s_mov_b64 exec, -1
    s_branch L_noffn
L_ffn:
    global_load_dwordx4 v[56:59], v[18:19], off offset:0 nt
    global_load_dwordx4 v[60:63], v[18:19], off offset:3584 nt
    v_add_co_u32 v18, vcc, 114688, v18
    s_nop 1
    v_addc_co_u32 v19, vcc, 0, v19, vcc
    s_waitcnt vmcnt(1)
    global_load_dwordx4 v[64:67], v[18:19], off offset:0 nt
    s_waitcnt vmcnt(1)
    global_load_dwordx4 v[68:71], v[18:19], off offset:3584 nt
    v_add_co_u32 v18, vcc, 114688, v18
    s_nop 1
    v_addc_co_u32 v19, vcc, 0, v19, vcc
    v_perm_b32 v40, v60, v56, s46
    v_perm_b32 v41, v60, v56, s47
    v_perm_b32 v42, v61, v57, s46
    v_perm_b32 v43, v61, v57, s47
    v_perm_b32 v44, v62, v58, s46
    v_perm_b32 v45, v62, v58, s47
    v_perm_b32 v46, v63, v59, s46
    v_perm_b32 v47, v63, v59, s47
    v_dot2c_f32_bf16_dpp v8, v16, v40 row_newbcast:0 row_mask:0xf bank_mask:0xf
    v_dot2c_f32_bf16_dpp v9, v16, v41 row_newbcast:0 row_mask:0xf bank_mask:0xf
    v_dot2c_f32_bf16_dpp v10, v16, v42 row_newbcast:0 row_mask:0xf bank_mask:0xf
    v_dot2c_f32_bf16_dpp v11, v16, v43 row_newbcast:0 row_mask:0xf bank_mask:0xf
    v_dot2c_f32_bf16_dpp v12, v16, v44 row_newbcast:0 row_mask:0xf bank_mask:0xf
    v_dot2c_f32_bf16_dpp v13, v16, v45 row_newbcast:0 row_mask:0xf bank_mask:0xf
    v_dot2c_f32_bf16_dpp v14, v16, v46 row_newbcast:0 row_mask:0xf bank_mask:0xf
    v_dot2c_f32_bf16_dpp v15, v16, v47 row_newbcast:0 row_mask:0xf bank_mask:0xf
    s_waitcnt vmcnt(1)
    global_load_dwordx4 v[72:75], v[18:19], off offset:0 nt
    s_waitcnt vmcnt(1)
    global_load_dwordx4 v[76:79], v[18:19], off offset:3584 nt
    v_add_co_u32 v18, vcc, 114688, v18
    s_nop 1
    v_addc_co_u32 v19, vcc, 0, v19, vcc
    v_perm_b32 v48, v68, v64, s46
    v_perm_b32 v49, v68, v64, s47
    v_perm_b32 v50, v69, v65, s46
    v_perm_b32 v51, v69, v65, s47
    v_perm_b32 v52, v70, v66, s46
    v_perm_b32 v53, v70, v66, s47
    v_perm_b32 v54, v71, v67, s46
    v_perm_b32 v55, v71, v67, s47
    v_dot2c_f32_bf16_dpp v8, v16, v48 row_newbcast:1 row_mask:0xf bank_mask:0xf
    v_dot2c_f32_bf16_dpp v9, v16, v49 row_newbcast:1 row_mask:0xf bank_mask:0xf
    v_dot2c_f32_bf16_dpp v10, v16, v50 row_newbcast:1 row_mask:0xf bank_mask:0xf
    v_dot2c_f32_bf16_dpp v11, v16, v51 row_newbcast:1 row_mask:0xf bank_mask:0xf
    v_dot2c_f32_bf16_dpp v12, v16, v52 row_newbcast:1 row_mask:0xf bank_mask:0xf
    v_dot2c_f32_bf16_dpp v13, v16, v53 row_newbcast:1 row_mask:0xf bank_mask:0xf
    v_dot2c_f32_bf16_dpp v14, v16, v54 row_newbcast:1 row_mask:0xf bank_mask:0xf
    v_dot2c_f32_bf16_dpp v15, v16, v55 row_newbcast:1 row_mask:0xf bank_mask:0xf
    s_waitcnt vmcnt(1)
    global_load_dwordx4 v[80:83], v[18:19], off offset:0 nt
    s_waitcnt vmcnt(1)
    global_load_dwordx4 v[84:87], v[18:19], off offset:3584 nt
    v_add_co_u32 v18, vcc, 114688, v18
    s_nop 1
    v_addc_co_u32 v19, vcc, 0, v19, vcc
    v_perm_b32 v40, v76, v72, s46
    v_perm_b32 v41, v76, v72, s47
    v_perm_b32 v42, v77, v73, s46
    v_perm_b32 v43, v77, v73, s47
    v_perm_b32 v44, v78, v74, s46
    v_perm_b32 v45, v78, v74, s47
    v_perm_b32 v46, v79, v75, s46
    v_perm_b32 v47, v79, v75, s47
    v_dot2c_f32_bf16_dpp v8, v16, v40 row_newbcast:2 row_mask:0xf bank_mask:0xf
    v_dot2c_f32_bf16_dpp v9, v16, v41 row_newbcast:2 row_mask:0xf bank_mask:0xf
    v_dot2c_f32_bf16_dpp v10, v16, v42 row_newbcast:2 row_mask:0xf bank_mask:0xf
    v_dot2c_f32_bf16_dpp v11, v16, v43 row_newbcast:2 row_mask:0xf bank_mask:0xf
    v_dot2c_f32_bf16_dpp v12, v16, v44 row_newbcast:2 row_mask:0xf bank_mask:0xf
    v_dot2c_f32_bf16_dpp v13, v16, v45 row_newbcast:2 row_mask:0xf bank_mask:0xf
    v_dot2c_f32_bf16_dpp v14, v16, v46 row_newbcast:2 row_mask:0xf bank_mask:0xf
    v_dot2c_f32_bf16_dpp v15, v16, v47 row_newbcast:2 row_mask:0xf bank_mask:0xf
    s_waitcnt vmcnt(1)
    global_load_dwordx4 v[88:91], v[18:19], off offset:0 nt
    s_waitcnt vmcnt(1)
    global_load_dwordx4 v[92:95], v[18:19], off offset:3584 nt
    v_add_co_u32 v18, vcc, 114688, v18
    s_nop 1
    v_addc_co_u32 v19, vcc, 0, v19, vcc
    v_perm_b32 v48, v84, v80, s46
    v_perm_b32 v49, v84, v80, s47
    v_perm_b32 v50, v85, v81, s46
    v_perm_b32 v51, v85, v81, s47
    v_perm_b32 v52, v86, v82, s46
    v_perm_b32 v53, v86, v82, s47
    v_perm_b32 v54, v87, v83, s46
    v_perm_b32 v55, v87, v83, s47
    v_dot2c_f32_bf16_dpp v8, v16, v48 row_newbcast:3 row_mask:0xf bank_mask:0xf
    v_dot2c_f32_bf16_dpp v9, v16, v49 row_newbcast:3 row_mask:0xf bank_mask:0xf
    v_dot2c_f32_bf16_dpp v10, v16, v50 row_newbcast:3 row_mask:0xf bank_mask:0xf
    v_dot2c_f32_bf16_dpp v11, v16, v51 row_newbcast:3 row_mask:0xf bank_mask:0xf
    v_dot2c_f32_bf16_dpp v12, v16, v52 row_newbcast:3 row_mask:0xf bank_mask:0xf
    v_dot2c_f32_bf16_dpp v13, v16, v53 row_newbcast:3 row_mask:0xf bank_mask:0xf
    v_dot2c_f32_bf16_dpp v14, v16, v54 row_newbcast:3 row_mask:0xf bank_mask:0xf
    v_dot2c_f32_bf16_dpp v15, v16, v55 row_newbcast:3 row_mask:0xf bank_mask:0xf
    s_waitcnt vmcnt(1)
    global_load_dwordx4 v[96:99], v[18:19], off offset:0 nt
    s_waitcnt vmcnt(1)
    global_load_dwordx4 v[100:103], v[18:19], off offset:3584 nt
    v_add_co_u32 v18, vcc, 114688, v18
    s_nop 1
    v_addc_co_u32 v19, vcc, 0, v19, vcc
    v_perm_b32 v40, v92, v88, s46
    v_perm_b32 v41, v92, v88, s47
    v_perm_b32 v42, v93, v89, s46
    v_perm_b32 v43, v93, v89, s47
    v_perm_b32 v44, v94, v90, s46
    v_perm_b32 v45, v94, v90, s47
    v_perm_b32 v46, v95, v91, s46
    v_perm_b32 v47, v95, v91, s47
    v_dot2c_f32_bf16_dpp v8, v16, v40 row_newbcast:4 row_mask:0xf bank_mask:0xf
    v_dot2c_f32_bf16_dpp v9, v16, v41 row_newbcast:4 row_mask:0xf bank_mask:0xf
    v_dot2c_f32_bf16_dpp v10, v16, v42 row_newbcast:4 row_mask:0xf bank_mask:0xf
    v_dot2c_f32_bf16_dpp v11, v16, v43 row_newbcast:4 row_mask:0xf bank_mask:0xf
    v_dot2c_f32_bf16_dpp v12, v16, v44 row_newbcast:4 row_mask:0xf bank_mask:0xf
    v_dot2c_f32_bf16_dpp v13, v16, v45 row_newbcast:4 row_mask:0xf bank_mask:0xf
    v_dot2c_f32_bf16_dpp v14, v16, v46 row_newbcast:4 row_mask:0xf bank_mask:0xf
    v_dot2c_f32_bf16_dpp v15, v16, v47 row_newbcast:4 row_mask:0xf bank_mask:0xf
    s_waitcnt vmcnt(1)
    global_load_dwordx4 v[104:107], v[18:19], off offset:0 nt
    s_waitcnt vmcnt(1)
    global_load_dwordx4 v[108:111], v[18:19], off offset:3584 nt
    v_add_co_u32 v18, vcc, 114688, v18
    s_nop 1
    v_addc_co_u32 v19, vcc, 0, v19, vcc
    v_perm_b32 v48, v100, v96, s46
    v_perm_b32 v49, v100, v96, s47
    v_perm_b32 v50, v101, v97, s46
    v_perm_b32 v51, v101, v97, s47
    v_perm_b32 v52, v102, v98, s46
    v_perm_b32 v53, v102, v98, s47
    v_perm_b32 v54, v103, v99, s46
    v_perm_b32 v55, v103, v99, s47
    v_dot2c_f32_bf16_dpp v8, v16, v48 row_newbcast:5 row_mask:0xf bank_mask:0xf
    v_dot2c_f32_bf16_dpp v9, v16, v49 row_newbcast:5 row_mask:0xf bank_mask:0xf
    v_dot2c_f32_bf16_dpp v10, v16, v50 row_newbcast:5 row_mask:0xf bank_mask:0xf
    v_dot2c_f32_bf16_dpp v11, v16, v51 row_newbcast:5 row_mask:0xf bank_mask:0xf
    v_dot2c_f32_bf16_dpp v12, v16, v52 row_newbcast:5 row_mask:0xf bank_mask:0xf
    v_dot2c_f32_bf16_dpp v13, v16, v53 row_newbcast:5 row_mask:0xf bank_mask:0xf
    v_dot2c_f32_bf16_dpp v14, v16, v54 row_newbcast:5 row_mask:0xf bank_mask:0xf
    v_dot2c_f32_bf16_dpp v15, v16, v55 row_newbcast:5 row_mask:0xf bank_mask:0xf
    s_waitcnt vmcnt(1)
    global_load_dwordx4 v[112:115], v[18:19], off offset:0 nt
    s_waitcnt vmcnt(1)
    global_load_dwordx4 v[116:119], v[18:19], off offset:3584 nt
    v_add_co_u32 v18, vcc, 114688, v18
    s_nop 1
    v_addc_co_u32 v19, vcc, 0, v19, vcc
    v_perm_b32 v40, v108, v104, s46
    v_perm_b32 v41, v108, v104, s47
    v_perm_b32 v42, v109, v105, s46
    v_perm_b32 v43, v109, v105, s47
    v_perm_b32 v44, v110, v106, s46
    v_perm_b32 v45, v110, v106, s47
    v_perm_b32 v46, v111, v107, s46
    v_perm_b32 v47, v111, v107, s47
    v_dot2c_f32_bf16_dpp v8, v16, v40 row_newbcast:6 row_mask:0xf bank_mask:0xf
    v_dot2c_f32_bf16_dpp v9, v16, v41 row_newbcast:6 row_mask:0xf bank_mask:0xf
    v_dot2c_f32_bf16_dpp v10, v16, v42 row_newbcast:6 row_mask:0xf bank_mask:0xf
    v_dot2c_f32_bf16_dpp v11, v16, v43 row_newbcast:6 row_mask:0xf bank_mask:0xf
    v_dot2c_f32_bf16_dpp v12, v16, v44 row_newbcast:6 row_mask:0xf bank_mask:0xf
    v_dot2c_f32_bf16_dpp v13, v16, v45 row_newbcast:6 row_mask:0xf bank_mask:0xf
    v_dot2c_f32_bf16_dpp v14, v16, v46 row_newbcast:6 row_mask:0xf bank_mask:0xf
    v_dot2c_f32_bf16_dpp v15, v16, v47 row_newbcast:6 row_mask:0xf bank_mask:0xf
    s_waitcnt vmcnt(1)
    global_load_dwordx4 v[56:59], v[18:19], off offset:0 nt
    s_waitcnt vmcnt(1)
    global_load_dwordx4 v[60:63], v[18:19], off offset:3584 nt
    v_add_co_u32 v18, vcc, 114688, v18
    s_nop 1
    v_addc_co_u32 v19, vcc, 0, v19, vcc
    v_perm_b32 v48, v116, v112, s46
    v_perm_b32 v49, v116, v112, s47
    v_perm_b32 v50, v117, v113, s46
    v_perm_b32 v51, v117, v113, s47
    v_perm_b32 v52, v118, v114, s46
    v_perm_b32 v53, v118, v114, s47
    v_perm_b32 v54, v119, v115, s46
    v_perm_b32 v55, v119, v115, s47
    v_dot2c_f32_bf16_dpp v8, v16, v48 row_newbcast:7 row_mask:0xf bank_mask:0xf
    v_dot2c_f32_bf16_dpp v9, v16, v49 row_newbcast:7 row_mask:0xf bank_mask:0xf
    v_dot2c_f32_bf16_dpp v10, v16, v50 row_newbcast:7 row_mask:0xf bank_mask:0xf
    v_dot2c_f32_bf16_dpp v11, v16, v51 row_newbcast:7 row_mask:0xf bank_mask:0xf
    v_dot2c_f32_bf16_dpp v12, v16, v52 row_newbcast:7 row_mask:0xf bank_mask:0xf
    v_dot2c_f32_bf16_dpp v13, v16, v53 row_newbcast:7 row_mask:0xf bank_mask:0xf
    v_dot2c_f32_bf16_dpp v14, v16, v54 row_newbcast:7 row_mask:0xf bank_mask:0xf
    v_dot2c_f32_bf16_dpp v15, v16, v55 row_newbcast:7 row_mask:0xf bank_mask:0xf
    s_waitcnt vmcnt(1)
    global_load_dwordx4 v[64:67], v[18:19], off offset:0 nt
    s_waitcnt vmcnt(1)
    global_load_dwordx4 v[68:71], v[18:19], off offset:3584 nt
    v_add_co_u32 v18, vcc, 114688, v18
    s_nop 1
    v_addc_co_u32 v19, vcc, 0, v19, vcc
    v_perm_b32 v40, v60, v56, s46
    v_perm_b32 v41, v60, v56, s47
    v_perm_b32 v42, v61, v57, s46
    v_perm_b32 v43, v61, v57, s47
    v_perm_b32 v44, v62, v58, s46
    v_perm_b32 v45, v62, v58, s47
    v_perm_b32 v46, v63, v59, s46
    v_perm_b32 v47, v63, v59, s47
    v_dot2c_f32_bf16_dpp v8, v16, v40 row_newbcast:8 row_mask:0xf bank_mask:0xf
    v_dot2c_f32_bf16_dpp v9, v16, v41 row_newbcast:8 row_mask:0xf bank_mask:0xf
    v_dot2c_f32_bf16_dpp v10, v16, v42 row_newbcast:8 row_mask:0xf bank_mask:0xf
    v_dot2c_f32_bf16_dpp v11, v16, v43 row_newbcast:8 row_mask:0xf bank_mask:0xf
    v_dot2c_f32_bf16_dpp v12, v16, v44 row_newbcast:8 row_mask:0xf bank_mask:0xf
    v_dot2c_f32_bf16_dpp v13, v16, v45 row_newbcast:8 row_mask:0xf bank_mask:0xf
    v_dot2c_f32_bf16_dpp v14, v16, v46 row_newbcast:8 row_mask:0xf bank_mask:0xf
    v_dot2c_f32_bf16_dpp v15, v16, v47 row_newbcast:8 row_mask:0xf bank_mask:0xf
    s_waitcnt vmcnt(1)
    global_load_dwordx4 v[72:75], v[18:19], off offset:0 nt
    s_waitcnt vmcnt(1)
    global_load_dwordx4 v[76:79], v[18:19], off offset:3584 nt
    v_add_co_u32 v18, vcc, 114688, v18
    s_nop 1
    v_addc_co_u32 v19, vcc, 0, v19, vcc
    v_perm_b32 v48, v68, v64, s46
    v_perm_b32 v49, v68, v64, s47
    v_perm_b32 v50, v69, v65, s46
    v_perm_b32 v51, v69, v65, s47
    v_perm_b32 v52, v70, v66, s46
    v_perm_b32 v53, v70, v66, s47
    v_perm_b32 v54, v71, v67, s46
    v_perm_b32 v55, v71, v67, s47
    v_dot2c_f32_bf16_dpp v8, v16, v48 row_newbcast:9 row_mask:0xf bank_mask:0xf
    v_dot2c_f32_bf16_dpp v9, v16, v49 row_newbcast:9 row_mask:0xf bank_mask:0xf
    v_dot2c_f32_bf16_dpp v10, v16, v50 row_newbcast:9 row_mask:0xf bank_mask:0xf
    v_dot2c_f32_bf16_dpp v11, v16, v51 row_newbcast:9 row_mask:0xf bank_mask:0xf
    v_dot2c_f32_bf16_dpp v12, v16, v52 row_newbcast:9 row_mask:0xf bank_mask:0xf
    v_dot2c_f32_bf16_dpp v13, v16, v53 row_newbcast:9 row_mask:0xf bank_mask:0xf
    v_dot2c_f32_bf16_dpp v14, v16, v54 row_newbcast:9 row_mask:0xf bank_mask:0xf
    v_dot2c_f32_bf16_dpp v15, v16, v55 row_newbcast:9 row_mask:0xf bank_mask:0xf
    s_waitcnt vmcnt(1)
    global_load_dwordx4 v[80:83], v[18:19], off offset:0 nt
    s_waitcnt vmcnt(1)
    global_load_dwordx4 v[84:87], v[18:19], off offset:3584 nt
    v_add_co_u32 v18, vcc, 114688, v18
    s_nop 1
    v_addc_co_u32 v19, vcc, 0, v19, vcc
    v_perm_b32 v40, v76, v72, s46
    v_perm_b32 v41, v76, v72, s47
    v_perm_b32 v42, v77, v73, s46
    v_perm_b32 v43, v77, v73, s47
    v_perm_b32 v44, v78, v74, s46
    v_perm_b32 v45, v78, v74, s47
    v_perm_b32 v46, v79, v75, s46
    v_perm_b32 v47, v79, v75, s47
    v_dot2c_f32_bf16_dpp v8, v16, v40 row_newbcast:10 row_mask:0xf bank_mask:0xf
    v_dot2c_f32_bf16_dpp v9, v16, v41 row_newbcast:10 row_mask:0xf bank_mask:0xf
    v_dot2c_f32_bf16_dpp v10, v16, v42 row_newbcast:10 row_mask:0xf bank_mask:0xf
    v_dot2c_f32_bf16_dpp v11, v16, v43 row_newbcast:10 row_mask:0xf bank_mask:0xf
    v_dot2c_f32_bf16_dpp v12, v16, v44 row_newbcast:10 row_mask:0xf bank_mask:0xf
    v_dot2c_f32_bf16_dpp v13, v16, v45 row_newbcast:10 row_mask:0xf bank_mask:0xf
    v_dot2c_f32_bf16_dpp v14, v16, v46 row_newbcast:10 row_mask:0xf bank_mask:0xf
    v_dot2c_f32_bf16_dpp v15, v16, v47 row_newbcast:10 row_mask:0xf bank_mask:0xf
    s_waitcnt vmcnt(1)
    global_load_dwordx4 v[88:91], v[18:19], off offset:0 nt
    s_waitcnt vmcnt(1)
    global_load_dwordx4 v[92:95], v[18:19], off offset:3584 nt
    v_add_co_u32 v18, vcc, 114688, v18
    s_nop 1
    v_addc_co_u32 v19, vcc, 0, v19, vcc
    v_perm_b32 v48, v84, v80, s46
    v_perm_b32 v49, v84, v80, s47
    v_perm_b32 v50, v85, v81, s46
    v_perm_b32 v51, v85, v81, s47
    v_perm_b32 v52, v86, v82, s46
    v_perm_b32 v53, v86, v82, s47
    v_perm_b32 v54, v87, v83, s46
    v_perm_b32 v55, v87, v83, s47
    v_dot2c_f32_bf16_dpp v8, v16, v48 row_newbcast:11 row_mask:0xf bank_mask:0xf
    v_dot2c_f32_bf16_dpp v9, v16, v49 row_newbcast:11 row_mask:0xf bank_mask:0xf
    v_dot2c_f32_bf16_dpp v10, v16, v50 row_newbcast:11 row_mask:0xf bank_mask:0xf
    v_dot2c_f32_bf16_dpp v11, v16, v51 row_newbcast:11 row_mask:0xf bank_mask:0xf
    v_dot2c_f32_bf16_dpp v12, v16, v52 row_newbcast:11 row_mask:0xf bank_mask:0xf
    v_dot2c_f32_bf16_dpp v13, v16, v53 row_newbcast:11 row_mask:0xf bank_mask:0xf
    v_dot2c_f32_bf16_dpp v14, v16, v54 row_newbcast:11 row_mask:0xf bank_mask:0xf
    v_dot2c_f32_bf16_dpp v15, v16, v55 row_newbcast:11 row_mask:0xf bank_mask:0xf
    s_waitcnt vmcnt(1)
    global_load_dwordx4 v[96:99], v[18:19], off offset:0 nt
    s_waitcnt vmcnt(1)
    global_load_dwordx4 v[100:103], v[18:19], off offset:3584 nt
    v_add_co_u32 v18, vcc, 114688, v18
    s_nop 1
    v_addc_co_u32 v19, vcc, 0, v19, vcc
    v_perm_b32 v40, v92, v88, s46
    v_perm_b32 v41, v92, v88, s47
    v_perm_b32 v42, v93, v89, s46
    v_perm_b32 v43, v93, v89, s47
    v_perm_b32 v44, v94, v90, s46
    v_perm_b32 v45, v94, v90, s47
    v_perm_b32 v46, v95, v91, s46
    v_perm_b32 v47, v95, v91, s47
    v_dot2c_f32_bf16_dpp v8, v16, v40 row_newbcast:12 row_mask:0xf bank_mask:0xf
    v_dot2c_f32_bf16_dpp v9, v16, v41 row_newbcast:12 row_mask:0xf bank_mask:0xf
    v_dot2c_f32_bf16_dpp v10, v16, v42 row_newbcast:12 row_mask:0xf bank_mask:0xf
    v_dot2c_f32_bf16_dpp v11, v16, v43 row_newbcast:12 row_mask:0xf bank_mask:0xf
    v_dot2c_f32_bf16_dpp v12, v16, v44 row_newbcast:12 row_mask:0xf bank_mask:0xf
    v_dot2c_f32_bf16_dpp v13, v16, v45 row_newbcast:12 row_mask:0xf bank_mask:0xf
    v_dot2c_f32_bf16_dpp v14, v16, v46 row_newbcast:12 row_mask:0xf bank_mask:0xf
    v_dot2c_f32_bf16_dpp v15, v16, v47 row_newbcast:12 row_mask:0xf bank_mask:0xf
    s_waitcnt vmcnt(1)
    global_load_dwordx4 v[104:107], v[18:19], off offset:0 nt
    s_waitcnt vmcnt(1)
    global_load_dwordx4 v[108:111], v[18:19], off offset:3584 nt
    v_add_co_u32 v18, vcc, 114688, v18
    s_nop 1
    v_addc_co_u32 v19, vcc, 0, v19, vcc
    v_perm_b32 v48, v100, v96, s46
    v_perm_b32 v49, v100, v96, s47
    v_perm_b32 v50, v101, v97, s46
    v_perm_b32 v51, v101, v97, s47
    v_perm_b32 v52, v102, v98, s46
    v_perm_b32 v53, v102, v98, s47
    v_perm_b32 v54, v103, v99, s46
    v_perm_b32 v55, v103, v99, s47
    v_dot2c_f32_bf16_dpp v8, v16, v48 row_newbcast:13 row_mask:0xf bank_mask:0xf
    v_dot2c_f32_bf16_dpp v9, v16, v49 row_newbcast:13 row_mask:0xf bank_mask:0xf
    v_dot2c_f32_bf16_dpp v10, v16, v50 row_newbcast:13 row_mask:0xf bank_mask:0xf
    v_dot2c_f32_bf16_dpp v11, v16, v51 row_newbcast:13 row_mask:0xf bank_mask:0xf
    v_dot2c_f32_bf16_dpp v12, v16, v52 row_newbcast:13 row_mask:0xf bank_mask:0xf
    v_dot2c_f32_bf16_dpp v13, v16, v53 row_newbcast:13 row_mask:0xf bank_mask:0xf
    v_dot2c_f32_bf16_dpp v14, v16, v54 row_newbcast:13 row_mask:0xf bank_mask:0xf
    v_dot2c_f32_bf16_dpp v15, v16, v55 row_newbcast:13 row_mask:0xf bank_mask:0xf
    s_waitcnt vmcnt(1)
    global_load_dwordx4 v[112:115], v[18:19], off offset:0 nt
    s_waitcnt vmcnt(1)
    global_load_dwordx4 v[116:119], v[18:19], off offset:3584 nt
    v_perm_b32 v40, v108, v104, s46
    v_perm_b32 v41, v108, v104, s47
    v_perm_b32 v42, v109, v105, s46
    v_perm_b32 v43, v109, v105, s47
    v_perm_b32 v44, v110, v106, s46
    v_perm_b32 v45, v110, v106, s47
    v_perm_b32 v46, v111, v107, s46
    v_perm_b32 v47, v111, v107, s47
    v_dot2c_f32_bf16_dpp v8, v16, v40 row_newbcast:14 row_mask:0xf bank_mask:0xf
    v_dot2c_f32_bf16_dpp v9, v16, v41 row_newbcast:14 row_mask:0xf bank_mask:0xf
    v_dot2c_f32_bf16_dpp v10, v16, v42 row_newbcast:14 row_mask:0xf bank_mask:0xf
    v_dot2c_f32_bf16_dpp v11, v16, v43 row_newbcast:14 row_mask:0xf bank_mask:0xf
    v_dot2c_f32_bf16_dpp v12, v16, v44 row_newbcast:14 row_mask:0xf bank_mask:0xf
    v_dot2c_f32_bf16_dpp v13, v16, v45 row_newbcast:14 row_mask:0xf bank_mask:0xf
    v_dot2c_f32_bf16_dpp v14, v16, v46 row_newbcast:14 row_mask:0xf bank_mask:0xf
    v_dot2c_f32_bf16_dpp v15, v16, v47 row_newbcast:14 row_mask:0xf bank_mask:0xf
    s_waitcnt vmcnt(1)
    buffer_load_dwordx4 v[56:59], v7, s[60:63], s50 offen offset:0 nt
    s_waitcnt vmcnt(1)
    buffer_load_dwordx4 v[60:63], v7, s[60:63], s50 offen offset:1024 nt
    s_add_u32 s50, s50, 8192
    v_perm_b32 v48, v116, v112, s46
    v_perm_b32 v49, v116, v112, s47
    v_perm_b32 v50, v117, v113, s46
    v_perm_b32 v51, v117, v113, s47
    v_perm_b32 v52, v118, v114, s46
    v_perm_b32 v53, v118, v114, s47
    v_perm_b32 v54, v119, v115, s46
    v_perm_b32 v55, v119, v115, s47
    v_dot2c_f32_bf16_dpp v8, v16, v48 row_newbcast:15 row_mask:0xf bank_mask:0xf
    v_dot2c_f32_bf16_dpp v9, v16, v49 row_newbcast:15 row_mask:0xf bank_mask:0xf
    v_dot2c_f32_bf16_dpp v10, v16, v50 row_newbcast:15 row_mask:0xf bank_mask:0xf
    v_dot2c_f32_bf16_dpp v11, v16, v51 row_newbcast:15 row_mask:0xf bank_mask:0xf
    v_dot2c_f32_bf16_dpp v12, v16, v52 row_newbcast:15 row_mask:0xf bank_mask:0xf
    v_dot2c_f32_bf16_dpp v13, v16, v53 row_newbcast:15 row_mask:0xf bank_mask:0xf
    v_dot2c_f32_bf16_dpp v14, v16, v54 row_newbcast:15 row_mask:0xf bank_mask:0xf
    v_dot2c_f32_bf16_dpp v15, v16, v55 row_newbcast:15 row_mask:0xf bank_mask:0xf
    v_permlane32_swap_b32 v8, v12
    v_permlane32_swap_b32 v9, v13
    v_permlane32_swap_b32 v10, v14
    v_permlane32_swap_b32 v11, v15
    v_pk_add_f32 v[8:9], v[8:9], v[12:13]
    v_pk_add_f32 v[10:11], v[10:11], v[14:15]
    s_nop 1
    v_permlane16_swap_b32 v8, v10
    v_permlane16_swap_b32 v9, v11
    v_pk_add_f32 v[8:9], v[8:9], v[10:11]
    ds_write_b64 v1, v[8:9] offset:2048
    s_waitcnt lgkmcnt(0)
    s_mov_b64 exec, 1
    ds_add_u32 v25, v28
    s_mov_b64 exec, -1
    s_mov_b32 s59, 0x400000
L_fwait:
    ds_read_b32 v29, v25
    s_waitcnt lgkmcnt(0)
    v_readfirstlane_b32 s35, v29
    s_cmp_ge_u32 s35, 4
    s_cbranch_scc1 L_fgo
    s_sleep 8
    s_sub_u32 s59, s59, 1
    s_cbranch_scc0 L_fwait
L_fgo:
    v_and_b32 v5, 0xff, v4
    ds_read_b64 v[40:41], v5 offset:2048
    ds_read_b64 v[42:43], v5 offset:2304
    ds_read_b64 v[44:45], v5 offset:2560
    ds_read_b64 v[46:47], v5 offset:2816
    ds_read_b64 v[48:49], v5 offset:3072
    ds_read_b64 v[50:51], v5 offset:3328
    ds_read_b64 v[52:53], v5 offset:3584
    ds_read_b64 v[54:55], v5 offset:3840
    v_mov_b32 v8, 0
    v_mov_b32 v9, 0
    v_mov_b32 v10, 0
    v_mov_b32 v11, 0
    v_mov_b32 v12, 0
    v_mov_b32 v13, 0
    v_mov_b32 v14, 0
    v_mov_b32 v15, 0
    s_waitcnt lgkmcnt(0)
    v_pk_add_f32 v[40:41], v[40:41], v[44:45]
    v_pk_add_f32 v[42:43], v[42:43], v[46:47]
    v_pk_add_f32 v[40:41], v[40:41], v[48:49]
    v_pk_add_f32 v[42:43], v[42:43], v[50:51]
    v_pk_add_f32 v[40:41], v[40:41], v[52:53]
    v_pk_add_f32 v[42:43], v[42:43], v[54:55]
    v_cvt_pk_bf16_f32 v44, v40, v41
    v_lshlrev_b32 v40, 16, v44
    v_and_b32 v41, 0xffff0000, v44
    v_cvt_pk_bf16_f32 v45, v42, v43
    v_lshlrev_b32 v42, 16, v45
    v_and_b32 v43, 0xffff0000, v45
    v_mul_f32 v46, 0xbfb8aa3b, v40
    v_exp_f32 v46, v46
    s_nop 0
    v_add_f32 v46, 1.0, v46
    v_rcp_f32 v46, v46
    v_mul_f32 v47, 0xbfb8aa3b, v41
    v_exp_f32 v47, v47
    s_nop 0
    v_add_f32 v47, 1.0, v47
    v_rcp_f32 v47, v47
    v_mul_f32 v40, v40, v46
    v_mul_f32 v41, v41, v47
    v_cvt_pk_bf16_f32 v44, v40, v41
    v_lshlrev_b32 v40, 16, v44
    v_and_b32 v41, 0xffff0000, v44
    v_mul_f32 v40, v40, v42
    v_mul_f32 v41, v41, v43
    v_cvt_pk_bf16_f32 v24, v40, v41
    s_waitcnt vmcnt(1)
    buffer_load_dwordx4 v[64:67], v7, s[60:63], s50 offen offset:0 nt
    s_waitcnt vmcnt(1)
    buffer_load_dwordx4 v[68:71], v7, s[60:63], s50 offen offset:1024 nt
    s_add_u32 s50, s50, 8192
    v_perm_b32 v40, v60, v56, s46
    v_perm_b32 v41, v60, v56, s47
    v_perm_b32 v42, v61, v57, s46
    v_perm_b32 v43, v61, v57, s47
    v_perm_b32 v44, v62, v58, s46
    v_perm_b32 v45, v62, v58, s47
    v_perm_b32 v46, v63, v59, s46
    v_perm_b32 v47, v63, v59, s47
    v_dot2c_f32_bf16_dpp v8, v24, v40 row_newbcast:0 row_mask:0xf bank_mask:0xf
    v_dot2c_f32_bf16_dpp v9, v24, v41 row_newbcast:0 row_mask:0xf bank_mask:0xf
    v_dot2c_f32_bf16_dpp v10, v24, v42 row_newbcast:0 row_mask:0xf bank_mask:0xf
    v_dot2c_f32_bf16_dpp v11, v24, v43 row_newbcast:0 row_mask:0xf bank_mask:0xf
    v_dot2c_f32_bf16_dpp v12, v24, v44 row_newbcast:0 row_mask:0xf bank_mask:0xf
    v_dot2c_f32_bf16_dpp v13, v24, v45 row_newbcast:0 row_mask:0xf bank_mask:0xf
    v_dot2c_f32_bf16_dpp v14, v24, v46 row_newbcast:0 row_mask:0xf bank_mask:0xf
    v_dot2c_f32_bf16_dpp v15, v24, v47 row_newbcast:0 row_mask:0xf bank_mask:0xf
    s_waitcnt vmcnt(1)
    buffer_load_dwordx4 v[72:75], v7, s[60:63], s50 offen offset:0 nt
    s_waitcnt vmcnt(1)
    buffer_load_dwordx4 v[76:79], v7, s[60:63], s50 offen offset:1024 nt
    s_add_u32 s50, s50, 8192
    v_perm_b32 v48, v68, v64, s46
    v_perm_b32 v49, v68, v64, s47
    v_perm_b32 v50, v69, v65, s46
    v_perm_b32 v51, v69, v65, s47
    v_perm_b32 v52, v70, v66, s46
    v_perm_b32 v53, v70, v66, s47
    v_perm_b32 v54, v71, v67, s46
    v_perm_b32 v55, v71, v67, s47
    v_dot2c_f32_bf16_dpp v8, v24, v48 row_newbcast:1 row_mask:0xf bank_mask:0xf
    v_dot2c_f32_bf16_dpp v9, v24, v49 row_newbcast:1 row_mask:0xf bank_mask:0xf
    v_dot2c_f32_bf16_dpp v10, v24, v50 row_newbcast:1 row_mask:0xf bank_mask:0xf
    v_dot2c_f32_bf16_dpp v11, v24, v51 row_newbcast:1 row_mask:0xf bank_mask:0xf
    v_dot2c_f32_bf16_dpp v12, v24, v52 row_newbcast:1 row_mask:0xf bank_mask:0xf
    v_dot2c_f32_bf16_dpp v13, v24, v53 row_newbcast:1 row_mask:0xf bank_mask:0xf
    v_dot2c_f32_bf16_dpp v14, v24, v54 row_newbcast:1 row_mask:0xf bank_mask:0xf
    v_dot2c_f32_bf16_dpp v15, v24, v55 row_newbcast:1 row_mask:0xf bank_mask:0xf
    s_waitcnt vmcnt(1)
    buffer_load_dwordx4 v[80:83], v7, s[60:63], s50 offen offset:0 nt
    s_waitcnt vmcnt(1)
    buffer_load_dwordx4 v[84:87], v7, s[60:63], s50 offen offset:1024 nt
    s_add_u32 s50, s50, 8192
    v_perm_b32 v40, v76, v72, s46
    v_perm_b32 v41, v76, v72, s47
    v_perm_b32 v42, v77, v73, s46
    v_perm_b32 v43, v77, v73, s47
    v_perm_b32 v44, v78, v74, s46
    v_perm_b32 v45, v78, v74, s47
    v_perm_b32 v46, v79, v75, s46
    v_perm_b32 v47, v79, v75, s47
    v_dot2c_f32_bf16_dpp v8, v24, v40 row_newbcast:2 row_mask:0xf bank_mask:0xf
    v_dot2c_f32_bf16_dpp v9, v24, v41 row_newbcast:2 row_mask:0xf bank_mask:0xf
    v_dot2c_f32_bf16_dpp v10, v24, v42 row_newbcast:2 row_mask:0xf bank_mask:0xf
    v_dot2c_f32_bf16_dpp v11, v24, v43 row_newbcast:2 row_mask:0xf bank_mask:0xf
    v_dot2c_f32_bf16_dpp v12, v24, v44 row_newbcast:2 row_mask:0xf bank_mask:0xf
    v_dot2c_f32_bf16_dpp v13, v24, v45 row_newbcast:2 row_mask:0xf bank_mask:0xf
    v_dot2c_f32_bf16_dpp v14, v24, v46 row_newbcast:2 row_mask:0xf bank_mask:0xf
    v_dot2c_f32_bf16_dpp v15, v24, v47 row_newbcast:2 row_mask:0xf bank_mask:0xf
    s_waitcnt vmcnt(1)
    buffer_load_dwordx4 v[88:91], v7, s[60:63], s50 offen offset:0 nt
    s_waitcnt vmcnt(1)
    buffer_load_dwordx4 v[92:95], v7, s[60:63], s50 offen offset:1024 nt
    s_add_u32 s50, s50, 8192
    v_perm_b32 v48, v84, v80, s46
    v_perm_b32 v49, v84, v80, s47
    v_perm_b32 v50, v85, v81, s46
    v_perm_b32 v51, v85, v81, s47
    v_perm_b32 v52, v86, v82, s46
    v_perm_b32 v53, v86, v82, s47
    v_perm_b32 v54, v87, v83, s46
    v_perm_b32 v55, v87, v83, s47
    v_dot2c_f32_bf16_dpp v8, v24, v48 row_newbcast:3 row_mask:0xf bank_mask:0xf
    v_dot2c_f32_bf16_dpp v9, v24, v49 row_newbcast:3 row_mask:0xf bank_mask:0xf
    v_dot2c_f32_bf16_dpp v10, v24, v50 row_newbcast:3 row_mask:0xf bank_mask:0xf
    v_dot2c_f32_bf16_dpp v11, v24, v51 row_newbcast:3 row_mask:0xf bank_mask:0xf
    v_dot2c_f32_bf16_dpp v12, v24, v52 row_newbcast:3 row_mask:0xf bank_mask:0xf
    v_dot2c_f32_bf16_dpp v13, v24, v53 row_newbcast:3 row_mask:0xf bank_mask:0xf
    v_dot2c_f32_bf16_dpp v14, v24, v54 row_newbcast:3 row_mask:0xf bank_mask:0xf
    v_dot2c_f32_bf16_dpp v15, v24, v55 row_newbcast:3 row_mask:0xf bank_mask:0xf
    s_waitcnt vmcnt(1)
    buffer_load_dwordx4 v[96:99], v7, s[60:63], s50 offen offset:0 nt
    s_waitcnt vmcnt(1)
    buffer_load_dwordx4 v[100:103], v7, s[60:63], s50 offen offset:1024 nt
    s_add_u32 s50, s50, 8192
    v_perm_b32 v40, v92, v88, s46
    v_perm_b32 v41, v92, v88, s47
    v_perm_b32 v42, v93, v89, s46
    v_perm_b32 v43, v93, v89, s47
    v_perm_b32 v44, v94, v90, s46
    v_perm_b32 v45, v94, v90, s47
    v_perm_b32 v46, v95, v91, s46
    v_perm_b32 v47, v95, v91, s47
    v_dot2c_f32_bf16_dpp v8, v24, v40 row_newbcast:4 row_mask:0xf bank_mask:0xf
    v_dot2c_f32_bf16_dpp v9, v24, v41 row_newbcast:4 row_mask:0xf bank_mask:0xf
    v_dot2c_f32_bf16_dpp v10, v24, v42 row_newbcast:4 row_mask:0xf bank_mask:0xf
    v_dot2c_f32_bf16_dpp v11, v24, v43 row_newbcast:4 row_mask:0xf bank_mask:0xf
    v_dot2c_f32_bf16_dpp v12, v24, v44 row_newbcast:4 row_mask:0xf bank_mask:0xf
    v_dot2c_f32_bf16_dpp v13, v24, v45 row_newbcast:4 row_mask:0xf bank_mask:0xf
    v_dot2c_f32_bf16_dpp v14, v24, v46 row_newbcast:4 row_mask:0xf bank_mask:0xf
    v_dot2c_f32_bf16_dpp v15, v24, v47 row_newbcast:4 row_mask:0xf bank_mask:0xf
    s_waitcnt vmcnt(1)
    buffer_load_dwordx4 v[104:107], v7, s[60:63], s50 offen offset:0 nt
    s_waitcnt vmcnt(1)
    buffer_load_dwordx4 v[108:111], v7, s[60:63], s50 offen offset:1024 nt
    s_add_u32 s50, s50, 8192
    v_perm_b32 v48, v100, v96, s46
    v_perm_b32 v49, v100, v96, s47
    v_perm_b32 v50, v101, v97, s46
    v_perm_b32 v51, v101, v97, s47
    v_perm_b32 v52, v102, v98, s46
    v_perm_b32 v53, v102, v98, s47
    v_perm_b32 v54, v103, v99, s46
    v_perm_b32 v55, v103, v99, s47
    v_dot2c_f32_bf16_dpp v8, v24, v48 row_newbcast:5 row_mask:0xf bank_mask:0xf
    v_dot2c_f32_bf16_dpp v9, v24, v49 row_newbcast:5 row_mask:0xf bank_mask:0xf
    v_dot2c_f32_bf16_dpp v10, v24, v50 row_newbcast:5 row_mask:0xf bank_mask:0xf
    v_dot2c_f32_bf16_dpp v11, v24, v51 row_newbcast:5 row_mask:0xf bank_mask:0xf
    v_dot2c_f32_bf16_dpp v12, v24, v52 row_newbcast:5 row_mask:0xf bank_mask:0xf
    v_dot2c_f32_bf16_dpp v13, v24, v53 row_newbcast:5 row_mask:0xf bank_mask:0xf
    v_dot2c_f32_bf16_dpp v14, v24, v54 row_newbcast:5 row_mask:0xf bank_mask:0xf
    v_dot2c_f32_bf16_dpp v15, v24, v55 row_newbcast:5 row_mask:0xf bank_mask:0xf
    s_waitcnt vmcnt(1)
    buffer_load_dwordx4 v[112:115], v7, s[60:63], s50 offen offset:0 nt
    s_waitcnt vmcnt(1)
    buffer_load_dwordx4 v[116:119], v7, s[60:63], s50 offen offset:1024 nt
    s_add_u32 s50, s50, 8192
    v_perm_b32 v40, v108, v104, s46
    v_perm_b32 v41, v108, v104, s47
    v_perm_b32 v42, v109, v105, s46
    v_perm_b32 v43, v109, v105, s47
    v_perm_b32 v44, v110, v106, s46
    v_perm_b32 v45, v110, v106, s47
    v_perm_b32 v46, v111, v107, s46
    v_perm_b32 v47, v111, v107, s47
    v_dot2c_f32_bf16_dpp v8, v24, v40 row_newbcast:6 row_mask:0xf bank_mask:0xf
    v_dot2c_f32_bf16_dpp v9, v24, v41 row_newbcast:6 row_mask:0xf bank_mask:0xf
    v_dot2c_f32_bf16_dpp v10, v24, v42 row_newbcast:6 row_mask:0xf bank_mask:0xf
    v_dot2c_f32_bf16_dpp v11, v24, v43 row_newbcast:6 row_mask:0xf bank_mask:0xf
    v_dot2c_f32_bf16_dpp v12, v24, v44 row_newbcast:6 row_mask:0xf bank_mask:0xf
    v_dot2c_f32_bf16_dpp v13, v24, v45 row_newbcast:6 row_mask:0xf bank_mask:0xf
    v_dot2c_f32_bf16_dpp v14, v24, v46 row_newbcast:6 row_mask:0xf bank_mask:0xf
    v_dot2c_f32_bf16_dpp v15, v24, v47 row_newbcast:6 row_mask:0xf bank_mask:0xf
    s_waitcnt vmcnt(0)
    v_perm_b32 v48, v116, v112, s46
    v_perm_b32 v49, v116, v112, s47
    v_perm_b32 v50, v117, v113, s46
    v_perm_b32 v51, v117, v113, s47
    v_perm_b32 v52, v118, v114, s46
    v_perm_b32 v53, v118, v114, s47
    v_perm_b32 v54, v119, v115, s46
    v_perm_b32 v55, v119, v115, s47
    v_dot2c_f32_bf16_dpp v8, v24, v48 row_newbcast:7 row_mask:0xf bank_mask:0xf
    v_dot2c_f32_bf16_dpp v9, v24, v49 row_newbcast:7 row_mask:0xf bank_mask:0xf
    v_dot2c_f32_bf16_dpp v10, v24, v50 row_newbcast:7 row_mask:0xf bank_mask:0xf
    v_dot2c_f32_bf16_dpp v11, v24, v51 row_newbcast:7 row_mask:0xf bank_mask:0xf
    v_dot2c_f32_bf16_dpp v12, v24, v52 row_newbcast:7 row_mask:0xf bank_mask:0xf
    v_dot2c_f32_bf16_dpp v13, v24, v53 row_newbcast:7 row_mask:0xf bank_mask:0xf
    v_dot2c_f32_bf16_dpp v14, v24, v54 row_newbcast:7 row_mask:0xf bank_mask:0xf
    v_dot2c_f32_bf16_dpp v15, v24, v55 row_newbcast:7 row_mask:0xf bank_mask:0xf
    v_permlane32_swap_b32 v8, v12
    v_permlane32_swap_b32 v9, v13
    v_permlane32_swap_b32 v10, v14
    v_permlane32_swap_b32 v11, v15
    v_pk_add_f32 v[8:9], v[8:9], v[12:13]
    v_pk_add_f32 v[10:11], v[10:11], v[14:15]
    s_nop 1
    v_permlane16_swap_b32 v8, v10
    v_permlane16_swap_b32 v9, v11
    v_pk_add_f32 v[8:9], v[8:9], v[10:11]
    v_fmac_f32 v22, v8, v21
    v_fmac_f32 v23, v9, v21
    v_mov_b32 v8, 0
    v_mov_b32 v9, 0
    v_mov_b32 v10, 0
    v_mov_b32 v11, 0
    v_mov_b32 v12, 0
    v_mov_b32 v13, 0
    v_mov_b32 v14, 0
    v_mov_b32 v15, 0
L_noffn:
    v_lshlrev_b32 v5, 3, v0
    v_mov_b32 v6, 0
    v_lshrrev_b32 v7, 1, v4
    s_lshl_b32 s51, s3, 8
    v_lshrrev_b32 v252, 3, v0
    v_and_b32 v253, 7, v0
    v_lshlrev_b32 v28, 11, v252
    v_lshl_add_u32 v28, v253, 4, v28
    s_lshl_b32 s35, s3, 7
    v_add_u32 v28, s35, v28
    s_and_b32 s35, s3, 1
    s_lshl_b32 s35, s35, 7
    s_lshr_b32 s45, s3, 1
    s_lshl_b32 s45, s45, 2
    s_add_u32 s35, s35, s45
    v_lshl_add_u32 v29, v253, 4, s35
    v_lshrrev_b32 v252, 5, v0
    v_lshl_add_u32 v29, v252, 3, v29
    s_lshl_b32 s54, s32, 5
    v_lshlrev_b32 v253, 4, v0
    v_mov_b32 v254, 0x10000
    v_mov_b32 v252, s53
    s_waitcnt lgkmcnt(0)
L_real:
    s_waitcnt vmcnt(0) lgkmcnt(0)
    s_barrier
    ds_read_b32 v255, v6 offset:6176
    s_waitcnt lgkmcnt(0)
    v_readfirstlane_b32 s50, v255
    s_andn2_b32 s55, s50, 31
    s_and_b32 s50, s50, 31
    s_cmp_lt_u32 s50, 28
    s_cbranch_scc1 L_nog
    buffer_load_dword v30, v6, s[84:87], s54 offen sc1
    s_sub_u32 s35, s50, 28
    s_lshl_b32 s51, s35, 8
    s_lshl_b32 s12, s35, 9
    s_add_u32 s13, s12, 16384
    s_add_u32 s14, s12, 32768
    s_add_u32 s15, s12, 49152
L_nog:
    s_barrier
L_nb:
    ds_read_b64 v[40:41], v5 offset:4096
    ds_read_b64 v[42:43], v5 offset:4608
    ds_read_b64 v[44:45], v5 offset:5120
    ds_read_b64 v[46:47], v5 offset:5632
    s_waitcnt lgkmcnt(2)
    v_pk_add_f32 v[40:41], v[40:41], v[42:43]
    s_waitcnt lgkmcnt(0)
    v_pk_add_f32 v[44:45], v[44:45], v[46:47]
    v_pk_add_f32 v[40:41], v[40:41], v[44:45]
    v_cvt_pk_bf16_f32 v24, v40, v41
    s_nop 1
    v_dot2c_f32_bf16_dpp v8, v24, v120 row_newbcast:0 row_mask:0xf bank_mask:0xf
    v_dot2c_f32_bf16_dpp v9, v24, v121 row_newbcast:0 row_mask:0xf bank_mask:0xf
    v_dot2c_f32_bf16_dpp v10, v24, v122 row_newbcast:0 row_mask:0xf bank_mask:0xf
    v_dot2c_f32_bf16_dpp v11, v24, v123 row_newbcast:0 row_mask:0xf bank_mask:0xf
    v_dot2c_f32_bf16_dpp v12, v24, v124 row_newbcast:0 row_mask:0xf bank_mask:0xf
    v_dot2c_f32_bf16_dpp v13, v24, v125 row_newbcast:0 row_mask:0xf bank_mask:0xf
    v_dot2c_f32_bf16_dpp v14, v24, v126 row_newbcast:0 row_mask:0xf bank_mask:0xf
    v_dot2c_f32_bf16_dpp v15, v24, v127 row_newbcast:0 row_mask:0xf bank_mask:0xf
    v_dot2c_f32_bf16_dpp v8, v24, v128 row_newbcast:1 row_mask:0xf bank_mask:0xf
    v_dot2c_f32_bf16_dpp v9, v24, v129 row_newbcast:1 row_mask:0xf bank_mask:0xf
    v_dot2c_f32_bf16_dpp v10, v24, v130 row_newbcast:1 row_mask:0xf bank_mask:0xf
    v_dot2c_f32_bf16_dpp v11, v24, v131 row_newbcast:1 row_mask:0xf bank_mask:0xf
    v_dot2c_f32_bf16_dpp v12, v24, v132 row_newbcast:1 row_mask:0xf bank_mask:0xf
    v_dot2c_f32_bf16_dpp v13, v24, v133 row_newbcast:1 row_mask:0xf bank_mask:0xf
    v_dot2c_f32_bf16_dpp v14, v24, v134 row_newbcast:1 row_mask:0xf bank_mask:0xf
    v_dot2c_f32_bf16_dpp v15, v24, v135 row_newbcast:1 row_mask:0xf bank_mask:0xf
    v_dot2c_f32_bf16_dpp v8, v24, v136 row_newbcast:2 row_mask:0xf bank_mask:0xf
    v_dot2c_f32_bf16_dpp v9, v24, v137 row_newbcast:2 row_mask:0xf bank_mask:0xf
    v_dot2c_f32_bf16_dpp v10, v24, v138 row_newbcast:2 row_mask:0xf bank_mask:0xf
    v_dot2c_f32_bf16_dpp v11, v24, v139 row_newbcast:2 row_mask:0xf bank_mask:0xf
    v_dot2c_f32_bf16_dpp v12, v24, v140 row_newbcast:2 row_mask:0xf bank_mask:0xf
    v_dot2c_f32_bf16_dpp v13, v24, v141 row_newbcast:2 row_mask:0xf bank_mask:0xf
    v_dot2c_f32_bf16_dpp v14, v24, v142 row_newbcast:2 row_mask:0xf bank_mask:0xf
    v_dot2c_f32_bf16_dpp v15, v24, v143 row_newbcast:2 row_mask:0xf bank_mask:0xf
    v_dot2c_f32_bf16_dpp v8, v24, v144 row_newbcast:3 row_mask:0xf bank_mask:0xf
    v_dot2c_f32_bf16_dpp v9, v24, v145 row_newbcast:3 row_mask:0xf bank_mask:0xf
    v_dot2c_f32_bf16_dpp v10, v24, v146 row_newbcast:3 row_mask:0xf bank_mask:0xf
    v_dot2c_f32_bf16_dpp v11, v24, v147 row_newbcast:3 row_mask:0xf bank_mask:0xf
    v_dot2c_f32_bf16_dpp v12, v24, v148 row_newbcast:3 row_mask:0xf bank_mask:0xf
    v_dot2c_f32_bf16_dpp v13, v24, v149 row_newbcast:3 row_mask:0xf bank_mask:0xf
    v_dot2c_f32_bf16_dpp v14, v24, v150 row_newbcast:3 row_mask:0xf bank_mask:0xf
    v_dot2c_f32_bf16_dpp v15, v24, v151 row_newbcast:3 row_mask:0xf bank_mask:0xf
    v_dot2c_f32_bf16_dpp v8, v24, v152 row_newbcast:4 row_mask:0xf bank_mask:0xf
    v_dot2c_f32_bf16_dpp v9, v24, v153 row_newbcast:4 row_mask:0xf bank_mask:0xf
    v_dot2c_f32_bf16_dpp v10, v24, v154 row_newbcast:4 row_mask:0xf bank_mask:0xf
    v_dot2c_f32_bf16_dpp v11, v24, v155 row_newbcast:4 row_mask:0xf bank_mask:0xf
    v_dot2c_f32_bf16_dpp v12, v24, v156 row_newbcast:4 row_mask:0xf bank_mask:0xf
    v_dot2c_f32_bf16_dpp v13, v24, v157 row_newbcast:4 row_mask:0xf bank_mask:0xf
    v_dot2c_f32_bf16_dpp v14, v24, v158 row_newbcast:4 row_mask:0xf bank_mask:0xf
    v_dot2c_f32_bf16_dpp v15, v24, v159 row_newbcast:4 row_mask:0xf bank_mask:0xf
    v_dot2c_f32_bf16_dpp v8, v24, v160 row_newbcast:5 row_mask:0xf bank_mask:0xf
    v_dot2c_f32_bf16_dpp v9, v24, v161 row_newbcast:5 row_mask:0xf bank_mask:0xf
    v_dot2c_f32_bf16_dpp v10, v24, v162 row_newbcast:5 row_mask:0xf bank_mask:0xf
    v_dot2c_f32_bf16_dpp v11, v24, v163 row_newbcast:5 row_mask:0xf bank_mask:0xf
    v_dot2c_f32_bf16_dpp v12, v24, v164 row_newbcast:5 row_mask:0xf bank_mask:0xf
    v_dot2c_f32_bf16_dpp v13, v24, v165 row_newbcast:5 row_mask:0xf bank_mask:0xf
    v_dot2c_f32_bf16_dpp v14, v24, v166 row_newbcast:5 row_mask:0xf bank_mask:0xf
    v_dot2c_f32_bf16_dpp v15, v24, v167 row_newbcast:5 row_mask:0xf bank_mask:0xf
    v_dot2c_f32_bf16_dpp v8, v24, v168 row_newbcast:6 row_mask:0xf bank_mask:0xf
    v_dot2c_f32_bf16_dpp v9, v24, v169 row_newbcast:6 row_mask:0xf bank_mask:0xf
    v_dot2c_f32_bf16_dpp v10, v24, v170 row_newbcast:6 row_mask:0xf bank_mask:0xf
    v_dot2c_f32_bf16_dpp v11, v24, v171 row_newbcast:6 row_mask:0xf bank_mask:0xf
    v_dot2c_f32_bf16_dpp v12, v24, v172 row_newbcast:6 row_mask:0xf bank_mask:0xf
    v_dot2c_f32_bf16_dpp v13, v24, v173 row_newbcast:6 row_mask:0xf bank_mask:0xf
    v_dot2c_f32_bf16_dpp v14, v24, v174 row_newbcast:6 row_mask:0xf bank_mask:0xf
    v_dot2c_f32_bf16_dpp v15, v24, v175 row_newbcast:6 row_mask:0xf bank_mask:0xf
    v_dot2c_f32_bf16_dpp v8, v24, v176 row_newbcast:7 row_mask:0xf bank_mask:0xf
    v_dot2c_f32_bf16_dpp v9, v24, v177 row_newbcast:7 row_mask:0xf bank_mask:0xf
    v_dot2c_f32_bf16_dpp v10, v24, v178 row_newbcast:7 row_mask:0xf bank_mask:0xf
    v_dot2c_f32_bf16_dpp v11, v24, v179 row_newbcast:7 row_mask:0xf bank_mask:0xf
    v_dot2c_f32_bf16_dpp v12, v24, v180 row_newbcast:7 row_mask:0xf bank_mask:0xf
    v_dot2c_f32_bf16_dpp v13, v24, v181 row_newbcast:7 row_mask:0xf bank_mask:0xf
    v_dot2c_f32_bf16_dpp v14, v24, v182 row_newbcast:7 row_mask:0xf bank_mask:0xf
    v_dot2c_f32_bf16_dpp v15, v24, v183 row_newbcast:7 row_mask:0xf bank_mask:0xf
    v_dot2c_f32_bf16_dpp v8, v24, v184 row_newbcast:8 row_mask:0xf bank_mask:0xf
    v_dot2c_f32_bf16_dpp v9, v24, v185 row_newbcast:8 row_mask:0xf bank_mask:0xf
    v_dot2c_f32_bf16_dpp v10, v24, v186 row_newbcast:8 row_mask:0xf bank_mask:0xf
    v_dot2c_f32_bf16_dpp v11, v24, v187 row_newbcast:8 row_mask:0xf bank_mask:0xf
    v_dot2c_f32_bf16_dpp v12, v24, v188 row_newbcast:8 row_mask:0xf bank_mask:0xf
    v_dot2c_f32_bf16_dpp v13, v24, v189 row_newbcast:8 row_mask:0xf bank_mask:0xf
    v_dot2c_f32_bf16_dpp v14, v24, v190 row_newbcast:8 row_mask:0xf bank_mask:0xf
    v_dot2c_f32_bf16_dpp v15, v24, v191 row_newbcast:8 row_mask:0xf bank_mask:0xf
    v_dot2c_f32_bf16_dpp v8, v24, v192 row_newbcast:9 row_mask:0xf bank_mask:0xf
    v_dot2c_f32_bf16_dpp v9, v24, v193 row_newbcast:9 row_mask:0xf bank_mask:0xf
    v_dot2c_f32_bf16_dpp v10, v24, v194 row_newbcast:9 row_mask:0xf bank_mask:0xf
    v_dot2c_f32_bf16_dpp v11, v24, v195 row_newbcast:9 row_mask:0xf bank_mask:0xf
    v_dot2c_f32_bf16_dpp v12, v24, v196 row_newbcast:9 row_mask:0xf bank_mask:0xf
    v_dot2c_f32_bf16_dpp v13, v24, v197 row_newbcast:9 row_mask:0xf bank_mask:0xf
    v_dot2c_f32_bf16_dpp v14, v24, v198 row_newbcast:9 row_mask:0xf bank_mask:0xf
    v_dot2c_f32_bf16_dpp v15, v24, v199 row_newbcast:9 row_mask:0xf bank_mask:0xf
    v_dot2c_f32_bf16_dpp v8, v24, v200 row_newbcast:10 row_mask:0xf bank_mask:0xf
    v_dot2c_f32_bf16_dpp v9, v24, v201 row_newbcast:10 row_mask:0xf bank_mask:0xf
    v_dot2c_f32_bf16_dpp v10, v24, v202 row_newbcast:10 row_mask:0xf bank_mask:0xf
    v_dot2c_f32_bf16_dpp v11, v24, v203 row_newbcast:10 row_mask:0xf bank_mask:0xf
    v_dot2c_f32_bf16_dpp v12, v24, v204 row_newbcast:10 row_mask:0xf bank_mask:0xf
    v_dot2c_f32_bf16_dpp v13, v24, v205 row_newbcast:10 row_mask:0xf bank_mask:0xf
    v_dot2c_f32_bf16_dpp v14, v24, v206 row_newbcast:10 row_mask:0xf bank_mask:0xf
    v_dot2c_f32_bf16_dpp v15, v24, v207 row_newbcast:10 row_mask:0xf bank_mask:0xf
    v_dot2c_f32_bf16_dpp v8, v24, v208 row_newbcast:11 row_mask:0xf bank_mask:0xf
    v_dot2c_f32_bf16_dpp v9, v24, v209 row_newbcast:11 row_mask:0xf bank_mask:0xf
    v_dot2c_f32_bf16_dpp v10, v24, v210 row_newbcast:11 row_mask:0xf bank_mask:0xf
    v_dot2c_f32_bf16_dpp v11, v24, v211 row_newbcast:11 row_mask:0xf bank_mask:0xf
    v_dot2c_f32_bf16_dpp v12, v24, v212 row_newbcast:11 row_mask:0xf bank_mask:0xf
    v_dot2c_f32_bf16_dpp v13, v24, v213 row_newbcast:11 row_mask:0xf bank_mask:0xf
    v_dot2c_f32_bf16_dpp v14, v24, v214 row_newbcast:11 row_mask:0xf bank_mask:0xf
    v_dot2c_f32_bf16_dpp v15, v24, v215 row_newbcast:11 row_mask:0xf bank_mask:0xf
    v_dot2c_f32_bf16_dpp v8, v24, v216 row_newbcast:12 row_mask:0xf bank_mask:0xf
    v_dot2c_f32_bf16_dpp v9, v24, v217 row_newbcast:12 row_mask:0xf bank_mask:0xf
    v_dot2c_f32_bf16_dpp v10, v24, v218 row_newbcast:12 row_mask:0xf bank_mask:0xf
    v_dot2c_f32_bf16_dpp v11, v24, v219 row_newbcast:12 row_mask:0xf bank_mask:0xf
    v_dot2c_f32_bf16_dpp v12, v24, v220 row_newbcast:12 row_mask:0xf bank_mask:0xf
    v_dot2c_f32_bf16_dpp v13, v24, v221 row_newbcast:12 row_mask:0xf bank_mask:0xf
    v_dot2c_f32_bf16_dpp v14, v24, v222 row_newbcast:12 row_mask:0xf bank_mask:0xf
    v_dot2c_f32_bf16_dpp v15, v24, v223 row_newbcast:12 row_mask:0xf bank_mask:0xf
    v_dot2c_f32_bf16_dpp v8, v24, v224 row_newbcast:13 row_mask:0xf bank_mask:0xf
    v_dot2c_f32_bf16_dpp v9, v24, v225 row_newbcast:13 row_mask:0xf bank_mask:0xf
    v_dot2c_f32_bf16_dpp v10, v24, v226 row_newbcast:13 row_mask:0xf bank_mask:0xf
    v_dot2c_f32_bf16_dpp v11, v24, v227 row_newbcast:13 row_mask:0xf bank_mask:0xf
    v_dot2c_f32_bf16_dpp v12, v24, v228 row_newbcast:13 row_mask:0xf bank_mask:0xf
    v_dot2c_f32_bf16_dpp v13, v24, v229 row_newbcast:13 row_mask:0xf bank_mask:0xf
    v_dot2c_f32_bf16_dpp v14, v24, v230 row_newbcast:13 row_mask:0xf bank_mask:0xf
    v_dot2c_f32_bf16_dpp v15, v24, v231 row_newbcast:13 row_mask:0xf bank_mask:0xf
    v_dot2c_f32_bf16_dpp v8, v24, v232 row_newbcast:14 row_mask:0xf bank_mask:0xf
    v_dot2c_f32_bf16_dpp v9, v24, v233 row_newbcast:14 row_mask:0xf bank_mask:0xf
    v_dot2c_f32_bf16_dpp v10, v24, v234 row_newbcast:14 row_mask:0xf bank_mask:0xf
    v_dot2c_f32_bf16_dpp v11, v24, v235 row_newbcast:14 row_mask:0xf bank_mask:0xf
    v_dot2c_f32_bf16_dpp v12, v24, v236 row_newbcast:14 row_mask:0xf bank_mask:0xf
    v_dot2c_f32_bf16_dpp v13, v24, v237 row_newbcast:14 row_mask:0xf bank_mask:0xf
    v_dot2c_f32_bf16_dpp v14, v24, v238 row_newbcast:14 row_mask:0xf bank_mask:0xf
    v_dot2c_f32_bf16_dpp v15, v24, v239 row_newbcast:14 row_mask:0xf bank_mask:0xf
    v_dot2c_f32_bf16_dpp v8, v24, v240 row_newbcast:15 row_mask:0xf bank_mask:0xf
    v_dot2c_f32_bf16_dpp v9, v24, v241 row_newbcast:15 row_mask:0xf bank_mask:0xf
    v_dot2c_f32_bf16_dpp v10, v24, v242 row_newbcast:15 row_mask:0xf bank_mask:0xf
    v_dot2c_f32_bf16_dpp v11, v24, v243 row_newbcast:15 row_mask:0xf bank_mask:0xf
    v_dot2c_f32_bf16_dpp v12, v24, v244 row_newbcast:15 row_mask:0xf bank_mask:0xf
    v_dot2c_f32_bf16_dpp v13, v24, v245 row_newbcast:15 row_mask:0xf bank_mask:0xf
    v_dot2c_f32_bf16_dpp v14, v24, v246 row_newbcast:15 row_mask:0xf bank_mask:0xf
    v_dot2c_f32_bf16_dpp v15, v24, v247 row_newbcast:15 row_mask:0xf bank_mask:0xf
    v_permlane32_swap_b32 v8, v12
    v_permlane32_swap_b32 v9, v13
    v_permlane32_swap_b32 v10, v14
    v_permlane32_swap_b32 v11, v15
    v_pk_add_f32 v[8:9], v[8:9], v[12:13]
    v_pk_add_f32 v[10:11], v[10:11], v[14:15]
    s_nop 1
    v_permlane16_swap_b32 v8, v10
    v_permlane16_swap_b32 v9, v11
    v_pk_add_f32 v[8:9], v[8:9], v[10:11]
    v_fmac_f32 v22, v8, v20
    v_fmac_f32 v23, v9, v20
    v_and_or_b32 v12, v22, s52, v27
    v_and_or_b32 v13, v23, s52, v27
    v_and_or_b32 v14, v22, s52, v27
    v_and_or_b32 v15, v23, s52, v27
    s_nop 0
    v_permlane32_swap_b32 v12, v14
    v_permlane32_swap_b32 v13, v15
    s_mov_b32 exec_hi, 0
    buffer_store_dwordx4 v[12:15], v253, s[76:79], s49 offen sc1
    s_cmp_lt_u32 s50, 28
    s_cbranch_scc1 L_hend
    s_mov_b64 exec, -1
    s_mov_b32 s59, 0x400000
    s_waitcnt vmcnt(1)
L_cnt:
    v_readfirstlane_b32 s35, v30
    s_sub_u32 s35, s35, s55
    s_cmp_ge_u32 s35, 32
    s_cbranch_scc1 L_go
    buffer_load_dword v30, v6, s[84:87], s54 offen sc1
    s_waitcnt vmcnt(0)
    s_sub_u32 s59, s59, 1
    s_cbranch_scc0 L_cnt
    s_branch L_fail
L_go:
L_poll:
    buffer_load_dwordx4 v[56:59], v28, s[76:79], s12 offen sc1
    buffer_load_dwordx4 v[60:63], v28, s[76:79], s13 offen sc1
    buffer_load_dwordx4 v[64:67], v28, s[76:79], s14 offen sc1
    buffer_load_dwordx4 v[68:71], v28, s[76:79], s15 offen sc1
L_p0w:
    s_waitcnt vmcnt(2)
    v_xor_b32 v16, v56, v27
    v_xor_b32 v17, v57, v27
    v_bitop3_b32 v16, v16, v58, v27 bitop3:0xf6
    v_bitop3_b32 v17, v17, v59, v27 bitop3:0xf6
    v_bitop3_b32 v16, v16, v60, v27 bitop3:0xf6
    v_bitop3_b32 v17, v17, v61, v27 bitop3:0xf6
    v_bitop3_b32 v16, v16, v62, v27 bitop3:0xf6
    v_bitop3_b32 v17, v17, v63, v27 bitop3:0xf6
    v_pk_add_f32 v[8:9], v[56:57], v[60:61]
    v_pk_add_f32 v[10:11], v[58:59], v[62:63]
    s_waitcnt vmcnt(0)
    v_bitop3_b32 v16, v16, v64, v27 bitop3:0xf6
    v_bitop3_b32 v17, v17, v65, v27 bitop3:0xf6
    v_bitop3_b32 v16, v16, v66, v27 bitop3:0xf6
    v_bitop3_b32 v17, v17, v67, v27 bitop3:0xf6
    v_bitop3_b32 v16, v16, v68, v27 bitop3:0xf6
    v_bitop3_b32 v17, v17, v69, v27 bitop3:0xf6
    v_bitop3_b32 v16, v16, v70, v27 bitop3:0xf6
    v_bitop3_b32 v17, v17, v71, v27 bitop3:0xf6
    v_pk_add_f32 v[12:13], v[64:65], v[68:69]
    v_or_b32 v16, v16, v17
    v_pk_add_f32 v[14:15], v[66:67], v[70:71]
    v_cmp_ne_u32_sdwa vcc, v16, v6 src0_sel:BYTE_0 src1_sel:DWORD
    v_pk_add_f32 v[8:9], v[8:9], v[12:13]
    v_pk_add_f32 v[10:11], v[10:11], v[14:15]
    s_cbranch_vccz L_ok
    s_sub_u32 s59, s59, 1
    s_cbranch_scc0 L_poll
L_fail:
    s_branch L_hend
L_ok:
    s_nop 0
    v_permlane32_swap_b32 v8, v10
    v_permlane32_swap_b32 v9, v11
    v_pk_add_f32 v[8:9], v[8:9], v[10:11]
    v_mov_b32 v10, v8
    v_mov_b32 v11, v9
    s_nop 0
    v_permlane16_swap_b32 v8, v10
    v_permlane16_swap_b32 v9, v11
    v_pk_add_f32 v[8:9], v[8:9], v[10:11]
    s_nop 1
    v_add_f32_dpp v8, v8, v8 row_ror:8 row_mask:0xf bank_mask:0xf
    v_add_f32_dpp v9, v9, v9 row_ror:8 row_mask:0xf bank_mask:0xf
    v_cvt_pk_bf16_f32 v8, v8, v9
    s_mov_b32 exec_lo, 255
    s_mov_b32 exec_hi, 255
    buffer_store_dword v8, v29, s[80:83], s51 offen
    s_cmp_lg_u32 s50, 31
    s_cbranch_scc1 L_hend
    s_cmp_lg_u32 s3, 0
    s_cbranch_scc1 L_hend
    s_mov_b64 exec, 1
    buffer_store_dword v252, v254, s[76:79], 0 offen
L_hend:
L_done:
    s_endpgm
.section .rodata,"a"
.p2align 6
.amdhsa_kernel gated_mix__mha_block_cached__moe_arch_mod__decode_kernel
  .amdhsa_next_free_vgpr 256
  .amdhsa_next_free_sgpr 102
  .amdhsa_accum_offset 256
  .amdhsa_group_segment_fixed_size 0
  .amdhsa_kernarg_size 112
  .amdhsa_user_sgpr_count 2
  .amdhsa_user_sgpr_kernarg_segment_ptr 1
  .amdhsa_system_sgpr_workgroup_id_x 1
.end_amdhsa_kernel
```
